```python
import torch

def _softmax(x, axis=-1):
    return torch.softmax(x, dim=axis)
def _gelu(x):
    return torch.nn.functional.gelu(x, approximate="tanh")
def _silu(x):
    return torch.nn.functional.silu(x)
def _sigmoid(x):
    return torch.sigmoid(x)
def _layernorm(x, axis=-1, eps=1e-5):
    m = x.mean(dim=axis, keepdim=True)
    v = x.var(dim=axis, keepdim=True, unbiased=False)
    return (x - m) / torch.sqrt(v + eps)
def _scatter_add(tgt, idx, src, axis=0):
    return tgt.clone().index_add_(axis, idx, src)
def _segment_sum(src, seg, n):
    out = torch.zeros((n,) + src.shape[1:], dtype=src.dtype)
    return out.index_add_(0, seg, src)
def _pad(x, pw):
    flat = tuple(v for pair in reversed(pw) for v in pair)
    return torch.nn.functional.pad(x, flat)

kernel_name = 'interleave_layers__mha_block_cached__glu_gated_geglu__decode'

def setup_inputs():

    _w = (lambda a: (lambda t: t.to(torch.bfloat16) if t.is_floating_point() else t)(torch.as_tensor(a)))
    def _A_setup():
        B, Sq, D = 4, 1, 640
        H, Sk, Dh = 32, 8192, 192
        return {
            "x": _w((lambda *s: torch.randn(*s, dtype=torch.bfloat16) * 0.05)(B, Sq, D)),
            "k_cache": _w((lambda *s: torch.randn(*s, dtype=torch.bfloat16) * 0.4)(B, H, Sk, Dh)),
            "v_cache": _w((lambda *s: torch.randn(*s, dtype=torch.bfloat16) * 1.6)(B, H, Sk, Dh)),
            "wq": _w((lambda *s: torch.randn(*s, dtype=torch.bfloat16) * 0.4)(D, H * Dh) * (D ** -0.5)),
            "wo": _w((lambda *s: torch.randn(*s, dtype=torch.bfloat16) * 1.6)(H * Dh, D) * ((H * Dh) ** -0.5)),
        }
    _A_in = _A_setup()

    def _B_setup():
        B, S, Dm, Df = 4, 1, 640, 1536
        return {
            "x": _w((lambda *s: torch.randn(*s, dtype=torch.bfloat16) * 0.05)(B, S, Dm)),
            "w_gate": _w((lambda *s: torch.randn(*s, dtype=torch.bfloat16) * 0.4)(Dm, Df) * (Dm ** -0.5)),
            "w_up": _w((lambda *s: torch.randn(*s, dtype=torch.bfloat16) * 0.4)(Dm, Df) * (Dm ** -0.5)),
            "w_down": _w((lambda *s: torch.randn(*s, dtype=torch.bfloat16) * 0.4)(Df, Dm) * (Df ** -0.5)),
        }
    _B_in = _B_setup()

    return {
        "A_x": _A_in["x"],
        "A_k_cache": _A_in["k_cache"],
        "A_v_cache": _A_in["v_cache"],
        "A_wq": _A_in["wq"],
        "A_wo": _A_in["wo"],
        "B_x": _B_in["x"],
        "B_w_gate": _B_in["w_gate"],
        "B_w_up": _B_in["w_up"],
        "B_w_down": _B_in["w_down"],
    }

def reference(A_x, A_k_cache, A_v_cache, A_wq, A_wo, B_x, B_w_gate, B_w_up, B_w_down):
    def _A_ref(x, k_cache, v_cache, wq, wo):
        B, Sq, D = x.shape
        H, Dh = 32, 192
        q = (lambda x, *d: x.permute(*d))((x @ wq).reshape(B, Sq, H, Dh), 0, 2, 1, 3)
        scores = torch.einsum("bhqd,bhkd->bhqk", q, k_cache) * (Dh ** -0.5)
        p = _softmax(scores, axis=-1)
        o = torch.einsum("bhqk,bhkd->bhqd", p, v_cache)
        return (lambda x, *d: x.permute(*d))(o, 0, 2, 1, 3).reshape(B, Sq, H * Dh) @ wo

    def _B_ref(x, w_gate, w_up, w_down):
        g = torch.einsum("bsd,df->bsf", x, w_gate)
        u = torch.einsum("bsd,df->bsf", x, w_up)
        h = _gelu(g) * u
        return torch.einsum("bsf,fd->bsd", h, w_down)

    x = A_x
    x = x + _A_ref(_layernorm(x, axis=-1), A_k_cache, A_v_cache, A_wq, A_wo)
    x = x + _B_ref(_layernorm(x, axis=-1), B_w_gate, B_w_up, B_w_down)
    x = x + _A_ref(_layernorm(x, axis=-1), A_k_cache, A_v_cache, A_wq, A_wo)
    x = x + _B_ref(_layernorm(x, axis=-1), B_w_gate, B_w_up, B_w_down)
    return x
```

```asm
; @launch grid=(256,1,1) block=(256,1,1) lds=163840
.amdgcn_target "amdgcn-amd-amdhsa--gfx950"
.text
.globl interleave_layers__mha_block_cached__glu_gated_geglu__decode_kernel
.p2align 8
.type interleave_layers__mha_block_cached__glu_gated_geglu__decode_kernel,@function
interleave_layers__mha_block_cached__glu_gated_geglu__decode_kernel:
    s_cmp_ge_u32 s2, 256
    s_cbranch_scc1 L_end
    s_load_dwordx16 s[4:19], s[0:1], 0
    s_load_dwordx8 s[20:27], s[0:1], 64
    s_mul_i32 s40, s2, 5042
    s_lshr_b32 s40, s40, 16
    s_mul_i32 s43, s40, 13
    s_sub_u32 s41, s2, s43
    s_sub_u32 s43, s2, 208
    s_mul_i32 s44, s43, 43691
    s_lshr_b32 s44, s44, 17
    s_mul_i32 s45, s44, 3
    s_sub_u32 s43, s43, s45
    s_add_u32 s43, s43, 13
    s_cmp_ge_u32 s2, 208
    s_cselect_b32 s40, s44, s40
    s_cselect_b32 s41, s43, s41
    v_lshrrev_b32 v1, 6, v0
    s_nop 0
    v_readfirstlane_b32 s42, v1
    v_mov_b32 v2, v0
    v_and_b32 v0, 63, v0
    s_waitcnt lgkmcnt(0)
    s_mov_b32 s28, s26
    s_mov_b32 s29, s27
    s_mov_b32 s30, 1610612736
    s_mov_b32 s31, 0x00020000
    s_mov_b32 s32, s24
    s_mov_b32 s33, s25
    s_mov_b32 s34, 256
    s_mov_b32 s35, 0x00020000
    s_mov_b32 s36, s26
    s_mov_b32 s37, s27
    s_mov_b32 s38, 9314304
    s_mov_b32 s39, 0x00020000
    s_cmp_ge_u32 s41, 13
    s_cbranch_scc1 L_svc
    v_mov_b32 v100, v0
    s_lshl_b32 s44, s41, 2
    s_add_u32 s70, s42, s44
    s_lshl_b32 s69, s40, 1
    s_cmp_ge_u32 s70, 26
    s_cselect_b32 s44, 26, 0
    s_cselect_b32 s43, 1, 0
    s_sub_u32 s70, s70, s44
    s_add_u32 s69, s69, s43
    s_mul_i32 s43, s69, 3145728
    s_add_u32 s52, s6, s43
    s_addc_u32 s53, s7, 0
    s_sub_u32 s54, 402653184, s43
    s_mov_b32 s55, 0x00020000
    s_add_u32 s56, s8, s43
    s_addc_u32 s57, s9, 0
    s_sub_u32 s58, 402653184, s43
    s_mov_b32 s59, 0x00020000
    v_lshrrev_b32 v101, 3, v100
    v_mul_u32_u24 v101, 384, v101
    v_and_b32 v102, 7, v100
    v_lshlrev_b32 v102, 4, v102
    v_accvgpr_write_b32 a252, v102
    v_add_u32 v5, v101, v102
    s_mul_i32 s43, s70, 3072
    v_add_u32 v5, s43, v5
    s_mul_i32 s88, s42, 40960
    s_mov_b32 s76, 0
    s_add_u32 s71, s76, 0
    buffer_load_dwordx4 v[112:115], v5, s[52:55], s71 offen offset:0 nt
    buffer_load_dwordx4 v[116:119], v5, s[52:55], s71 offen offset:128 nt
    buffer_load_dwordx4 v[120:123], v5, s[52:55], s71 offen offset:256 nt
    buffer_load_dwordx4 a[0:3], v5, s[56:59], s71 offen offset:0 nt
    buffer_load_dwordx4 a[4:7], v5, s[56:59], s71 offen offset:128 nt
    buffer_load_dwordx4 a[8:11], v5, s[56:59], s71 offen offset:256 nt
    s_mov_b32 s60, 0x3dd53b95
    s_mov_b32 s64, 0x00ff00ff
    s_mov_b32 s65, 0
    s_cmp_lt_u32 s70, 10
    s_cselect_b32 s66, 0, 0xff800000
    v_and_b32 v101, 15, v100
    v_lshlrev_b32 v101, 5, v101
    v_lshrrev_b32 v102, 4, v100
    v_lshlrev_b32 v102, 4, v102
    v_add_u32 v101, v101, v102
    v_accvgpr_write_b32 a253, v101
    v_lshlrev_b32 v6, 4, v100
    v_add_u32 v6, s88, v6
    v_and_b32 v101, 1, v100
    v_lshlrev_b32 v101, 4, v101
    v_mov_b32 v102, 0xffff
    v_lshlrev_b32 v102, v101, v102
    v_bfe_u32 v103, v100, 1, 2
    v_cmp_eq_u32 vcc, 0, v103
    s_nop 1
    v_cndmask_b32 v8, 0, v102, vcc
    v_cmp_eq_u32 vcc, 1, v103
    s_nop 1
    v_cndmask_b32 v9, 0, v102, vcc
    v_cmp_eq_u32 vcc, 2, v103
    s_nop 1
    v_cndmask_b32 v10, 0, v102, vcc
    v_cmp_eq_u32 vcc, 3, v103
    s_nop 1
    v_cndmask_b32 v11, 0, v102, vcc
    s_getpc_b64 s[94:95]
L_pc0:
    s_add_u32 s98, s94, L_rareB2-L_pc0
    s_addc_u32 s99, s95, 0
    s_add_u32 s96, s94, L_rareB-L_pc0
    s_addc_u32 s97, s95, 0
    s_add_u32 s94, s94, L_rareA-L_pc0
    s_addc_u32 s95, s95, 0
    s_mul_i32 s84, s69, 26
    s_add_u32 s84, s84, s70
    s_lshl_b32 s84, s84, 10
    s_add_u32 s84, s84, 794624
    s_mul_i32 s85, s69, 384
    s_mov_b32 s80, 0xac491280
    s_mov_b32 s81, 0x00de6b35
    s_lshl_b32 s45, s69, 2
    s_add_u32 s45, s45, 64
    s_waitcnt vmcnt(0)
    s_add_u32 s71, s76, 79872
    buffer_load_dwordx4 v[124:127], v5, s[52:55], s71 offen offset:0 nt
    buffer_load_dwordx4 v[128:131], v5, s[52:55], s71 offen offset:128 nt
    buffer_load_dwordx4 v[132:135], v5, s[52:55], s71 offen offset:256 nt
    buffer_load_dwordx4 a[12:15], v5, s[56:59], s71 offen offset:0 nt
    buffer_load_dwordx4 a[16:19], v5, s[56:59], s71 offen offset:128 nt
    buffer_load_dwordx4 a[20:23], v5, s[56:59], s71 offen offset:256 nt
    s_waitcnt vmcnt(0)
    s_add_u32 s71, s76, 159744
    buffer_load_dwordx4 v[136:139], v5, s[52:55], s71 offen offset:0 nt
    buffer_load_dwordx4 v[140:143], v5, s[52:55], s71 offen offset:128 nt
    buffer_load_dwordx4 v[144:147], v5, s[52:55], s71 offen offset:256 nt
    buffer_load_dwordx4 a[24:27], v5, s[56:59], s71 offen offset:0 nt
    buffer_load_dwordx4 a[28:31], v5, s[56:59], s71 offen offset:128 nt
    buffer_load_dwordx4 a[32:35], v5, s[56:59], s71 offen offset:256 nt
    s_waitcnt vmcnt(0)
    s_add_u32 s71, s76, 239616
    buffer_load_dwordx4 v[148:151], v5, s[52:55], s71 offen offset:0 nt
    buffer_load_dwordx4 v[152:155], v5, s[52:55], s71 offen offset:128 nt
    buffer_load_dwordx4 v[156:159], v5, s[52:55], s71 offen offset:256 nt
    buffer_load_dwordx4 a[36:39], v5, s[56:59], s71 offen offset:0 nt
    buffer_load_dwordx4 a[40:43], v5, s[56:59], s71 offen offset:128 nt
    buffer_load_dwordx4 a[44:47], v5, s[56:59], s71 offen offset:256 nt
    s_waitcnt vmcnt(0)
    s_add_u32 s71, s76, 319488
    buffer_load_dwordx4 v[160:163], v5, s[52:55], s71 offen offset:0 nt
    buffer_load_dwordx4 v[164:167], v5, s[52:55], s71 offen offset:128 nt
    buffer_load_dwordx4 v[168:171], v5, s[52:55], s71 offen offset:256 nt
    buffer_load_dwordx4 a[48:51], v5, s[56:59], s71 offen offset:0 nt
    buffer_load_dwordx4 a[52:55], v5, s[56:59], s71 offen offset:128 nt
    buffer_load_dwordx4 a[56:59], v5, s[56:59], s71 offen offset:256 nt
    s_waitcnt vmcnt(18)
    s_add_u32 s71, s76, 399360
    buffer_load_dwordx4 v[172:175], v5, s[52:55], s71 offen offset:0 nt
    buffer_load_dwordx4 v[176:179], v5, s[52:55], s71 offen offset:128 nt
    buffer_load_dwordx4 v[180:183], v5, s[52:55], s71 offen offset:256 nt
    buffer_load_dwordx4 a[60:63], v5, s[56:59], s71 offen offset:0 nt
    buffer_load_dwordx4 a[64:67], v5, s[56:59], s71 offen offset:128 nt
    buffer_load_dwordx4 a[68:71], v5, s[56:59], s71 offen offset:256 nt
    s_waitcnt vmcnt(18)
    s_add_u32 s71, s76, 479232
    buffer_load_dwordx4 v[184:187], v5, s[52:55], s71 offen offset:0 nt
    buffer_load_dwordx4 v[188:191], v5, s[52:55], s71 offen offset:128 nt
    buffer_load_dwordx4 v[192:195], v5, s[52:55], s71 offen offset:256 nt
    buffer_load_dwordx4 a[72:75], v5, s[56:59], s71 offen offset:0 nt
    buffer_load_dwordx4 a[76:79], v5, s[56:59], s71 offen offset:128 nt
    buffer_load_dwordx4 a[80:83], v5, s[56:59], s71 offen offset:256 nt
    s_waitcnt vmcnt(18)
    s_add_u32 s71, s76, 559104
    buffer_load_dwordx4 v[196:199], v5, s[52:55], s71 offen offset:0 nt
    buffer_load_dwordx4 v[200:203], v5, s[52:55], s71 offen offset:128 nt
    buffer_load_dwordx4 v[204:207], v5, s[52:55], s71 offen offset:256 nt
    buffer_load_dwordx4 a[84:87], v5, s[56:59], s71 offen offset:0 nt
    buffer_load_dwordx4 a[88:91], v5, s[56:59], s71 offen offset:128 nt
    buffer_load_dwordx4 a[92:95], v5, s[56:59], s71 offen offset:256 nt
    s_waitcnt vmcnt(18)
    s_add_u32 s71, s76, 638976
    s_add_u32 m0, s88, 0
    s_nop 0
    buffer_load_dwordx4 v5, s[52:55], s71 offen offset:0 nt lds
    s_add_u32 m0, s88, 896
    s_nop 0
    buffer_load_dwordx4 v5, s[52:55], s71 offen offset:128 nt lds
    s_add_u32 m0, s88, 1792
    s_nop 0
    buffer_load_dwordx4 v5, s[52:55], s71 offen offset:256 nt lds
    s_add_u32 m0, s88, 33792
    s_nop 0
    buffer_load_dwordx4 v5, s[56:59], s71 offen offset:0 nt lds
    s_add_u32 m0, s88, 34688
    s_nop 0
    buffer_load_dwordx4 v5, s[56:59], s71 offen offset:128 nt lds
    s_add_u32 m0, s88, 35584
    s_nop 0
    buffer_load_dwordx4 v5, s[56:59], s71 offen offset:256 nt lds
    s_waitcnt vmcnt(18)
    s_add_u32 s71, s76, 718848
    s_add_u32 m0, s88, 3072
    s_nop 0
    buffer_load_dwordx4 v5, s[52:55], s71 offen offset:0 nt lds
    s_add_u32 m0, s88, 3968
    s_nop 0
    buffer_load_dwordx4 v5, s[52:55], s71 offen offset:128 nt lds
    s_add_u32 m0, s88, 4864
    s_nop 0
    buffer_load_dwordx4 v5, s[52:55], s71 offen offset:256 nt lds
    s_add_u32 m0, s88, 36864
    s_nop 0
    buffer_load_dwordx4 v5, s[56:59], s71 offen offset:0 nt lds
    s_add_u32 m0, s88, 37760
    s_nop 0
    buffer_load_dwordx4 v5, s[56:59], s71 offen offset:128 nt lds
    s_add_u32 m0, s88, 38656
    s_nop 0
    buffer_load_dwordx4 v5, s[56:59], s71 offen offset:256 nt lds
    buffer_load_dword v0, off, s[32:35], s45 sc1
    s_waitcnt vmcnt(19)
    s_add_u32 s71, s76, 798720
    s_add_u32 m0, s88, 6144
    s_nop 0
    buffer_load_dwordx4 v5, s[52:55], s71 offen offset:0 nt lds
    s_add_u32 m0, s88, 7040
    s_nop 0
    buffer_load_dwordx4 v5, s[52:55], s71 offen offset:128 nt lds
    s_add_u32 m0, s88, 7936
    s_nop 0
    buffer_load_dwordx4 v5, s[52:55], s71 offen offset:256 nt lds
    buffer_load_dwordx4 a[96:99], v5, s[56:59], s71 offen offset:0 nt
    buffer_load_dwordx4 a[100:103], v5, s[56:59], s71 offen offset:128 nt
    buffer_load_dwordx4 a[104:107], v5, s[56:59], s71 offen offset:256 nt
    s_waitcnt vmcnt(19)
    s_add_u32 s71, s76, 878592
    s_add_u32 m0, s88, 9216
    s_nop 0
    buffer_load_dwordx4 v5, s[52:55], s71 offen offset:0 nt lds
    s_add_u32 m0, s88, 10112
    s_nop 0
    buffer_load_dwordx4 v5, s[52:55], s71 offen offset:128 nt lds
    s_add_u32 m0, s88, 11008
    s_nop 0
    buffer_load_dwordx4 v5, s[52:55], s71 offen offset:256 nt lds
    buffer_load_dwordx4 a[108:111], v5, s[56:59], s71 offen offset:0 nt
    buffer_load_dwordx4 a[112:115], v5, s[56:59], s71 offen offset:128 nt
    buffer_load_dwordx4 a[116:119], v5, s[56:59], s71 offen offset:256 nt
    s_waitcnt vmcnt(19)
    s_add_u32 s71, s76, 958464
    s_add_u32 m0, s88, 12288
    s_nop 0
    buffer_load_dwordx4 v5, s[52:55], s71 offen offset:0 nt lds
    s_add_u32 m0, s88, 13184
    s_nop 0
    buffer_load_dwordx4 v5, s[52:55], s71 offen offset:128 nt lds
    s_add_u32 m0, s88, 14080
    s_nop 0
    buffer_load_dwordx4 v5, s[52:55], s71 offen offset:256 nt lds
    buffer_load_dwordx4 a[120:123], v5, s[56:59], s71 offen offset:0 nt
    buffer_load_dwordx4 a[124:127], v5, s[56:59], s71 offen offset:128 nt
    buffer_load_dwordx4 a[128:131], v5, s[56:59], s71 offen offset:256 nt
    s_waitcnt vmcnt(19)
    s_add_u32 s71, s76, 1038336
    s_add_u32 m0, s88, 15360
    s_nop 0
    buffer_load_dwordx4 v5, s[52:55], s71 offen offset:0 nt lds
    s_add_u32 m0, s88, 16256
    s_nop 0
    buffer_load_dwordx4 v5, s[52:55], s71 offen offset:128 nt lds
    s_add_u32 m0, s88, 17152
    s_nop 0
    buffer_load_dwordx4 v5, s[52:55], s71 offen offset:256 nt lds
    buffer_load_dwordx4 a[132:135], v5, s[56:59], s71 offen offset:0 nt
    buffer_load_dwordx4 a[136:139], v5, s[56:59], s71 offen offset:128 nt
    buffer_load_dwordx4 a[140:143], v5, s[56:59], s71 offen offset:256 nt
    s_waitcnt vmcnt(24)
    v_readfirstlane_b32 s43, v0
    s_cmp_ge_u32 s43, 1
    s_cbranch_scc1 Lq1ok_1
    s_mov_b32 s46, 0
    v_mov_b32 v1, 0
Lpoll_2:
    buffer_load_dword v0, v1, s[32:35], s45 offen sc1
    s_waitcnt vmcnt(0)
    v_readfirstlane_b32 s43, v0
    s_cmp_ge_u32 s43, 1
    s_cbranch_scc1 Lok_3
    s_sleep 16
    s_add_u32 s46, s46, 1
    s_cmp_lt_u32 s46, 524288
    s_cbranch_scc1 Lpoll_2
Lok_3:
Lq1ok_1:
    v_accvgpr_read_b32 v1, a252
    buffer_load_dwordx4 v[12:15], v1, s[28:31], s85 offen offset:0 sc1
    buffer_load_dwordx4 v[16:19], v1, s[28:31], s85 offen offset:128 sc1
    buffer_load_dwordx4 v[20:23], v1, s[28:31], s85 offen offset:256 sc1
    s_add_u32 s71, s76, 1118208
    s_add_u32 m0, s88, 18432
    s_nop 0
    buffer_load_dwordx4 v5, s[52:55], s71 offen offset:0 nt lds
    s_add_u32 m0, s88, 19328
    s_nop 0
    buffer_load_dwordx4 v5, s[52:55], s71 offen offset:128 nt lds
    s_add_u32 m0, s88, 20224
    s_nop 0
    buffer_load_dwordx4 v5, s[52:55], s71 offen offset:256 nt lds
    buffer_load_dwordx4 a[144:147], v5, s[56:59], s71 offen offset:0 nt
    buffer_load_dwordx4 a[148:151], v5, s[56:59], s71 offen offset:128 nt
    buffer_load_dwordx4 a[152:155], v5, s[56:59], s71 offen offset:256 nt
    s_add_u32 s71, s76, 1198080
    s_add_u32 m0, s88, 21504
    s_nop 0
    buffer_load_dwordx4 v5, s[52:55], s71 offen offset:0 nt lds
    s_add_u32 m0, s88, 22400
    s_nop 0
    buffer_load_dwordx4 v5, s[52:55], s71 offen offset:128 nt lds
    s_add_u32 m0, s88, 23296
    s_nop 0
    buffer_load_dwordx4 v5, s[52:55], s71 offen offset:256 nt lds
    buffer_load_dwordx4 a[156:159], v5, s[56:59], s71 offen offset:0 nt
    buffer_load_dwordx4 a[160:163], v5, s[56:59], s71 offen offset:128 nt
    buffer_load_dwordx4 a[164:167], v5, s[56:59], s71 offen offset:256 nt
    s_add_u32 s71, s76, 1277952
    s_add_u32 m0, s88, 24576
    s_nop 0
    buffer_load_dwordx4 v5, s[52:55], s71 offen offset:0 nt lds
    s_add_u32 m0, s88, 25472
    s_nop 0
    buffer_load_dwordx4 v5, s[52:55], s71 offen offset:128 nt lds
    s_add_u32 m0, s88, 26368
    s_nop 0
    buffer_load_dwordx4 v5, s[52:55], s71 offen offset:256 nt lds
    buffer_load_dwordx4 a[168:171], v5, s[56:59], s71 offen offset:0 nt
    buffer_load_dwordx4 a[172:175], v5, s[56:59], s71 offen offset:128 nt
    buffer_load_dwordx4 a[176:179], v5, s[56:59], s71 offen offset:256 nt
    s_add_u32 s71, s76, 1357824
    s_add_u32 m0, s88, 27648
    s_nop 0
    buffer_load_dwordx4 v5, s[52:55], s71 offen offset:0 nt lds
    s_add_u32 m0, s88, 28544
    s_nop 0
    buffer_load_dwordx4 v5, s[52:55], s71 offen offset:128 nt lds
    s_add_u32 m0, s88, 29440
    s_nop 0
    buffer_load_dwordx4 v5, s[52:55], s71 offen offset:256 nt lds
    buffer_load_dwordx4 a[180:183], v5, s[56:59], s71 offen offset:0 nt
    buffer_load_dwordx4 a[184:187], v5, s[56:59], s71 offen offset:128 nt
    buffer_load_dwordx4 a[188:191], v5, s[56:59], s71 offen offset:256 nt
    v_mov_b32 v24, 0
    v_mov_b32 v25, 0
    v_mov_b32 v26, 0
    v_mov_b32 v27, 0
    v_mov_b32 v28, 0
    v_mov_b32 v29, 0
    v_mov_b32 v30, 0
    v_mov_b32 v31, 0
    v_mov_b32 v32, 0
    v_mov_b32 v33, 0
    v_mov_b32 v34, 0
    v_mov_b32 v35, 0
    v_mov_b32 v36, 0
    v_mov_b32 v37, 0x7f800000
    v_mov_b32 v52, 0
    v_mov_b32 v53, 0
    v_mov_b32 v54, 0
    v_mov_b32 v55, 0
    v_mov_b32 v56, 0
    v_mov_b32 v57, 0
    v_mov_b32 v58, 0
    v_mov_b32 v59, 0
    v_mov_b32 v60, 0
    v_mov_b32 v61, 0
    v_mov_b32 v62, 0
    v_mov_b32 v63, 0
    v_mov_b32 v7, 0
    v_mov_b32 v38, 0x7f800000
    v_mov_b32 v40, 0
    v_mov_b32 v41, 0
    v_mov_b32 v42, 0
    v_mov_b32 v43, 0
    v_mov_b32 v44, 0
    v_mov_b32 v45, 0
    v_mov_b32 v46, 0
    v_mov_b32 v47, 0
    v_mov_b32 v48, 0
    v_mov_b32 v49, 0
    v_mov_b32 v50, 0
    v_mov_b32 v51, 0
    s_waitcnt vmcnt(24)
    s_mov_b32 s92, 0
    s_mov_b32 s72, 0
    s_mov_b32 s73, 0
    s_mov_b32 s89, 18
    s_mov_b32 s91, 1
    s_branch L_rphase
L_rphase:
    s_lshl_b32 s45, s72, 2
    s_lshr_b64 s[82:83], s[80:81], s45
    s_and_b32 s43, s82, 7
    s_bfe_u32 s45, s82, 0x10003
    s_and_b32 s43, s43, 3
    s_mul_i32 s74, s43, 100663296
    s_mul_i32 s43, s45, 638976
    s_add_u32 s74, s74, s43
    s_add_u32 s74, s74, 1837056
    s_cmp_ge_u32 s72, 14
    s_cselect_b32 s74, 2130706432, s74
    s_mov_b32 s67, 0
    s_mov_b32 s68, 0
    s_cmp_lg_u32 s73, 4
    s_cbranch_scc1 Lr4e_5
    s_mov_b32 s67, s66
    s_mov_b32 s68, 0xff800000
    v_mov_b32 v12, v40
    v_mov_b32 v13, v41
    v_mov_b32 v14, v42
    v_mov_b32 v15, v43
    v_mov_b32 v16, v44
    v_mov_b32 v17, v45
    v_mov_b32 v18, v46
    v_mov_b32 v19, v47
    v_mov_b32 v20, v48
    v_mov_b32 v21, v49
    v_mov_b32 v22, v50
    v_mov_b32 v23, v51
    v_mov_b32 v24, 0
    v_mov_b32 v25, 0
    v_mov_b32 v26, 0
    v_mov_b32 v27, 0
    v_mov_b32 v28, 0
    v_mov_b32 v29, 0
    v_mov_b32 v30, 0
    v_mov_b32 v31, 0
    v_mov_b32 v32, 0
    v_mov_b32 v33, 0
    v_mov_b32 v34, 0
    v_mov_b32 v35, 0
    v_mov_b32 v36, 0
    v_mov_b32 v37, 0x7f800000
Lr4e_5:
    ds_read_b128 v[64:67], v6 offset:0
    ds_read_b128 v[68:71], v6 offset:1024
    ds_read_b128 v[72:75], v6 offset:2048
    s_waitcnt vmcnt(45)
    s_waitcnt lgkmcnt(0)
    v_mov_b32 v76, 0
    v_mov_b32 v77, 0
    v_mov_b32 v78, 0
    v_mov_b32 v0, 0
    v_mov_b32 v1, 0
    v_mov_b32 v2, 0
    v_dot2c_f32_bf16 v76, v64, v40
    v_dot2c_f32_bf16 v77, v68, v44
    v_dot2c_f32_bf16 v78, v72, v48
    v_dot2c_f32_bf16 v0, v112, v12
    v_dot2c_f32_bf16 v1, v116, v16
    v_dot2c_f32_bf16 v2, v120, v20
    v_dot2c_f32_bf16 v76, v65, v41
    v_dot2c_f32_bf16 v77, v69, v45
    v_dot2c_f32_bf16 v78, v73, v49
    v_dot2c_f32_bf16 v0, v113, v13
    v_dot2c_f32_bf16 v1, v117, v17
    v_dot2c_f32_bf16 v2, v121, v21
    v_dot2c_f32_bf16 v76, v66, v42
    v_dot2c_f32_bf16 v77, v70, v46
    v_dot2c_f32_bf16 v78, v74, v50
    v_dot2c_f32_bf16 v0, v114, v14
    v_dot2c_f32_bf16 v1, v118, v18
    v_dot2c_f32_bf16 v2, v122, v22
    v_dot2c_f32_bf16 v76, v67, v43
    v_dot2c_f32_bf16 v77, v71, v47
    v_dot2c_f32_bf16 v78, v75, v51
    v_dot2c_f32_bf16 v0, v115, v15
    v_dot2c_f32_bf16 v1, v119, v19
    v_dot2c_f32_bf16 v2, v123, v23
    ds_read_b128 v[64:67], v6 offset:3072
    ds_read_b128 v[68:71], v6 offset:4096
    ds_read_b128 v[72:75], v6 offset:5120
    v_add_f32 v76, v76, v77
    v_add_f32 v76, v76, v78
    s_nop 0
    v_add_f32 v0, v0, v1
    v_add_f32 v0, v0, v2
    v_add_f32_dpp v76, v76, v76 quad_perm:[1,0,3,2] row_mask:0xf bank_mask:0xf
    s_nop 0
    v_add_f32_dpp v0, v0, v0 quad_perm:[1,0,3,2] row_mask:0xf bank_mask:0xf
    s_nop 0
    v_add_f32_dpp v76, v76, v76 quad_perm:[2,3,0,1] row_mask:0xf bank_mask:0xf
    s_nop 0
    v_add_f32_dpp v0, v0, v0 quad_perm:[2,3,0,1] row_mask:0xf bank_mask:0xf
    s_nop 0
    v_add_f32_dpp v76, v76, v76 row_half_mirror row_mask:0xf bank_mask:0xf
    s_nop 0
    v_add_f32_dpp v0, v0, v0 row_half_mirror row_mask:0xf bank_mask:0xf
    s_nop 0
    v_mul_f32 v76, s60, v76
    v_mul_f32 v0, s60, v0
    v_add_f32 v79, v76, v38
    v_add_f32 v3, v0, v37
    v_max_f32 v80, v79, v3
    v_cmp_lt_f32 vcc, 0, v80
    s_cbranch_vccz Lpsk_6
    s_swappc_b64 s[62:63], s[98:99]
    s_swappc_b64 s[62:63], s[94:95]
Lpsk_6:
    v_exp_f32 v80, v79
    v_exp_f32 v4, v3
    v_add_f32 v7, v7, v80
    v_add_f32 v36, v36, v4
    v_cvt_pk_bf16_f32 v80, v80, v80
    v_cvt_pk_bf16_f32 v4, v4, v4
    v_and_b32 v82, v80, v8
    v_and_b32 v83, v80, v9
    v_and_b32 v84, v80, v10
    v_and_b32 v85, v80, v11
    v_and_b32 v0, v4, v8
    v_and_b32 v1, v4, v9
    v_and_b32 v2, v4, v10
    v_and_b32 v3, v4, v11
    s_waitcnt vmcnt(42)
    ds_read_b128 v[100:103], v6 offset:33792
    ds_read_b128 v[104:107], v6 offset:34816
    ds_read_b128 v[108:111], v6 offset:35840
    s_waitcnt lgkmcnt(0)
    v_mfma_f32_16x16x32_bf16 v[52:55], v[82:85], v[100:103], v[52:55]
    v_mfma_f32_16x16x32_bf16 v[56:59], v[82:85], v[104:107], v[56:59]
    v_mfma_f32_16x16x32_bf16 v[60:63], v[82:85], v[108:111], v[60:63]
    v_mfma_f32_16x16x32_bf16 v[24:27], v[0:3], a[0:3], v[24:27]
    v_mfma_f32_16x16x32_bf16 v[28:31], v[0:3], a[4:7], v[28:31]
    v_mfma_f32_16x16x32_bf16 v[32:35], v[0:3], a[8:11], v[32:35]
    s_cmp_gt_u32 s89, 8
    s_cbranch_scc1 LskIs_7
    s_cmp_eq_u32 s91, 1
    s_cbranch_scc1 Lthr_8
    s_waitcnt vmcnt(18)
Lthr_8:
    s_add_u32 s71, s76, 638976
    s_add_u32 m0, s88, 0
    s_nop 0
    buffer_load_dwordx4 v5, s[52:55], s71 offen offset:0 nt lds
    s_add_u32 m0, s88, 896
    s_nop 0
    buffer_load_dwordx4 v5, s[52:55], s71 offen offset:128 nt lds
    s_add_u32 m0, s88, 1792
    s_nop 0
    buffer_load_dwordx4 v5, s[52:55], s71 offen offset:256 nt lds
    s_add_u32 m0, s88, 33792
    s_nop 0
    buffer_load_dwordx4 v5, s[56:59], s71 offen offset:0 nt lds
    s_add_u32 m0, s88, 34688
    s_nop 0
    buffer_load_dwordx4 v5, s[56:59], s71 offen offset:128 nt lds
    s_add_u32 m0, s88, 35584
    s_nop 0
    buffer_load_dwordx4 v5, s[56:59], s71 offen offset:256 nt lds
LskIs_7:
    s_waitcnt vmcnt(45)
    s_waitcnt lgkmcnt(0)
    v_mov_b32 v76, 0
    v_mov_b32 v77, 0
    v_mov_b32 v78, 0
    v_mov_b32 v0, 0
    v_mov_b32 v1, 0
    v_mov_b32 v2, 0
    v_dot2c_f32_bf16 v76, v64, v40
    v_dot2c_f32_bf16 v77, v68, v44
    v_dot2c_f32_bf16 v78, v72, v48
    v_dot2c_f32_bf16 v0, v124, v12
    v_dot2c_f32_bf16 v1, v128, v16
    v_dot2c_f32_bf16 v2, v132, v20
    v_dot2c_f32_bf16 v76, v65, v41
    v_dot2c_f32_bf16 v77, v69, v45
    v_dot2c_f32_bf16 v78, v73, v49
    v_dot2c_f32_bf16 v0, v125, v13
    v_dot2c_f32_bf16 v1, v129, v17
    v_dot2c_f32_bf16 v2, v133, v21
    v_dot2c_f32_bf16 v76, v66, v42
    v_dot2c_f32_bf16 v77, v70, v46
    v_dot2c_f32_bf16 v78, v74, v50
    v_dot2c_f32_bf16 v0, v126, v14
    v_dot2c_f32_bf16 v1, v130, v18
    v_dot2c_f32_bf16 v2, v134, v22
    v_dot2c_f32_bf16 v76, v67, v43
    v_dot2c_f32_bf16 v77, v71, v47
    v_dot2c_f32_bf16 v78, v75, v51
    v_dot2c_f32_bf16 v0, v127, v15
    v_dot2c_f32_bf16 v1, v131, v19
    v_dot2c_f32_bf16 v2, v135, v23
    ds_read_b128 v[64:67], v6 offset:6144
    ds_read_b128 v[68:71], v6 offset:7168
    ds_read_b128 v[72:75], v6 offset:8192
    v_add_f32 v76, v76, v77
    v_add_f32 v76, v76, v78
    s_nop 0
    v_add_f32 v0, v0, v1
    v_add_f32 v0, v0, v2
    v_add_f32_dpp v76, v76, v76 quad_perm:[1,0,3,2] row_mask:0xf bank_mask:0xf
    s_nop 0
    v_add_f32_dpp v0, v0, v0 quad_perm:[1,0,3,2] row_mask:0xf bank_mask:0xf
    s_nop 0
    v_add_f32_dpp v76, v76, v76 quad_perm:[2,3,0,1] row_mask:0xf bank_mask:0xf
    s_nop 0
    v_add_f32_dpp v0, v0, v0 quad_perm:[2,3,0,1] row_mask:0xf bank_mask:0xf
    s_nop 0
    v_add_f32_dpp v76, v76, v76 row_half_mirror row_mask:0xf bank_mask:0xf
    s_nop 0
    v_add_f32_dpp v0, v0, v0 row_half_mirror row_mask:0xf bank_mask:0xf
    s_nop 0
    v_mul_f32 v76, s60, v76
    v_mul_f32 v0, s60, v0
    v_add_f32 v79, v76, v38
    v_add_f32 v3, v0, v37
    v_max_f32 v80, v79, v3
    v_cmp_lt_f32 vcc, 0, v80
    s_cbranch_vccz Lpsk_9
    s_swappc_b64 s[62:63], s[98:99]
    s_swappc_b64 s[62:63], s[94:95]
Lpsk_9:
    v_exp_f32 v80, v79
    v_exp_f32 v4, v3
    v_add_f32 v7, v7, v80
    v_add_f32 v36, v36, v4
    v_cvt_pk_bf16_f32 v80, v80, v80
    v_cvt_pk_bf16_f32 v4, v4, v4
    v_and_b32 v82, v80, v8
    v_and_b32 v83, v80, v9
    v_and_b32 v84, v80, v10
    v_and_b32 v85, v80, v11
    v_and_b32 v0, v4, v8
    v_and_b32 v1, v4, v9
    v_and_b32 v2, v4, v10
    v_and_b32 v3, v4, v11
    s_waitcnt vmcnt(42)
    ds_read_b128 v[100:103], v6 offset:36864
    ds_read_b128 v[104:107], v6 offset:37888
    ds_read_b128 v[108:111], v6 offset:38912
    s_waitcnt lgkmcnt(0)
    v_mfma_f32_16x16x32_bf16 v[52:55], v[82:85], v[100:103], v[52:55]
    v_mfma_f32_16x16x32_bf16 v[56:59], v[82:85], v[104:107], v[56:59]
    v_mfma_f32_16x16x32_bf16 v[60:63], v[82:85], v[108:111], v[60:63]
    v_mfma_f32_16x16x32_bf16 v[24:27], v[0:3], a[12:15], v[24:27]
    v_mfma_f32_16x16x32_bf16 v[28:31], v[0:3], a[16:19], v[28:31]
    v_mfma_f32_16x16x32_bf16 v[32:35], v[0:3], a[20:23], v[32:35]
    s_cmp_gt_u32 s89, 9
    s_cbranch_scc1 LskIs_10
    s_cmp_eq_u32 s91, 1
    s_cbranch_scc1 Lthr_11
    s_waitcnt vmcnt(18)
Lthr_11:
    s_add_u32 s71, s76, 718848
    s_add_u32 m0, s88, 3072
    s_nop 0
    buffer_load_dwordx4 v5, s[52:55], s71 offen offset:0 nt lds
    s_add_u32 m0, s88, 3968
    s_nop 0
    buffer_load_dwordx4 v5, s[52:55], s71 offen offset:128 nt lds
    s_add_u32 m0, s88, 4864
    s_nop 0
    buffer_load_dwordx4 v5, s[52:55], s71 offen offset:256 nt lds
    s_add_u32 m0, s88, 36864
    s_nop 0
    buffer_load_dwordx4 v5, s[56:59], s71 offen offset:0 nt lds
    s_add_u32 m0, s88, 37760
    s_nop 0
    buffer_load_dwordx4 v5, s[56:59], s71 offen offset:128 nt lds
    s_add_u32 m0, s88, 38656
    s_nop 0
    buffer_load_dwordx4 v5, s[56:59], s71 offen offset:256 nt lds
LskIs_10:
    s_waitcnt vmcnt(45)
    s_waitcnt lgkmcnt(0)
    v_mov_b32 v76, 0
    v_mov_b32 v77, 0
    v_mov_b32 v78, 0
    v_mov_b32 v0, 0
    v_mov_b32 v1, 0
    v_mov_b32 v2, 0
    v_dot2c_f32_bf16 v76, v64, v40
    v_dot2c_f32_bf16 v77, v68, v44
    v_dot2c_f32_bf16 v78, v72, v48
    v_dot2c_f32_bf16 v0, v136, v12
    v_dot2c_f32_bf16 v1, v140, v16
    v_dot2c_f32_bf16 v2, v144, v20
    v_dot2c_f32_bf16 v76, v65, v41
    v_dot2c_f32_bf16 v77, v69, v45
    v_dot2c_f32_bf16 v78, v73, v49
    v_dot2c_f32_bf16 v0, v137, v13
    v_dot2c_f32_bf16 v1, v141, v17
    v_dot2c_f32_bf16 v2, v145, v21
    v_dot2c_f32_bf16 v76, v66, v42
    v_dot2c_f32_bf16 v77, v70, v46
    v_dot2c_f32_bf16 v78, v74, v50
    v_dot2c_f32_bf16 v0, v138, v14
    v_dot2c_f32_bf16 v1, v142, v18
    v_dot2c_f32_bf16 v2, v146, v22
    v_dot2c_f32_bf16 v76, v67, v43
    v_dot2c_f32_bf16 v77, v71, v47
    v_dot2c_f32_bf16 v78, v75, v51
    v_dot2c_f32_bf16 v0, v139, v15
    v_dot2c_f32_bf16 v1, v143, v19
    v_dot2c_f32_bf16 v2, v147, v23
    ds_read_b128 v[64:67], v6 offset:9216
    ds_read_b128 v[68:71], v6 offset:10240
    ds_read_b128 v[72:75], v6 offset:11264
    v_add_f32 v76, v76, v77
    v_add_f32 v76, v76, v78
    s_nop 0
    v_add_f32 v0, v0, v1
    v_add_f32 v0, v0, v2
    v_add_f32_dpp v76, v76, v76 quad_perm:[1,0,3,2] row_mask:0xf bank_mask:0xf
    s_nop 0
    v_add_f32_dpp v0, v0, v0 quad_perm:[1,0,3,2] row_mask:0xf bank_mask:0xf
    s_nop 0
    v_add_f32_dpp v76, v76, v76 quad_perm:[2,3,0,1] row_mask:0xf bank_mask:0xf
    s_nop 0
    v_add_f32_dpp v0, v0, v0 quad_perm:[2,3,0,1] row_mask:0xf bank_mask:0xf
    s_nop 0
    v_add_f32_dpp v76, v76, v76 row_half_mirror row_mask:0xf bank_mask:0xf
    s_nop 0
    v_add_f32_dpp v0, v0, v0 row_half_mirror row_mask:0xf bank_mask:0xf
    s_nop 0
    v_mul_f32 v76, s60, v76
    v_mul_f32 v0, s60, v0
    v_add_f32 v79, v76, v38
    v_add_f32 v3, v0, v37
    v_max_f32 v80, v79, v3
    v_cmp_lt_f32 vcc, 0, v80
    s_cbranch_vccz Lpsk_12
    s_swappc_b64 s[62:63], s[98:99]
    s_swappc_b64 s[62:63], s[94:95]
Lpsk_12:
    v_exp_f32 v80, v79
    v_exp_f32 v4, v3
    v_add_f32 v7, v7, v80
    v_add_f32 v36, v36, v4
    v_cvt_pk_bf16_f32 v80, v80, v80
    v_cvt_pk_bf16_f32 v4, v4, v4
    v_and_b32 v82, v80, v8
    v_and_b32 v83, v80, v9
    v_and_b32 v84, v80, v10
    v_and_b32 v85, v80, v11
    v_and_b32 v0, v4, v8
    v_and_b32 v1, v4, v9
    v_and_b32 v2, v4, v10
    v_and_b32 v3, v4, v11
    s_waitcnt vmcnt(42)
    v_mfma_f32_16x16x32_bf16 v[52:55], v[82:85], a[96:99], v[52:55]
    v_mfma_f32_16x16x32_bf16 v[56:59], v[82:85], a[100:103], v[56:59]
    v_mfma_f32_16x16x32_bf16 v[60:63], v[82:85], a[104:107], v[60:63]
    v_mfma_f32_16x16x32_bf16 v[24:27], v[0:3], a[24:27], v[24:27]
    v_mfma_f32_16x16x32_bf16 v[28:31], v[0:3], a[28:31], v[28:31]
    v_mfma_f32_16x16x32_bf16 v[32:35], v[0:3], a[32:35], v[32:35]
    s_cmp_gt_u32 s89, 10
    s_cbranch_scc1 LskIs_13
    s_cmp_eq_u32 s91, 1
    s_cbranch_scc1 Lthr_14
    s_waitcnt vmcnt(18)
Lthr_14:
    s_add_u32 s71, s76, 798720
    s_add_u32 m0, s88, 6144
    s_nop 0
    buffer_load_dwordx4 v5, s[52:55], s71 offen offset:0 nt lds
    s_add_u32 m0, s88, 7040
    s_nop 0
    buffer_load_dwordx4 v5, s[52:55], s71 offen offset:128 nt lds
    s_add_u32 m0, s88, 7936
    s_nop 0
    buffer_load_dwordx4 v5, s[52:55], s71 offen offset:256 nt lds
    buffer_load_dwordx4 a[96:99], v5, s[56:59], s71 offen offset:0 nt
    buffer_load_dwordx4 a[100:103], v5, s[56:59], s71 offen offset:128 nt
    buffer_load_dwordx4 a[104:107], v5, s[56:59], s71 offen offset:256 nt
LskIs_13:
    s_waitcnt vmcnt(45)
    s_waitcnt lgkmcnt(0)
    v_mov_b32 v76, 0
    v_mov_b32 v77, 0
    v_mov_b32 v78, 0
    v_mov_b32 v0, 0
    v_mov_b32 v1, 0
    v_mov_b32 v2, 0
    v_dot2c_f32_bf16 v76, v64, v40
    v_dot2c_f32_bf16 v77, v68, v44
    v_dot2c_f32_bf16 v78, v72, v48
    v_dot2c_f32_bf16 v0, v148, v12
    v_dot2c_f32_bf16 v1, v152, v16
    v_dot2c_f32_bf16 v2, v156, v20
    v_dot2c_f32_bf16 v76, v65, v41
    v_dot2c_f32_bf16 v77, v69, v45
    v_dot2c_f32_bf16 v78, v73, v49
    v_dot2c_f32_bf16 v0, v149, v13
    v_dot2c_f32_bf16 v1, v153, v17
    v_dot2c_f32_bf16 v2, v157, v21
    v_dot2c_f32_bf16 v76, v66, v42
    v_dot2c_f32_bf16 v77, v70, v46
    v_dot2c_f32_bf16 v78, v74, v50
    v_dot2c_f32_bf16 v0, v150, v14
    v_dot2c_f32_bf16 v1, v154, v18
    v_dot2c_f32_bf16 v2, v158, v22
    v_dot2c_f32_bf16 v76, v67, v43
    v_dot2c_f32_bf16 v77, v71, v47
    v_dot2c_f32_bf16 v78, v75, v51
    v_dot2c_f32_bf16 v0, v151, v15
    v_dot2c_f32_bf16 v1, v155, v19
    v_dot2c_f32_bf16 v2, v159, v23
    ds_read_b128 v[64:67], v6 offset:12288
    ds_read_b128 v[68:71], v6 offset:13312
    ds_read_b128 v[72:75], v6 offset:14336
    v_add_f32 v76, v76, v77
    v_add_f32 v76, v76, v78
    s_nop 0
    v_add_f32 v0, v0, v1
    v_add_f32 v0, v0, v2
    v_add_f32_dpp v76, v76, v76 quad_perm:[1,0,3,2] row_mask:0xf bank_mask:0xf
    s_nop 0
    v_add_f32_dpp v0, v0, v0 quad_perm:[1,0,3,2] row_mask:0xf bank_mask:0xf
    s_nop 0
    v_add_f32_dpp v76, v76, v76 quad_perm:[2,3,0,1] row_mask:0xf bank_mask:0xf
    s_nop 0
    v_add_f32_dpp v0, v0, v0 quad_perm:[2,3,0,1] row_mask:0xf bank_mask:0xf
    s_nop 0
    v_add_f32_dpp v76, v76, v76 row_half_mirror row_mask:0xf bank_mask:0xf
    s_nop 0
    v_add_f32_dpp v0, v0, v0 row_half_mirror row_mask:0xf bank_mask:0xf
    s_nop 0
    v_mul_f32 v76, s60, v76
    v_mul_f32 v0, s60, v0
    v_add_f32 v79, v76, v38
    v_add_f32 v3, v0, v37
    v_max_f32 v80, v79, v3
    v_cmp_lt_f32 vcc, 0, v80
    s_cbranch_vccz Lpsk_15
    s_swappc_b64 s[62:63], s[98:99]
    s_swappc_b64 s[62:63], s[94:95]
Lpsk_15:
    v_exp_f32 v80, v79
    v_exp_f32 v4, v3
    v_add_f32 v7, v7, v80
    v_add_f32 v36, v36, v4
    v_cvt_pk_bf16_f32 v80, v80, v80
    v_cvt_pk_bf16_f32 v4, v4, v4
    v_and_b32 v82, v80, v8
    v_and_b32 v83, v80, v9
    v_and_b32 v84, v80, v10
    v_and_b32 v85, v80, v11
    v_and_b32 v0, v4, v8
    v_and_b32 v1, v4, v9
    v_and_b32 v2, v4, v10
    v_and_b32 v3, v4, v11
    s_waitcnt vmcnt(42)
    v_mfma_f32_16x16x32_bf16 v[52:55], v[82:85], a[108:111], v[52:55]
    v_mfma_f32_16x16x32_bf16 v[56:59], v[82:85], a[112:115], v[56:59]
    v_mfma_f32_16x16x32_bf16 v[60:63], v[82:85], a[116:119], v[60:63]
    v_mfma_f32_16x16x32_bf16 v[24:27], v[0:3], a[36:39], v[24:27]
    v_mfma_f32_16x16x32_bf16 v[28:31], v[0:3], a[40:43], v[28:31]
    v_mfma_f32_16x16x32_bf16 v[32:35], v[0:3], a[44:47], v[32:35]
    s_cmp_gt_u32 s89, 11
    s_cbranch_scc1 LskIs_16
    s_cmp_eq_u32 s91, 1
    s_cbranch_scc1 Lthr_17
    s_waitcnt vmcnt(18)
Lthr_17:
    s_add_u32 s71, s76, 878592
    s_add_u32 m0, s88, 9216
    s_nop 0
    buffer_load_dwordx4 v5, s[52:55], s71 offen offset:0 nt lds
    s_add_u32 m0, s88, 10112
    s_nop 0
    buffer_load_dwordx4 v5, s[52:55], s71 offen offset:128 nt lds
    s_add_u32 m0, s88, 11008
    s_nop 0
    buffer_load_dwordx4 v5, s[52:55], s71 offen offset:256 nt lds
    buffer_load_dwordx4 a[108:111], v5, s[56:59], s71 offen offset:0 nt
    buffer_load_dwordx4 a[112:115], v5, s[56:59], s71 offen offset:128 nt
    buffer_load_dwordx4 a[116:119], v5, s[56:59], s71 offen offset:256 nt
LskIs_16:
    s_waitcnt vmcnt(45)
    s_waitcnt lgkmcnt(0)
    v_mov_b32 v76, 0
    v_mov_b32 v77, 0
    v_mov_b32 v78, 0
    v_mov_b32 v0, 0
    v_mov_b32 v1, 0
    v_mov_b32 v2, 0
    v_dot2c_f32_bf16 v76, v64, v40
    v_dot2c_f32_bf16 v77, v68, v44
    v_dot2c_f32_bf16 v78, v72, v48
    v_dot2c_f32_bf16 v0, v160, v12
    v_dot2c_f32_bf16 v1, v164, v16
    v_dot2c_f32_bf16 v2, v168, v20
    v_dot2c_f32_bf16 v76, v65, v41
    v_dot2c_f32_bf16 v77, v69, v45
    v_dot2c_f32_bf16 v78, v73, v49
    v_dot2c_f32_bf16 v0, v161, v13
    v_dot2c_f32_bf16 v1, v165, v17
    v_dot2c_f32_bf16 v2, v169, v21
    v_dot2c_f32_bf16 v76, v66, v42
    v_dot2c_f32_bf16 v77, v70, v46
    v_dot2c_f32_bf16 v78, v74, v50
    v_dot2c_f32_bf16 v0, v162, v14
    v_dot2c_f32_bf16 v1, v166, v18
    v_dot2c_f32_bf16 v2, v170, v22
    v_dot2c_f32_bf16 v76, v67, v43
    v_dot2c_f32_bf16 v77, v71, v47
    v_dot2c_f32_bf16 v78, v75, v51
    v_dot2c_f32_bf16 v0, v163, v15
    v_dot2c_f32_bf16 v1, v167, v19
    v_dot2c_f32_bf16 v2, v171, v23
    ds_read_b128 v[64:67], v6 offset:15360
    ds_read_b128 v[68:71], v6 offset:16384
    ds_read_b128 v[72:75], v6 offset:17408
    v_add_f32 v76, v76, v77
    v_add_f32 v76, v76, v78
    s_nop 0
    v_add_f32 v0, v0, v1
    v_add_f32 v0, v0, v2
    v_add_f32_dpp v76, v76, v76 quad_perm:[1,0,3,2] row_mask:0xf bank_mask:0xf
    s_nop 0
    v_add_f32_dpp v0, v0, v0 quad_perm:[1,0,3,2] row_mask:0xf bank_mask:0xf
    s_nop 0
    v_add_f32_dpp v76, v76, v76 quad_perm:[2,3,0,1] row_mask:0xf bank_mask:0xf
    s_nop 0
    v_add_f32_dpp v0, v0, v0 quad_perm:[2,3,0,1] row_mask:0xf bank_mask:0xf
    s_nop 0
    v_add_f32_dpp v76, v76, v76 row_half_mirror row_mask:0xf bank_mask:0xf
    s_nop 0
    v_add_f32_dpp v0, v0, v0 row_half_mirror row_mask:0xf bank_mask:0xf
    s_nop 0
    v_mul_f32 v76, s60, v76
    v_mul_f32 v0, s60, v0
    v_add_f32 v79, v76, v38
    v_add_f32 v3, v0, v37
    v_max_f32 v80, v79, v3
    v_cmp_lt_f32 vcc, 0, v80
    s_cbranch_vccz Lpsk_18
    s_swappc_b64 s[62:63], s[98:99]
    s_swappc_b64 s[62:63], s[94:95]
Lpsk_18:
    v_exp_f32 v80, v79
    v_exp_f32 v4, v3
    v_add_f32 v7, v7, v80
    v_add_f32 v36, v36, v4
    v_cvt_pk_bf16_f32 v80, v80, v80
    v_cvt_pk_bf16_f32 v4, v4, v4
    v_and_b32 v82, v80, v8
    v_and_b32 v83, v80, v9
    v_and_b32 v84, v80, v10
    v_and_b32 v85, v80, v11
    v_and_b32 v0, v4, v8
    v_and_b32 v1, v4, v9
    v_and_b32 v2, v4, v10
    v_and_b32 v3, v4, v11
    s_waitcnt vmcnt(42)
    v_mfma_f32_16x16x32_bf16 v[52:55], v[82:85], a[120:123], v[52:55]
    v_mfma_f32_16x16x32_bf16 v[56:59], v[82:85], a[124:127], v[56:59]
    v_mfma_f32_16x16x32_bf16 v[60:63], v[82:85], a[128:131], v[60:63]
    v_mfma_f32_16x16x32_bf16 v[24:27], v[0:3], a[48:51], v[24:27]
    v_mfma_f32_16x16x32_bf16 v[28:31], v[0:3], a[52:55], v[28:31]
    v_mfma_f32_16x16x32_bf16 v[32:35], v[0:3], a[56:59], v[32:35]
    s_cmp_gt_u32 s89, 12
    s_cbranch_scc1 LskIs_19
    s_cmp_eq_u32 s91, 1
    s_cbranch_scc1 Lthr_20
    s_waitcnt vmcnt(18)
Lthr_20:
    s_add_u32 s71, s76, 958464
    s_add_u32 m0, s88, 12288
    s_nop 0
    buffer_load_dwordx4 v5, s[52:55], s71 offen offset:0 nt lds
    s_add_u32 m0, s88, 13184
    s_nop 0
    buffer_load_dwordx4 v5, s[52:55], s71 offen offset:128 nt lds
    s_add_u32 m0, s88, 14080
    s_nop 0
    buffer_load_dwordx4 v5, s[52:55], s71 offen offset:256 nt lds
    buffer_load_dwordx4 a[120:123], v5, s[56:59], s71 offen offset:0 nt
    buffer_load_dwordx4 a[124:127], v5, s[56:59], s71 offen offset:128 nt
    buffer_load_dwordx4 a[128:131], v5, s[56:59], s71 offen offset:256 nt
LskIs_19:
    s_waitcnt vmcnt(45)
    s_waitcnt lgkmcnt(0)
    v_mov_b32 v76, 0
    v_mov_b32 v77, 0
    v_mov_b32 v78, 0
    v_mov_b32 v0, 0
    v_mov_b32 v1, 0
    v_mov_b32 v2, 0
    v_dot2c_f32_bf16 v76, v64, v40
    v_dot2c_f32_bf16 v77, v68, v44
    v_dot2c_f32_bf16 v78, v72, v48
    v_dot2c_f32_bf16 v0, v172, v12
    v_dot2c_f32_bf16 v1, v176, v16
    v_dot2c_f32_bf16 v2, v180, v20
    v_dot2c_f32_bf16 v76, v65, v41
    v_dot2c_f32_bf16 v77, v69, v45
    v_dot2c_f32_bf16 v78, v73, v49
    v_dot2c_f32_bf16 v0, v173, v13
    v_dot2c_f32_bf16 v1, v177, v17
    v_dot2c_f32_bf16 v2, v181, v21
    v_dot2c_f32_bf16 v76, v66, v42
    v_dot2c_f32_bf16 v77, v70, v46
    v_dot2c_f32_bf16 v78, v74, v50
    v_dot2c_f32_bf16 v0, v174, v14
    v_dot2c_f32_bf16 v1, v178, v18
    v_dot2c_f32_bf16 v2, v182, v22
    v_dot2c_f32_bf16 v76, v67, v43
    v_dot2c_f32_bf16 v77, v71, v47
    v_dot2c_f32_bf16 v78, v75, v51
    v_dot2c_f32_bf16 v0, v175, v15
    v_dot2c_f32_bf16 v1, v179, v19
    v_dot2c_f32_bf16 v2, v183, v23
    ds_read_b128 v[64:67], v6 offset:18432
    ds_read_b128 v[68:71], v6 offset:19456
    ds_read_b128 v[72:75], v6 offset:20480
    v_add_f32 v76, v76, v77
    v_add_f32 v76, v76, v78
    s_nop 0
    v_add_f32 v0, v0, v1
    v_add_f32 v0, v0, v2
    v_add_f32_dpp v76, v76, v76 quad_perm:[1,0,3,2] row_mask:0xf bank_mask:0xf
    s_nop 0
    v_add_f32_dpp v0, v0, v0 quad_perm:[1,0,3,2] row_mask:0xf bank_mask:0xf
    s_nop 0
    v_add_f32_dpp v76, v76, v76 quad_perm:[2,3,0,1] row_mask:0xf bank_mask:0xf
    s_nop 0
    v_add_f32_dpp v0, v0, v0 quad_perm:[2,3,0,1] row_mask:0xf bank_mask:0xf
    s_nop 0
    v_add_f32_dpp v76, v76, v76 row_half_mirror row_mask:0xf bank_mask:0xf
    s_nop 0
    v_add_f32_dpp v0, v0, v0 row_half_mirror row_mask:0xf bank_mask:0xf
    s_nop 0
    v_mul_f32 v76, s60, v76
    v_mul_f32 v0, s60, v0
    v_add_f32 v79, v76, v38
    v_add_f32 v3, v0, v37
    v_max_f32 v80, v79, v3
    v_cmp_lt_f32 vcc, 0, v80
    s_cbranch_vccz Lpsk_21
    s_swappc_b64 s[62:63], s[98:99]
    s_swappc_b64 s[62:63], s[94:95]
Lpsk_21:
    v_exp_f32 v80, v79
    v_exp_f32 v4, v3
    v_add_f32 v7, v7, v80
    v_add_f32 v36, v36, v4
    v_cvt_pk_bf16_f32 v80, v80, v80
    v_cvt_pk_bf16_f32 v4, v4, v4
    v_and_b32 v82, v80, v8
    v_and_b32 v83, v80, v9
    v_and_b32 v84, v80, v10
    v_and_b32 v85, v80, v11
    v_and_b32 v0, v4, v8
    v_and_b32 v1, v4, v9
    v_and_b32 v2, v4, v10
    v_and_b32 v3, v4, v11
    s_waitcnt vmcnt(42)
    v_mfma_f32_16x16x32_bf16 v[52:55], v[82:85], a[132:135], v[52:55]
    v_mfma_f32_16x16x32_bf16 v[56:59], v[82:85], a[136:139], v[56:59]
    v_mfma_f32_16x16x32_bf16 v[60:63], v[82:85], a[140:143], v[60:63]
    v_mfma_f32_16x16x32_bf16 v[24:27], v[0:3], a[60:63], v[24:27]
    v_mfma_f32_16x16x32_bf16 v[28:31], v[0:3], a[64:67], v[28:31]
    v_mfma_f32_16x16x32_bf16 v[32:35], v[0:3], a[68:71], v[32:35]
    s_cmp_gt_u32 s89, 13
    s_cbranch_scc1 LskIs_22
    s_cmp_eq_u32 s91, 1
    s_cbranch_scc1 Lthr_23
    s_waitcnt vmcnt(18)
Lthr_23:
    s_add_u32 s71, s76, 1038336
    s_add_u32 m0, s88, 15360
    s_nop 0
    buffer_load_dwordx4 v5, s[52:55], s71 offen offset:0 nt lds
    s_add_u32 m0, s88, 16256
    s_nop 0
    buffer_load_dwordx4 v5, s[52:55], s71 offen offset:128 nt lds
    s_add_u32 m0, s88, 17152
    s_nop 0
    buffer_load_dwordx4 v5, s[52:55], s71 offen offset:256 nt lds
    buffer_load_dwordx4 a[132:135], v5, s[56:59], s71 offen offset:0 nt
    buffer_load_dwordx4 a[136:139], v5, s[56:59], s71 offen offset:128 nt
    buffer_load_dwordx4 a[140:143], v5, s[56:59], s71 offen offset:256 nt
LskIs_22:
    s_waitcnt vmcnt(45)
    s_waitcnt lgkmcnt(0)
    v_mov_b32 v76, 0
    v_mov_b32 v77, 0
    v_mov_b32 v78, 0
    v_mov_b32 v0, 0
    v_mov_b32 v1, 0
    v_mov_b32 v2, 0
    v_dot2c_f32_bf16 v76, v64, v40
    v_dot2c_f32_bf16 v77, v68, v44
    v_dot2c_f32_bf16 v78, v72, v48
    v_dot2c_f32_bf16 v0, v184, v12
    v_dot2c_f32_bf16 v1, v188, v16
    v_dot2c_f32_bf16 v2, v192, v20
    v_dot2c_f32_bf16 v76, v65, v41
    v_dot2c_f32_bf16 v77, v69, v45
    v_dot2c_f32_bf16 v78, v73, v49
    v_dot2c_f32_bf16 v0, v185, v13
    v_dot2c_f32_bf16 v1, v189, v17
    v_dot2c_f32_bf16 v2, v193, v21
    v_dot2c_f32_bf16 v76, v66, v42
    v_dot2c_f32_bf16 v77, v70, v46
    v_dot2c_f32_bf16 v78, v74, v50
    v_dot2c_f32_bf16 v0, v186, v14
    v_dot2c_f32_bf16 v1, v190, v18
    v_dot2c_f32_bf16 v2, v194, v22
    v_dot2c_f32_bf16 v76, v67, v43
    v_dot2c_f32_bf16 v77, v71, v47
    v_dot2c_f32_bf16 v78, v75, v51
    v_dot2c_f32_bf16 v0, v187, v15
    v_dot2c_f32_bf16 v1, v191, v19
    v_dot2c_f32_bf16 v2, v195, v23
    ds_read_b128 v[64:67], v6 offset:21504
    ds_read_b128 v[68:71], v6 offset:22528
    ds_read_b128 v[72:75], v6 offset:23552
    v_add_f32 v76, v76, v77
    v_add_f32 v76, v76, v78
    s_nop 0
    v_add_f32 v0, v0, v1
    v_add_f32 v0, v0, v2
    v_add_f32_dpp v76, v76, v76 quad_perm:[1,0,3,2] row_mask:0xf bank_mask:0xf
    s_nop 0
    v_add_f32_dpp v0, v0, v0 quad_perm:[1,0,3,2] row_mask:0xf bank_mask:0xf
    s_nop 0
    v_add_f32_dpp v76, v76, v76 quad_perm:[2,3,0,1] row_mask:0xf bank_mask:0xf
    s_nop 0
    v_add_f32_dpp v0, v0, v0 quad_perm:[2,3,0,1] row_mask:0xf bank_mask:0xf
    s_nop 0
    v_add_f32_dpp v76, v76, v76 row_half_mirror row_mask:0xf bank_mask:0xf
    s_nop 0
    v_add_f32_dpp v0, v0, v0 row_half_mirror row_mask:0xf bank_mask:0xf
    s_nop 0
    v_mul_f32 v76, s60, v76
    v_mul_f32 v0, s60, v0
    v_add_f32 v79, v76, v38
    v_add_f32 v3, v0, v37
    v_max_f32 v80, v79, v3
    v_cmp_lt_f32 vcc, 0, v80
    s_cbranch_vccz Lpsk_24
    s_swappc_b64 s[62:63], s[98:99]
    s_swappc_b64 s[62:63], s[94:95]
Lpsk_24:
    v_exp_f32 v80, v79
    v_exp_f32 v4, v3
    v_add_f32 v7, v7, v80
    v_add_f32 v36, v36, v4
    v_cvt_pk_bf16_f32 v80, v80, v80
    v_cvt_pk_bf16_f32 v4, v4, v4
    v_and_b32 v82, v80, v8
    v_and_b32 v83, v80, v9
    v_and_b32 v84, v80, v10
    v_and_b32 v85, v80, v11
    v_and_b32 v0, v4, v8
    v_and_b32 v1, v4, v9
    v_and_b32 v2, v4, v10
    v_and_b32 v3, v4, v11
    s_waitcnt vmcnt(42)
    v_mfma_f32_16x16x32_bf16 v[52:55], v[82:85], a[144:147], v[52:55]
    v_mfma_f32_16x16x32_bf16 v[56:59], v[82:85], a[148:151], v[56:59]
    v_mfma_f32_16x16x32_bf16 v[60:63], v[82:85], a[152:155], v[60:63]
    v_mfma_f32_16x16x32_bf16 v[24:27], v[0:3], a[72:75], v[24:27]
    v_mfma_f32_16x16x32_bf16 v[28:31], v[0:3], a[76:79], v[28:31]
    v_mfma_f32_16x16x32_bf16 v[32:35], v[0:3], a[80:83], v[32:35]
    s_cmp_gt_u32 s89, 14
    s_cbranch_scc1 LskIs_25
    s_cmp_eq_u32 s91, 1
    s_cbranch_scc1 Lthr_26
    s_waitcnt vmcnt(18)
Lthr_26:
    s_add_u32 s71, s76, 1118208
    s_add_u32 m0, s88, 18432
    s_nop 0
    buffer_load_dwordx4 v5, s[52:55], s71 offen offset:0 nt lds
    s_add_u32 m0, s88, 19328
    s_nop 0
    buffer_load_dwordx4 v5, s[52:55], s71 offen offset:128 nt lds
    s_add_u32 m0, s88, 20224
    s_nop 0
    buffer_load_dwordx4 v5, s[52:55], s71 offen offset:256 nt lds
    buffer_load_dwordx4 a[144:147], v5, s[56:59], s71 offen offset:0 nt
    buffer_load_dwordx4 a[148:151], v5, s[56:59], s71 offen offset:128 nt
    buffer_load_dwordx4 a[152:155], v5, s[56:59], s71 offen offset:256 nt
LskIs_25:
    s_waitcnt vmcnt(45)
    s_waitcnt lgkmcnt(0)
    v_mov_b32 v76, 0
    v_mov_b32 v77, 0
    v_mov_b32 v78, 0
    v_mov_b32 v0, 0
    v_mov_b32 v1, 0
    v_mov_b32 v2, 0
    v_dot2c_f32_bf16 v76, v64, v40
    v_dot2c_f32_bf16 v77, v68, v44
    v_dot2c_f32_bf16 v78, v72, v48
    v_dot2c_f32_bf16 v0, v196, v12
    v_dot2c_f32_bf16 v1, v200, v16
    v_dot2c_f32_bf16 v2, v204, v20
    v_dot2c_f32_bf16 v76, v65, v41
    v_dot2c_f32_bf16 v77, v69, v45
    v_dot2c_f32_bf16 v78, v73, v49
    v_dot2c_f32_bf16 v0, v197, v13
    v_dot2c_f32_bf16 v1, v201, v17
    v_dot2c_f32_bf16 v2, v205, v21
    v_dot2c_f32_bf16 v76, v66, v42
    v_dot2c_f32_bf16 v77, v70, v46
    v_dot2c_f32_bf16 v78, v74, v50
    v_dot2c_f32_bf16 v0, v198, v14
    v_dot2c_f32_bf16 v1, v202, v18
    v_dot2c_f32_bf16 v2, v206, v22
    v_dot2c_f32_bf16 v76, v67, v43
    v_dot2c_f32_bf16 v77, v71, v47
    v_dot2c_f32_bf16 v78, v75, v51
    v_dot2c_f32_bf16 v0, v199, v15
    v_dot2c_f32_bf16 v1, v203, v19
    v_dot2c_f32_bf16 v2, v207, v23
    ds_read_b128 v[64:67], v6 offset:24576
    ds_read_b128 v[68:71], v6 offset:25600
    ds_read_b128 v[72:75], v6 offset:26624
    s_waitcnt vmcnt(39)
    ds_read_b128 v[88:91], v6 offset:0
    ds_read_b128 v[92:95], v6 offset:1024
    ds_read_b128 v[96:99], v6 offset:2048
    v_add_f32 v76, v76, v77
    v_add_f32 v76, v76, v78
    s_nop 0
    v_add_f32 v0, v0, v1
    v_add_f32 v0, v0, v2
    v_add_f32_dpp v76, v76, v76 quad_perm:[1,0,3,2] row_mask:0xf bank_mask:0xf
    s_nop 0
    v_add_f32_dpp v0, v0, v0 quad_perm:[1,0,3,2] row_mask:0xf bank_mask:0xf
    s_nop 0
    v_add_f32_dpp v76, v76, v76 quad_perm:[2,3,0,1] row_mask:0xf bank_mask:0xf
    s_nop 0
    v_add_f32_dpp v0, v0, v0 quad_perm:[2,3,0,1] row_mask:0xf bank_mask:0xf
    s_nop 0
    v_add_f32_dpp v76, v76, v76 row_half_mirror row_mask:0xf bank_mask:0xf
    s_nop 0
    v_add_f32_dpp v0, v0, v0 row_half_mirror row_mask:0xf bank_mask:0xf
    s_nop 0
    v_mul_f32 v76, s60, v76
    v_mul_f32 v0, s60, v0
    v_add_f32 v79, v76, v38
    v_add_f32 v3, v0, v37
    v_max_f32 v80, v79, v3
    v_cmp_lt_f32 vcc, 0, v80
    s_cbranch_vccz Lpsk_27
    s_swappc_b64 s[62:63], s[98:99]
    s_swappc_b64 s[62:63], s[94:95]
Lpsk_27:
    v_exp_f32 v80, v79
    v_exp_f32 v4, v3
    v_add_f32 v7, v7, v80
    v_add_f32 v36, v36, v4
    v_cvt_pk_bf16_f32 v80, v80, v80
    v_cvt_pk_bf16_f32 v4, v4, v4
    v_and_b32 v82, v80, v8
    v_and_b32 v83, v80, v9
    v_and_b32 v84, v80, v10
    v_and_b32 v85, v80, v11
    v_and_b32 v0, v4, v8
    v_and_b32 v1, v4, v9
    v_and_b32 v2, v4, v10
    v_and_b32 v3, v4, v11
    s_waitcnt vmcnt(42)
    v_mfma_f32_16x16x32_bf16 v[52:55], v[82:85], a[156:159], v[52:55]
    v_mfma_f32_16x16x32_bf16 v[56:59], v[82:85], a[160:163], v[56:59]
    v_mfma_f32_16x16x32_bf16 v[60:63], v[82:85], a[164:167], v[60:63]
    v_mfma_f32_16x16x32_bf16 v[24:27], v[0:3], a[84:87], v[24:27]
    v_mfma_f32_16x16x32_bf16 v[28:31], v[0:3], a[88:91], v[28:31]
    v_mfma_f32_16x16x32_bf16 v[32:35], v[0:3], a[92:95], v[32:35]
    s_cmp_gt_u32 s89, 15
    s_cbranch_scc1 LskIs_28
    s_cmp_eq_u32 s91, 1
    s_cbranch_scc1 Lthr_29
    s_waitcnt vmcnt(18)
Lthr_29:
    s_add_u32 s71, s76, 1198080
    s_add_u32 m0, s88, 21504
    s_nop 0
    buffer_load_dwordx4 v5, s[52:55], s71 offen offset:0 nt lds
    s_add_u32 m0, s88, 22400
    s_nop 0
    buffer_load_dwordx4 v5, s[52:55], s71 offen offset:128 nt lds
    s_add_u32 m0, s88, 23296
    s_nop 0
    buffer_load_dwordx4 v5, s[52:55], s71 offen offset:256 nt lds
    buffer_load_dwordx4 a[156:159], v5, s[56:59], s71 offen offset:0 nt
    buffer_load_dwordx4 a[160:163], v5, s[56:59], s71 offen offset:128 nt
    buffer_load_dwordx4 a[164:167], v5, s[56:59], s71 offen offset:256 nt
LskIs_28:
    s_waitcnt lgkmcnt(0)
    v_mov_b32 v76, 0
    v_mov_b32 v77, 0
    v_mov_b32 v78, 0
    v_mov_b32 v0, 0
    v_mov_b32 v1, 0
    v_mov_b32 v2, 0
    v_dot2c_f32_bf16 v76, v64, v40
    v_dot2c_f32_bf16 v77, v68, v44
    v_dot2c_f32_bf16 v78, v72, v48
    v_dot2c_f32_bf16 v0, v88, v12
    v_dot2c_f32_bf16 v1, v92, v16
    v_dot2c_f32_bf16 v2, v96, v20
    v_dot2c_f32_bf16 v76, v65, v41
    v_dot2c_f32_bf16 v77, v69, v45
    v_dot2c_f32_bf16 v78, v73, v49
    v_dot2c_f32_bf16 v0, v89, v13
    v_dot2c_f32_bf16 v1, v93, v17
    v_dot2c_f32_bf16 v2, v97, v21
    v_dot2c_f32_bf16 v76, v66, v42
    v_dot2c_f32_bf16 v77, v70, v46
    v_dot2c_f32_bf16 v78, v74, v50
    v_dot2c_f32_bf16 v0, v90, v14
    v_dot2c_f32_bf16 v1, v94, v18
    v_dot2c_f32_bf16 v2, v98, v22
    v_dot2c_f32_bf16 v76, v67, v43
    v_dot2c_f32_bf16 v77, v71, v47
    v_dot2c_f32_bf16 v78, v75, v51
    v_dot2c_f32_bf16 v0, v91, v15
    v_dot2c_f32_bf16 v1, v95, v19
    v_dot2c_f32_bf16 v2, v99, v23
    ds_read_b128 v[64:67], v6 offset:27648
    ds_read_b128 v[68:71], v6 offset:28672
    ds_read_b128 v[72:75], v6 offset:29696
    s_waitcnt vmcnt(39)
    ds_read_b128 v[88:91], v6 offset:3072
    ds_read_b128 v[92:95], v6 offset:4096
    ds_read_b128 v[96:99], v6 offset:5120
    v_add_f32 v76, v76, v77
    v_add_f32 v76, v76, v78
    s_nop 0
    v_add_f32 v0, v0, v1
    v_add_f32 v0, v0, v2
    v_add_f32_dpp v76, v76, v76 quad_perm:[1,0,3,2] row_mask:0xf bank_mask:0xf
    s_nop 0
    v_add_f32_dpp v0, v0, v0 quad_perm:[1,0,3,2] row_mask:0xf bank_mask:0xf
    s_nop 0
    v_add_f32_dpp v76, v76, v76 quad_perm:[2,3,0,1] row_mask:0xf bank_mask:0xf
    s_nop 0
    v_add_f32_dpp v0, v0, v0 quad_perm:[2,3,0,1] row_mask:0xf bank_mask:0xf
    s_nop 0
    v_add_f32_dpp v76, v76, v76 row_half_mirror row_mask:0xf bank_mask:0xf
    s_nop 0
    v_add_f32_dpp v0, v0, v0 row_half_mirror row_mask:0xf bank_mask:0xf
    s_nop 0
    v_mul_f32 v76, s60, v76
    v_mul_f32 v0, s60, v0
    v_add_f32 v79, v76, v38
    v_add_f32 v3, v0, v37
    v_max_f32 v80, v79, v3
    v_cmp_lt_f32 vcc, 0, v80
    s_cbranch_vccz Lpsk_30
    s_swappc_b64 s[62:63], s[98:99]
    s_swappc_b64 s[62:63], s[94:95]
Lpsk_30:
    v_exp_f32 v80, v79
    v_exp_f32 v4, v3
    v_add_f32 v7, v7, v80
    v_add_f32 v36, v36, v4
    v_cvt_pk_bf16_f32 v80, v80, v80
    v_cvt_pk_bf16_f32 v4, v4, v4
    v_and_b32 v82, v80, v8
    v_and_b32 v83, v80, v9
    v_and_b32 v84, v80, v10
    v_and_b32 v85, v80, v11
    v_and_b32 v0, v4, v8
    v_and_b32 v1, v4, v9
    v_and_b32 v2, v4, v10
    v_and_b32 v3, v4, v11
    s_waitcnt vmcnt(42)
    ds_read_b128 v[100:103], v6 offset:33792
    ds_read_b128 v[104:107], v6 offset:34816
    ds_read_b128 v[108:111], v6 offset:35840
    s_waitcnt lgkmcnt(0)
    v_mfma_f32_16x16x32_bf16 v[52:55], v[82:85], a[168:171], v[52:55]
    v_mfma_f32_16x16x32_bf16 v[56:59], v[82:85], a[172:175], v[56:59]
    v_mfma_f32_16x16x32_bf16 v[60:63], v[82:85], a[176:179], v[60:63]
    v_mfma_f32_16x16x32_bf16 v[24:27], v[0:3], v[100:103], v[24:27]
    v_mfma_f32_16x16x32_bf16 v[28:31], v[0:3], v[104:107], v[28:31]
    v_mfma_f32_16x16x32_bf16 v[32:35], v[0:3], v[108:111], v[32:35]
    s_cmp_gt_u32 s89, 16
    s_cbranch_scc1 LskIs_31
    s_cmp_eq_u32 s91, 1
    s_cbranch_scc1 Lthr_32
    s_waitcnt vmcnt(18)
Lthr_32:
    s_add_u32 s71, s76, 1277952
    s_lshr_b32 s43, s67, 1
    s_max_u32 s71, s71, s43
    s_add_u32 m0, s88, 24576
    s_nop 0
    buffer_load_dwordx4 v5, s[52:55], s71 offen offset:0 nt lds
    s_add_u32 m0, s88, 25472
    s_nop 0
    buffer_load_dwordx4 v5, s[52:55], s71 offen offset:128 nt lds
    s_add_u32 m0, s88, 26368
    s_nop 0
    buffer_load_dwordx4 v5, s[52:55], s71 offen offset:256 nt lds
    buffer_load_dwordx4 a[168:171], v5, s[56:59], s71 offen offset:0 nt
    buffer_load_dwordx4 a[172:175], v5, s[56:59], s71 offen offset:128 nt
    buffer_load_dwordx4 a[176:179], v5, s[56:59], s71 offen offset:256 nt
LskIs_31:
    s_waitcnt lgkmcnt(0)
    v_mov_b32 v76, 0
    v_mov_b32 v77, 0
    v_mov_b32 v78, 0
    v_mov_b32 v0, 0
    v_mov_b32 v1, 0
    v_mov_b32 v2, 0
    v_dot2c_f32_bf16 v76, v64, v40
    v_dot2c_f32_bf16 v77, v68, v44
    v_dot2c_f32_bf16 v78, v72, v48
    v_dot2c_f32_bf16 v0, v88, v12
    v_dot2c_f32_bf16 v1, v92, v16
    v_dot2c_f32_bf16 v2, v96, v20
    v_dot2c_f32_bf16 v76, v65, v41
    v_dot2c_f32_bf16 v77, v69, v45
    v_dot2c_f32_bf16 v78, v73, v49
    v_dot2c_f32_bf16 v0, v89, v13
    v_dot2c_f32_bf16 v1, v93, v17
    v_dot2c_f32_bf16 v2, v97, v21
    v_dot2c_f32_bf16 v76, v66, v42
    v_dot2c_f32_bf16 v77, v70, v46
    v_dot2c_f32_bf16 v78, v74, v50
    v_dot2c_f32_bf16 v0, v90, v14
    v_dot2c_f32_bf16 v1, v94, v18
    v_dot2c_f32_bf16 v2, v98, v22
    v_dot2c_f32_bf16 v76, v67, v43
    v_dot2c_f32_bf16 v77, v71, v47
    v_dot2c_f32_bf16 v78, v75, v51
    v_dot2c_f32_bf16 v0, v91, v15
    v_dot2c_f32_bf16 v1, v95, v19
    v_dot2c_f32_bf16 v2, v99, v23
    ds_read_b128 v[64:67], v6 offset:30720
    ds_read_b128 v[68:71], v6 offset:31744
    ds_read_b128 v[72:75], v6 offset:32768
    s_waitcnt vmcnt(39)
    ds_read_b128 v[88:91], v6 offset:6144
    ds_read_b128 v[92:95], v6 offset:7168
    ds_read_b128 v[96:99], v6 offset:8192
    v_add_f32 v76, v76, v77
    v_add_f32 v76, v76, v78
    s_nop 0
    v_add_f32 v0, v0, v1
    v_add_f32 v0, v0, v2
    v_add_f32_dpp v76, v76, v76 quad_perm:[1,0,3,2] row_mask:0xf bank_mask:0xf
    s_nop 0
    v_add_f32_dpp v0, v0, v0 quad_perm:[1,0,3,2] row_mask:0xf bank_mask:0xf
    s_nop 0
    v_add_f32_dpp v76, v76, v76 quad_perm:[2,3,0,1] row_mask:0xf bank_mask:0xf
    s_nop 0
    v_add_f32_dpp v0, v0, v0 quad_perm:[2,3,0,1] row_mask:0xf bank_mask:0xf
    s_nop 0
    v_add_f32_dpp v76, v76, v76 row_half_mirror row_mask:0xf bank_mask:0xf
    s_nop 0
    v_add_f32_dpp v0, v0, v0 row_half_mirror row_mask:0xf bank_mask:0xf
    s_nop 0
    v_mul_f32 v76, s60, v76
    v_mul_f32 v0, s60, v0
    v_add_f32 v79, v76, v38
    v_add_f32 v3, v0, v37
    v_max_f32 v80, v79, v3
    v_cmp_lt_f32 vcc, 0, v80
    s_cbranch_vccz Lpsk_33
    s_swappc_b64 s[62:63], s[98:99]
    s_swappc_b64 s[62:63], s[94:95]
Lpsk_33:
    v_exp_f32 v80, v79
    v_exp_f32 v4, v3
    v_add_f32 v7, v7, v80
    v_add_f32 v36, v36, v4
    v_cvt_pk_bf16_f32 v80, v80, v80
    v_cvt_pk_bf16_f32 v4, v4, v4
    v_and_b32 v82, v80, v8
    v_and_b32 v83, v80, v9
    v_and_b32 v84, v80, v10
    v_and_b32 v85, v80, v11
    v_and_b32 v0, v4, v8
    v_and_b32 v1, v4, v9
    v_and_b32 v2, v4, v10
    v_and_b32 v3, v4, v11
    s_waitcnt vmcnt(42)
    ds_read_b128 v[100:103], v6 offset:36864
    ds_read_b128 v[104:107], v6 offset:37888
    ds_read_b128 v[108:111], v6 offset:38912
    s_waitcnt lgkmcnt(0)
    v_mfma_f32_16x16x32_bf16 v[52:55], v[82:85], a[180:183], v[52:55]
    v_mfma_f32_16x16x32_bf16 v[56:59], v[82:85], a[184:187], v[56:59]
    v_mfma_f32_16x16x32_bf16 v[60:63], v[82:85], a[188:191], v[60:63]
    v_mfma_f32_16x16x32_bf16 v[24:27], v[0:3], v[100:103], v[24:27]
    v_mfma_f32_16x16x32_bf16 v[28:31], v[0:3], v[104:107], v[28:31]
    v_mfma_f32_16x16x32_bf16 v[32:35], v[0:3], v[108:111], v[32:35]
    s_cmp_gt_u32 s89, 17
    s_cbranch_scc1 LskIs_34
    s_cmp_eq_u32 s91, 1
    s_cbranch_scc1 Lthr_35
    s_waitcnt vmcnt(18)
Lthr_35:
    s_add_u32 s71, s76, 1357824
    s_lshr_b32 s43, s68, 1
    s_max_u32 s71, s71, s43
    s_add_u32 m0, s88, 27648
    s_nop 0
    buffer_load_dwordx4 v5, s[52:55], s71 offen offset:0 nt lds
    s_add_u32 m0, s88, 28544
    s_nop 0
    buffer_load_dwordx4 v5, s[52:55], s71 offen offset:128 nt lds
    s_add_u32 m0, s88, 29440
    s_nop 0
    buffer_load_dwordx4 v5, s[52:55], s71 offen offset:256 nt lds
    buffer_load_dwordx4 a[180:183], v5, s[56:59], s71 offen offset:0 nt
    buffer_load_dwordx4 a[184:187], v5, s[56:59], s71 offen offset:128 nt
    buffer_load_dwordx4 a[188:191], v5, s[56:59], s71 offen offset:256 nt
LskIs_34:
    s_waitcnt lgkmcnt(0)
    v_mov_b32 v76, 0
    v_mov_b32 v77, 0
    v_mov_b32 v78, 0
    v_mov_b32 v0, 0
    v_mov_b32 v1, 0
    v_mov_b32 v2, 0
    v_dot2c_f32_bf16 v76, v64, v40
    v_dot2c_f32_bf16 v77, v68, v44
    v_dot2c_f32_bf16 v78, v72, v48
    v_dot2c_f32_bf16 v0, v88, v12
    v_dot2c_f32_bf16 v1, v92, v16
    v_dot2c_f32_bf16 v2, v96, v20
    v_dot2c_f32_bf16 v76, v65, v41
    v_dot2c_f32_bf16 v77, v69, v45
    v_dot2c_f32_bf16 v78, v73, v49
    v_dot2c_f32_bf16 v0, v89, v13
    v_dot2c_f32_bf16 v1, v93, v17
    v_dot2c_f32_bf16 v2, v97, v21
    v_dot2c_f32_bf16 v76, v66, v42
    v_dot2c_f32_bf16 v77, v70, v46
    v_dot2c_f32_bf16 v78, v74, v50
    v_dot2c_f32_bf16 v0, v90, v14
    v_dot2c_f32_bf16 v1, v94, v18
    v_dot2c_f32_bf16 v2, v98, v22
    v_dot2c_f32_bf16 v76, v67, v43
    v_dot2c_f32_bf16 v77, v71, v47
    v_dot2c_f32_bf16 v78, v75, v51
    v_dot2c_f32_bf16 v0, v91, v15
    v_dot2c_f32_bf16 v1, v95, v19
    v_dot2c_f32_bf16 v2, v99, v23
    s_waitcnt vmcnt(39)
    ds_read_b128 v[88:91], v6 offset:9216
    ds_read_b128 v[92:95], v6 offset:10240
    ds_read_b128 v[96:99], v6 offset:11264
    v_add_f32 v76, v76, v77
    v_add_f32 v76, v76, v78
    s_nop 0
    v_add_f32 v0, v0, v1
    v_add_f32 v0, v0, v2
    v_add_f32_dpp v76, v76, v76 quad_perm:[1,0,3,2] row_mask:0xf bank_mask:0xf
    s_nop 0
    v_add_f32_dpp v0, v0, v0 quad_perm:[1,0,3,2] row_mask:0xf bank_mask:0xf
    s_nop 0
    v_add_f32_dpp v76, v76, v76 quad_perm:[2,3,0,1] row_mask:0xf bank_mask:0xf
    s_nop 0
    v_add_f32_dpp v0, v0, v0 quad_perm:[2,3,0,1] row_mask:0xf bank_mask:0xf
    s_nop 0
    v_add_f32_dpp v76, v76, v76 row_half_mirror row_mask:0xf bank_mask:0xf
    s_nop 0
    v_add_f32_dpp v0, v0, v0 row_half_mirror row_mask:0xf bank_mask:0xf
    s_nop 0
    v_mul_f32 v76, s60, v76
    v_mul_f32 v0, s60, v0
    v_add_f32 v79, v76, v38
    v_add_f32 v3, v0, v37
    v_max_f32 v80, v79, v3
    v_cmp_lt_f32 vcc, 0, v80
    s_cbranch_vccz Lpsk_36
    s_swappc_b64 s[62:63], s[98:99]
    s_swappc_b64 s[62:63], s[94:95]
Lpsk_36:
    v_exp_f32 v80, v79
    v_exp_f32 v4, v3
    v_add_f32 v7, v7, v80
    v_add_f32 v36, v36, v4
    v_cvt_pk_bf16_f32 v80, v80, v80
    v_cvt_pk_bf16_f32 v4, v4, v4
    v_and_b32 v82, v80, v8
    v_and_b32 v83, v80, v9
    v_and_b32 v84, v80, v10
    v_and_b32 v85, v80, v11
    v_and_b32 v0, v4, v8
    v_and_b32 v1, v4, v9
    v_and_b32 v2, v4, v10
    v_and_b32 v3, v4, v11
    s_waitcnt vmcnt(42)
    v_mfma_f32_16x16x32_bf16 v[52:55], v[82:85], a[192:195], v[52:55]
    v_mfma_f32_16x16x32_bf16 v[56:59], v[82:85], a[196:199], v[56:59]
    v_mfma_f32_16x16x32_bf16 v[60:63], v[82:85], a[200:203], v[60:63]
    v_mfma_f32_16x16x32_bf16 v[24:27], v[0:3], a[96:99], v[24:27]
    v_mfma_f32_16x16x32_bf16 v[28:31], v[0:3], a[100:103], v[28:31]
    v_mfma_f32_16x16x32_bf16 v[32:35], v[0:3], a[104:107], v[32:35]
    s_cmp_eq_u32 s91, 1
    s_cbranch_scc1 Lthr_38
    s_waitcnt vmcnt(18)
Lthr_38:
    s_add_u32 s71, s76, 1437696
    s_lshr_b32 s43, s68, 1
    s_max_u32 s71, s71, s43
    s_add_u32 m0, s88, 30720
    s_nop 0
    buffer_load_dwordx4 v5, s[52:55], s71 offen offset:0 nt lds
    s_add_u32 m0, s88, 31616
    s_nop 0
    buffer_load_dwordx4 v5, s[52:55], s71 offen offset:128 nt lds
    s_add_u32 m0, s88, 32512
    s_nop 0
    buffer_load_dwordx4 v5, s[52:55], s71 offen offset:256 nt lds
    buffer_load_dwordx4 a[192:195], v5, s[56:59], s71 offen offset:0 nt
    buffer_load_dwordx4 a[196:199], v5, s[56:59], s71 offen offset:128 nt
    buffer_load_dwordx4 a[200:203], v5, s[56:59], s71 offen offset:256 nt
LskIs_37:
    s_waitcnt lgkmcnt(0)
    v_mov_b32 v76, 0
    v_mov_b32 v77, 0
    v_mov_b32 v78, 0
    v_mov_b32 v0, 0
    v_mov_b32 v1, 0
    v_mov_b32 v2, 0
    v_dot2c_f32_bf16 v76, v208, v40
    v_dot2c_f32_bf16 v77, v212, v44
    v_dot2c_f32_bf16 v78, v216, v48
    v_dot2c_f32_bf16 v0, v88, v12
    v_dot2c_f32_bf16 v1, v92, v16
    v_dot2c_f32_bf16 v2, v96, v20
    v_dot2c_f32_bf16 v76, v209, v41
    v_dot2c_f32_bf16 v77, v213, v45
    v_dot2c_f32_bf16 v78, v217, v49
    v_dot2c_f32_bf16 v0, v89, v13
    v_dot2c_f32_bf16 v1, v93, v17
    v_dot2c_f32_bf16 v2, v97, v21
    v_dot2c_f32_bf16 v76, v210, v42
    v_dot2c_f32_bf16 v77, v214, v46
    v_dot2c_f32_bf16 v78, v218, v50
    v_dot2c_f32_bf16 v0, v90, v14
    v_dot2c_f32_bf16 v1, v94, v18
    v_dot2c_f32_bf16 v2, v98, v22
    v_dot2c_f32_bf16 v76, v211, v43
    v_dot2c_f32_bf16 v77, v215, v47
    v_dot2c_f32_bf16 v78, v219, v51
    v_dot2c_f32_bf16 v0, v91, v15
    v_dot2c_f32_bf16 v1, v95, v19
    v_dot2c_f32_bf16 v2, v99, v23
    s_waitcnt vmcnt(39)
    ds_read_b128 v[88:91], v6 offset:12288
    ds_read_b128 v[92:95], v6 offset:13312
    ds_read_b128 v[96:99], v6 offset:14336
    v_add_f32 v76, v76, v77
    v_add_f32 v76, v76, v78
    s_nop 0
    v_add_f32 v0, v0, v1
    v_add_f32 v0, v0, v2
    v_add_f32_dpp v76, v76, v76 quad_perm:[1,0,3,2] row_mask:0xf bank_mask:0xf
    s_nop 0
    v_add_f32_dpp v0, v0, v0 quad_perm:[1,0,3,2] row_mask:0xf bank_mask:0xf
    s_nop 0
    v_add_f32_dpp v76, v76, v76 quad_perm:[2,3,0,1] row_mask:0xf bank_mask:0xf
    s_nop 0
    v_add_f32_dpp v0, v0, v0 quad_perm:[2,3,0,1] row_mask:0xf bank_mask:0xf
    s_nop 0
    v_add_f32_dpp v76, v76, v76 row_half_mirror row_mask:0xf bank_mask:0xf
    s_nop 0
    v_add_f32_dpp v0, v0, v0 row_half_mirror row_mask:0xf bank_mask:0xf
    s_nop 0
    v_mul_f32 v76, s60, v76
    v_mul_f32 v0, s60, v0
    v_add_f32 v79, v76, v38
    v_add_f32 v3, v0, v37
    v_max_f32 v80, v79, v3
    v_cmp_lt_f32 vcc, 0, v80
    s_cbranch_vccz Lpsk_39
    s_swappc_b64 s[62:63], s[98:99]
    s_swappc_b64 s[62:63], s[94:95]
Lpsk_39:
    v_exp_f32 v80, v79
    v_exp_f32 v4, v3
    v_add_f32 v7, v7, v80
    v_add_f32 v36, v36, v4
    v_cvt_pk_bf16_f32 v80, v80, v80
    v_cvt_pk_bf16_f32 v4, v4, v4
    v_and_b32 v82, v80, v8
    v_and_b32 v83, v80, v9
    v_and_b32 v84, v80, v10
    v_and_b32 v85, v80, v11
    v_and_b32 v0, v4, v8
    v_and_b32 v1, v4, v9
    v_and_b32 v2, v4, v10
    v_and_b32 v3, v4, v11
    s_waitcnt vmcnt(42)
    v_mfma_f32_16x16x32_bf16 v[52:55], v[82:85], a[204:207], v[52:55]
    v_mfma_f32_16x16x32_bf16 v[56:59], v[82:85], a[208:211], v[56:59]
    v_mfma_f32_16x16x32_bf16 v[60:63], v[82:85], a[212:215], v[60:63]
    v_mfma_f32_16x16x32_bf16 v[24:27], v[0:3], a[108:111], v[24:27]
    v_mfma_f32_16x16x32_bf16 v[28:31], v[0:3], a[112:115], v[28:31]
    v_mfma_f32_16x16x32_bf16 v[32:35], v[0:3], a[116:119], v[32:35]
    s_cmp_eq_u32 s91, 1
    s_cbranch_scc1 Lthr_41
    s_waitcnt vmcnt(18)
Lthr_41:
    s_add_u32 s71, s76, 1517568
    s_lshr_b32 s43, s68, 1
    s_max_u32 s71, s71, s43
    buffer_load_dwordx4 v[208:211], v5, s[52:55], s71 offen offset:0 nt
    buffer_load_dwordx4 v[212:215], v5, s[52:55], s71 offen offset:128 nt
    buffer_load_dwordx4 v[216:219], v5, s[52:55], s71 offen offset:256 nt
    buffer_load_dwordx4 a[204:207], v5, s[56:59], s71 offen offset:0 nt
    buffer_load_dwordx4 a[208:211], v5, s[56:59], s71 offen offset:128 nt
    buffer_load_dwordx4 a[212:215], v5, s[56:59], s71 offen offset:256 nt
LskIs_40:
    s_waitcnt lgkmcnt(0)
    v_mov_b32 v76, 0
    v_mov_b32 v77, 0
    v_mov_b32 v78, 0
    v_mov_b32 v0, 0
    v_mov_b32 v1, 0
    v_mov_b32 v2, 0
    v_dot2c_f32_bf16 v76, v220, v40
    v_dot2c_f32_bf16 v77, v224, v44
    v_dot2c_f32_bf16 v78, v228, v48
    v_dot2c_f32_bf16 v0, v88, v12
    v_dot2c_f32_bf16 v1, v92, v16
    v_dot2c_f32_bf16 v2, v96, v20
    v_dot2c_f32_bf16 v76, v221, v41
    v_dot2c_f32_bf16 v77, v225, v45
    v_dot2c_f32_bf16 v78, v229, v49
    v_dot2c_f32_bf16 v0, v89, v13
    v_dot2c_f32_bf16 v1, v93, v17
    v_dot2c_f32_bf16 v2, v97, v21
    v_dot2c_f32_bf16 v76, v222, v42
    v_dot2c_f32_bf16 v77, v226, v46
    v_dot2c_f32_bf16 v78, v230, v50
    v_dot2c_f32_bf16 v0, v90, v14
    v_dot2c_f32_bf16 v1, v94, v18
    v_dot2c_f32_bf16 v2, v98, v22
    v_dot2c_f32_bf16 v76, v223, v43
    v_dot2c_f32_bf16 v77, v227, v47
    v_dot2c_f32_bf16 v78, v231, v51
    v_dot2c_f32_bf16 v0, v91, v15
    v_dot2c_f32_bf16 v1, v95, v19
    v_dot2c_f32_bf16 v2, v99, v23
    s_waitcnt vmcnt(39)
    ds_read_b128 v[88:91], v6 offset:15360
    ds_read_b128 v[92:95], v6 offset:16384
    ds_read_b128 v[96:99], v6 offset:17408
    v_add_f32 v76, v76, v77
    v_add_f32 v76, v76, v78
    s_nop 0
    v_add_f32 v0, v0, v1
    v_add_f32 v0, v0, v2
    v_add_f32_dpp v76, v76, v76 quad_perm:[1,0,3,2] row_mask:0xf bank_mask:0xf
    s_nop 0
    v_add_f32_dpp v0, v0, v0 quad_perm:[1,0,3,2] row_mask:0xf bank_mask:0xf
    s_nop 0
    v_add_f32_dpp v76, v76, v76 quad_perm:[2,3,0,1] row_mask:0xf bank_mask:0xf
    s_nop 0
    v_add_f32_dpp v0, v0, v0 quad_perm:[2,3,0,1] row_mask:0xf bank_mask:0xf
    s_nop 0
    v_add_f32_dpp v76, v76, v76 row_half_mirror row_mask:0xf bank_mask:0xf
    s_nop 0
    v_add_f32_dpp v0, v0, v0 row_half_mirror row_mask:0xf bank_mask:0xf
    s_nop 0
    v_mul_f32 v76, s60, v76
    v_mul_f32 v0, s60, v0
    v_add_f32 v79, v76, v38
    v_add_f32 v3, v0, v37
    v_max_f32 v80, v79, v3
    v_cmp_lt_f32 vcc, 0, v80
    s_cbranch_vccz Lpsk_42
    s_swappc_b64 s[62:63], s[98:99]
    s_swappc_b64 s[62:63], s[94:95]
Lpsk_42:
    v_exp_f32 v80, v79
    v_exp_f32 v4, v3
    v_add_f32 v7, v7, v80
    v_add_f32 v36, v36, v4
    v_cvt_pk_bf16_f32 v80, v80, v80
    v_cvt_pk_bf16_f32 v4, v4, v4
    v_and_b32 v82, v80, v8
    v_and_b32 v83, v80, v9
    v_and_b32 v84, v80, v10
    v_and_b32 v85, v80, v11
    v_and_b32 v0, v4, v8
    v_and_b32 v1, v4, v9
    v_and_b32 v2, v4, v10
    v_and_b32 v3, v4, v11
    s_waitcnt vmcnt(42)
    v_mfma_f32_16x16x32_bf16 v[52:55], v[82:85], a[216:219], v[52:55]
    v_mfma_f32_16x16x32_bf16 v[56:59], v[82:85], a[220:223], v[56:59]
    v_mfma_f32_16x16x32_bf16 v[60:63], v[82:85], a[224:227], v[60:63]
    v_mfma_f32_16x16x32_bf16 v[24:27], v[0:3], a[120:123], v[24:27]
    v_mfma_f32_16x16x32_bf16 v[28:31], v[0:3], a[124:127], v[28:31]
    v_mfma_f32_16x16x32_bf16 v[32:35], v[0:3], a[128:131], v[32:35]
    s_cmp_eq_u32 s91, 1
    s_cbranch_scc1 Lthr_44
    s_waitcnt vmcnt(18)
Lthr_44:
    s_add_u32 s71, s76, 1597440
    s_lshr_b32 s43, s68, 1
    s_max_u32 s71, s71, s43
    buffer_load_dwordx4 v[220:223], v5, s[52:55], s71 offen offset:0 nt
    buffer_load_dwordx4 v[224:227], v5, s[52:55], s71 offen offset:128 nt
    buffer_load_dwordx4 v[228:231], v5, s[52:55], s71 offen offset:256 nt
    buffer_load_dwordx4 a[216:219], v5, s[56:59], s71 offen offset:0 nt
    buffer_load_dwordx4 a[220:223], v5, s[56:59], s71 offen offset:128 nt
    buffer_load_dwordx4 a[224:227], v5, s[56:59], s71 offen offset:256 nt
LskIs_43:
    s_waitcnt lgkmcnt(0)
    v_mov_b32 v76, 0
    v_mov_b32 v77, 0
    v_mov_b32 v78, 0
    v_mov_b32 v0, 0
    v_mov_b32 v1, 0
    v_mov_b32 v2, 0
    v_dot2c_f32_bf16 v76, v232, v40
    v_dot2c_f32_bf16 v77, v236, v44
    v_dot2c_f32_bf16 v78, v240, v48
    v_dot2c_f32_bf16 v0, v88, v12
    v_dot2c_f32_bf16 v1, v92, v16
    v_dot2c_f32_bf16 v2, v96, v20
    v_dot2c_f32_bf16 v76, v233, v41
    v_dot2c_f32_bf16 v77, v237, v45
    v_dot2c_f32_bf16 v78, v241, v49
    v_dot2c_f32_bf16 v0, v89, v13
    v_dot2c_f32_bf16 v1, v93, v17
    v_dot2c_f32_bf16 v2, v97, v21
    v_dot2c_f32_bf16 v76, v234, v42
    v_dot2c_f32_bf16 v77, v238, v46
    v_dot2c_f32_bf16 v78, v242, v50
    v_dot2c_f32_bf16 v0, v90, v14
    v_dot2c_f32_bf16 v1, v94, v18
    v_dot2c_f32_bf16 v2, v98, v22
    v_dot2c_f32_bf16 v76, v235, v43
    v_dot2c_f32_bf16 v77, v239, v47
    v_dot2c_f32_bf16 v78, v243, v51
    v_dot2c_f32_bf16 v0, v91, v15
    v_dot2c_f32_bf16 v1, v95, v19
    v_dot2c_f32_bf16 v2, v99, v23
    s_waitcnt vmcnt(39)
    ds_read_b128 v[88:91], v6 offset:18432
    ds_read_b128 v[92:95], v6 offset:19456
    ds_read_b128 v[96:99], v6 offset:20480
    v_add_f32 v76, v76, v77
    v_add_f32 v76, v76, v78
    s_nop 0
    v_add_f32 v0, v0, v1
    v_add_f32 v0, v0, v2
    v_add_f32_dpp v76, v76, v76 quad_perm:[1,0,3,2] row_mask:0xf bank_mask:0xf
    s_nop 0
    v_add_f32_dpp v0, v0, v0 quad_perm:[1,0,3,2] row_mask:0xf bank_mask:0xf
    s_nop 0
    v_add_f32_dpp v76, v76, v76 quad_perm:[2,3,0,1] row_mask:0xf bank_mask:0xf
    s_nop 0
    v_add_f32_dpp v0, v0, v0 quad_perm:[2,3,0,1] row_mask:0xf bank_mask:0xf
    s_nop 0
    v_add_f32_dpp v76, v76, v76 row_half_mirror row_mask:0xf bank_mask:0xf
    s_nop 0
    v_add_f32_dpp v0, v0, v0 row_half_mirror row_mask:0xf bank_mask:0xf
    s_nop 0
    v_mul_f32 v76, s60, v76
    v_mul_f32 v0, s60, v0
    v_add_f32 v79, v76, v38
    v_add_f32 v3, v0, v37
    v_max_f32 v80, v79, v3
    v_cmp_lt_f32 vcc, 0, v80
    s_cbranch_vccz Lpsk_45
    s_swappc_b64 s[62:63], s[98:99]
    s_swappc_b64 s[62:63], s[94:95]
Lpsk_45:
    v_exp_f32 v80, v79
    v_exp_f32 v4, v3
    v_add_f32 v7, v7, v80
    v_add_f32 v36, v36, v4
    v_cvt_pk_bf16_f32 v80, v80, v80
    v_cvt_pk_bf16_f32 v4, v4, v4
    v_and_b32 v82, v80, v8
    v_and_b32 v83, v80, v9
    v_and_b32 v84, v80, v10
    v_and_b32 v85, v80, v11
    v_and_b32 v0, v4, v8
    v_and_b32 v1, v4, v9
    v_and_b32 v2, v4, v10
    v_and_b32 v3, v4, v11
    s_waitcnt vmcnt(42)
    v_mfma_f32_16x16x32_bf16 v[52:55], v[82:85], a[228:231], v[52:55]
    v_mfma_f32_16x16x32_bf16 v[56:59], v[82:85], a[232:235], v[56:59]
    v_mfma_f32_16x16x32_bf16 v[60:63], v[82:85], a[236:239], v[60:63]
    v_mfma_f32_16x16x32_bf16 v[24:27], v[0:3], a[132:135], v[24:27]
    v_mfma_f32_16x16x32_bf16 v[28:31], v[0:3], a[136:139], v[28:31]
    v_mfma_f32_16x16x32_bf16 v[32:35], v[0:3], a[140:143], v[32:35]
    s_cmp_eq_u32 s91, 1
    s_cbranch_scc1 Lthr_47
    s_waitcnt vmcnt(18)
Lthr_47:
    s_add_u32 s71, s76, 1677312
    s_lshr_b32 s43, s68, 1
    s_max_u32 s71, s71, s43
    buffer_load_dwordx4 v[232:235], v5, s[52:55], s71 offen offset:0 nt
    buffer_load_dwordx4 v[236:239], v5, s[52:55], s71 offen offset:128 nt
    buffer_load_dwordx4 v[240:243], v5, s[52:55], s71 offen offset:256 nt
    buffer_load_dwordx4 a[228:231], v5, s[56:59], s71 offen offset:0 nt
    buffer_load_dwordx4 a[232:235], v5, s[56:59], s71 offen offset:128 nt
    buffer_load_dwordx4 a[236:239], v5, s[56:59], s71 offen offset:256 nt
LskIs_46:
    s_waitcnt lgkmcnt(0)
    v_mov_b32 v76, 0
    v_mov_b32 v77, 0
    v_mov_b32 v78, 0
    v_mov_b32 v0, 0
    v_mov_b32 v1, 0
    v_mov_b32 v2, 0
    v_dot2c_f32_bf16 v76, v244, v40
    v_dot2c_f32_bf16 v77, v248, v44
    v_dot2c_f32_bf16 v78, v252, v48
    v_dot2c_f32_bf16 v0, v88, v12
    v_dot2c_f32_bf16 v1, v92, v16
    v_dot2c_f32_bf16 v2, v96, v20
    v_dot2c_f32_bf16 v76, v245, v41
    v_dot2c_f32_bf16 v77, v249, v45
    v_dot2c_f32_bf16 v78, v253, v49
    v_dot2c_f32_bf16 v0, v89, v13
    v_dot2c_f32_bf16 v1, v93, v17
    v_dot2c_f32_bf16 v2, v97, v21
    v_dot2c_f32_bf16 v76, v246, v42
    v_dot2c_f32_bf16 v77, v250, v46
    v_dot2c_f32_bf16 v78, v254, v50
    v_dot2c_f32_bf16 v0, v90, v14
    v_dot2c_f32_bf16 v1, v94, v18
    v_dot2c_f32_bf16 v2, v98, v22
    v_dot2c_f32_bf16 v76, v247, v43
    v_dot2c_f32_bf16 v77, v251, v47
    v_dot2c_f32_bf16 v78, v255, v51
    v_dot2c_f32_bf16 v0, v91, v15
    v_dot2c_f32_bf16 v1, v95, v19
    v_dot2c_f32_bf16 v2, v99, v23
    s_waitcnt vmcnt(39)
    ds_read_b128 v[88:91], v6 offset:21504
    ds_read_b128 v[92:95], v6 offset:22528
    ds_read_b128 v[96:99], v6 offset:23552
    v_add_f32 v76, v76, v77
    v_add_f32 v76, v76, v78
    s_nop 0
    v_add_f32 v0, v0, v1
    v_add_f32 v0, v0, v2
    v_add_f32_dpp v76, v76, v76 quad_perm:[1,0,3,2] row_mask:0xf bank_mask:0xf
    s_nop 0
    v_add_f32_dpp v0, v0, v0 quad_perm:[1,0,3,2] row_mask:0xf bank_mask:0xf
    s_nop 0
    v_add_f32_dpp v76, v76, v76 quad_perm:[2,3,0,1] row_mask:0xf bank_mask:0xf
    s_nop 0
    v_add_f32_dpp v0, v0, v0 quad_perm:[2,3,0,1] row_mask:0xf bank_mask:0xf
    s_nop 0
    v_add_f32_dpp v76, v76, v76 row_half_mirror row_mask:0xf bank_mask:0xf
    s_nop 0
    v_add_f32_dpp v0, v0, v0 row_half_mirror row_mask:0xf bank_mask:0xf
    s_nop 0
    v_mul_f32 v76, s60, v76
    v_mul_f32 v0, s60, v0
    v_add_f32 v79, v76, v38
    v_add_f32 v3, v0, v37
    v_max_f32 v80, v79, v3
    v_cmp_lt_f32 vcc, 0, v80
    s_cbranch_vccz Lpsk_48
    s_swappc_b64 s[62:63], s[98:99]
    s_swappc_b64 s[62:63], s[94:95]
Lpsk_48:
    v_exp_f32 v80, v79
    v_exp_f32 v4, v3
    v_add_f32 v7, v7, v80
    v_add_f32 v36, v36, v4
    v_cvt_pk_bf16_f32 v80, v80, v80
    v_cvt_pk_bf16_f32 v4, v4, v4
    v_and_b32 v82, v80, v8
    v_and_b32 v83, v80, v9
    v_and_b32 v84, v80, v10
    v_and_b32 v85, v80, v11
    v_and_b32 v0, v4, v8
    v_and_b32 v1, v4, v9
    v_and_b32 v2, v4, v10
    v_and_b32 v3, v4, v11
    s_waitcnt vmcnt(42)
    v_mfma_f32_16x16x32_bf16 v[52:55], v[82:85], a[240:243], v[52:55]
    v_mfma_f32_16x16x32_bf16 v[56:59], v[82:85], a[244:247], v[56:59]
    v_mfma_f32_16x16x32_bf16 v[60:63], v[82:85], a[248:251], v[60:63]
    v_mfma_f32_16x16x32_bf16 v[24:27], v[0:3], a[144:147], v[24:27]
    v_mfma_f32_16x16x32_bf16 v[28:31], v[0:3], a[148:151], v[28:31]
    v_mfma_f32_16x16x32_bf16 v[32:35], v[0:3], a[152:155], v[32:35]
    s_cmp_eq_u32 s91, 1
    s_cbranch_scc1 Lthr_50
    s_waitcnt vmcnt(18)
Lthr_50:
    s_add_u32 s71, s76, 1757184
    s_lshr_b32 s43, s68, 1
    s_max_u32 s71, s71, s43
    buffer_load_dwordx4 v[244:247], v5, s[52:55], s71 offen offset:0 nt
    buffer_load_dwordx4 v[248:251], v5, s[52:55], s71 offen offset:128 nt
    buffer_load_dwordx4 v[252:255], v5, s[52:55], s71 offen offset:256 nt
    buffer_load_dwordx4 a[240:243], v5, s[56:59], s71 offen offset:0 nt
    buffer_load_dwordx4 a[244:247], v5, s[56:59], s71 offen offset:128 nt
    buffer_load_dwordx4 a[248:251], v5, s[56:59], s71 offen offset:256 nt
LskIs_49:
    s_waitcnt lgkmcnt(0)
    v_mov_b32 v0, 0
    v_mov_b32 v1, 0
    v_mov_b32 v2, 0
    v_dot2c_f32_bf16 v0, v88, v12
    v_dot2c_f32_bf16 v1, v92, v16
    v_dot2c_f32_bf16 v2, v96, v20
    v_dot2c_f32_bf16 v0, v89, v13
    v_dot2c_f32_bf16 v1, v93, v17
    v_dot2c_f32_bf16 v2, v97, v21
    v_dot2c_f32_bf16 v0, v90, v14
    v_dot2c_f32_bf16 v1, v94, v18
    v_dot2c_f32_bf16 v2, v98, v22
    v_dot2c_f32_bf16 v0, v91, v15
    v_dot2c_f32_bf16 v1, v95, v19
    v_dot2c_f32_bf16 v2, v99, v23
    s_waitcnt vmcnt(39)
    ds_read_b128 v[88:91], v6 offset:24576
    ds_read_b128 v[92:95], v6 offset:25600
    ds_read_b128 v[96:99], v6 offset:26624
    s_nop 1
    v_add_f32 v0, v0, v1
    v_add_f32 v0, v0, v2
    s_nop 1
    v_add_f32_dpp v0, v0, v0 quad_perm:[1,0,3,2] row_mask:0xf bank_mask:0xf
    s_nop 1
    v_add_f32_dpp v0, v0, v0 quad_perm:[2,3,0,1] row_mask:0xf bank_mask:0xf
    s_nop 1
    v_add_f32_dpp v0, v0, v0 row_half_mirror row_mask:0xf bank_mask:0xf
    v_mul_f32 v0, s60, v0
    v_add_f32 v3, v0, v37
    v_cmp_lt_f32 vcc, 0, v3
    s_cbranch_vccz Lskip_51
    s_swappc_b64 s[62:63], s[94:95]
Lskip_51:
    v_exp_f32 v4, v3
    s_nop 0
    v_add_f32 v36, v36, v4
    v_cvt_pk_bf16_f32 v4, v4, v4
    v_and_b32 v0, v4, v8
    v_and_b32 v1, v4, v9
    v_and_b32 v2, v4, v10
    v_and_b32 v3, v4, v11
    s_waitcnt vmcnt(42)
    s_nop 1
    v_mfma_f32_16x16x32_bf16 v[24:27], v[0:3], a[156:159], v[24:27]
    v_mfma_f32_16x16x32_bf16 v[28:31], v[0:3], a[160:163], v[28:31]
    v_mfma_f32_16x16x32_bf16 v[32:35], v[0:3], a[164:167], v[32:35]
    s_waitcnt lgkmcnt(0)
    v_mov_b32 v0, 0
    v_mov_b32 v1, 0
    v_mov_b32 v2, 0
    v_dot2c_f32_bf16 v0, v88, v12
    v_dot2c_f32_bf16 v1, v92, v16
    v_dot2c_f32_bf16 v2, v96, v20
    v_dot2c_f32_bf16 v0, v89, v13
    v_dot2c_f32_bf16 v1, v93, v17
    v_dot2c_f32_bf16 v2, v97, v21
    v_dot2c_f32_bf16 v0, v90, v14
    v_dot2c_f32_bf16 v1, v94, v18
    v_dot2c_f32_bf16 v2, v98, v22
    v_dot2c_f32_bf16 v0, v91, v15
    v_dot2c_f32_bf16 v1, v95, v19
    v_dot2c_f32_bf16 v2, v99, v23
    s_waitcnt vmcnt(33)
    ds_read_b128 v[88:91], v6 offset:27648
    ds_read_b128 v[92:95], v6 offset:28672
    ds_read_b128 v[96:99], v6 offset:29696
    s_nop 1
    v_add_f32 v0, v0, v1
    v_add_f32 v0, v0, v2
    s_nop 1
    v_add_f32_dpp v0, v0, v0 quad_perm:[1,0,3,2] row_mask:0xf bank_mask:0xf
    s_nop 1
    v_add_f32_dpp v0, v0, v0 quad_perm:[2,3,0,1] row_mask:0xf bank_mask:0xf
    s_nop 1
    v_add_f32_dpp v0, v0, v0 row_half_mirror row_mask:0xf bank_mask:0xf
    v_mul_f32 v0, s60, v0
    v_add_f32 v0, s67, v0
    v_add_f32 v3, v0, v37
    v_cmp_lt_f32 vcc, 0, v3
    s_cbranch_vccz Lskip_52
    s_swappc_b64 s[62:63], s[94:95]
Lskip_52:
    v_exp_f32 v4, v3
    s_nop 0
    v_add_f32 v36, v36, v4
    v_cvt_pk_bf16_f32 v4, v4, v4
    v_and_b32 v0, v4, v8
    v_and_b32 v1, v4, v9
    v_and_b32 v2, v4, v10
    v_and_b32 v3, v4, v11
    s_waitcnt vmcnt(36)
    s_nop 1
    v_mfma_f32_16x16x32_bf16 v[24:27], v[0:3], a[168:171], v[24:27]
    v_mfma_f32_16x16x32_bf16 v[28:31], v[0:3], a[172:175], v[28:31]
    v_mfma_f32_16x16x32_bf16 v[32:35], v[0:3], a[176:179], v[32:35]
    s_waitcnt lgkmcnt(0)
    v_mov_b32 v0, 0
    v_mov_b32 v1, 0
    v_mov_b32 v2, 0
    v_dot2c_f32_bf16 v0, v88, v12
    v_dot2c_f32_bf16 v1, v92, v16
    v_dot2c_f32_bf16 v2, v96, v20
    v_dot2c_f32_bf16 v0, v89, v13
    v_dot2c_f32_bf16 v1, v93, v17
    v_dot2c_f32_bf16 v2, v97, v21
    v_dot2c_f32_bf16 v0, v90, v14
    v_dot2c_f32_bf16 v1, v94, v18
    v_dot2c_f32_bf16 v2, v98, v22
    v_dot2c_f32_bf16 v0, v91, v15
    v_dot2c_f32_bf16 v1, v95, v19
    v_dot2c_f32_bf16 v2, v99, v23
    s_waitcnt vmcnt(27)
    ds_read_b128 v[88:91], v6 offset:30720
    ds_read_b128 v[92:95], v6 offset:31744
    ds_read_b128 v[96:99], v6 offset:32768
    s_nop 1
    v_add_f32 v0, v0, v1
    v_add_f32 v0, v0, v2
    s_nop 1
    v_add_f32_dpp v0, v0, v0 quad_perm:[1,0,3,2] row_mask:0xf bank_mask:0xf
    s_nop 1
    v_add_f32_dpp v0, v0, v0 quad_perm:[2,3,0,1] row_mask:0xf bank_mask:0xf
    s_nop 1
    v_add_f32_dpp v0, v0, v0 row_half_mirror row_mask:0xf bank_mask:0xf
    v_mul_f32 v0, s60, v0
    v_add_f32 v0, s68, v0
    v_add_f32 v3, v0, v37
    v_cmp_lt_f32 vcc, 0, v3
    s_cbranch_vccz Lskip_53
    s_swappc_b64 s[62:63], s[94:95]
Lskip_53:
    v_exp_f32 v4, v3
    s_nop 0
    v_add_f32 v36, v36, v4
    v_cvt_pk_bf16_f32 v4, v4, v4
    v_and_b32 v0, v4, v8
    v_and_b32 v1, v4, v9
    v_and_b32 v2, v4, v10
    v_and_b32 v3, v4, v11
    s_waitcnt vmcnt(30)
    s_nop 1
    v_mfma_f32_16x16x32_bf16 v[24:27], v[0:3], a[180:183], v[24:27]
    v_mfma_f32_16x16x32_bf16 v[28:31], v[0:3], a[184:187], v[28:31]
    v_mfma_f32_16x16x32_bf16 v[32:35], v[0:3], a[188:191], v[32:35]
    s_waitcnt lgkmcnt(0)
    v_mov_b32 v0, 0
    v_mov_b32 v1, 0
    v_mov_b32 v2, 0
    v_dot2c_f32_bf16 v0, v88, v12
    v_dot2c_f32_bf16 v1, v92, v16
    v_dot2c_f32_bf16 v2, v96, v20
    v_dot2c_f32_bf16 v0, v89, v13
    v_dot2c_f32_bf16 v1, v93, v17
    v_dot2c_f32_bf16 v2, v97, v21
    v_dot2c_f32_bf16 v0, v90, v14
    v_dot2c_f32_bf16 v1, v94, v18
    v_dot2c_f32_bf16 v2, v98, v22
    v_dot2c_f32_bf16 v0, v91, v15
    v_dot2c_f32_bf16 v1, v95, v19
    v_dot2c_f32_bf16 v2, v99, v23
    s_nop 1
    v_add_f32 v0, v0, v1
    v_add_f32 v0, v0, v2
    s_nop 1
    v_add_f32_dpp v0, v0, v0 quad_perm:[1,0,3,2] row_mask:0xf bank_mask:0xf
    s_nop 1
    v_add_f32_dpp v0, v0, v0 quad_perm:[2,3,0,1] row_mask:0xf bank_mask:0xf
    s_nop 1
    v_add_f32_dpp v0, v0, v0 row_half_mirror row_mask:0xf bank_mask:0xf
    v_mul_f32 v0, s60, v0
    v_add_f32 v0, s68, v0
    v_add_f32 v3, v0, v37
    v_cmp_lt_f32 vcc, 0, v3
    s_cbranch_vccz Lskip_54
    s_swappc_b64 s[62:63], s[94:95]
Lskip_54:
    v_exp_f32 v4, v3
    s_nop 0
    v_add_f32 v36, v36, v4
    v_cvt_pk_bf16_f32 v4, v4, v4
    v_and_b32 v0, v4, v8
    v_and_b32 v1, v4, v9
    v_and_b32 v2, v4, v10
    v_and_b32 v3, v4, v11
    s_waitcnt vmcnt(24)
    s_nop 1
    v_mfma_f32_16x16x32_bf16 v[24:27], v[0:3], a[192:195], v[24:27]
    v_mfma_f32_16x16x32_bf16 v[28:31], v[0:3], a[196:199], v[28:31]
    v_mfma_f32_16x16x32_bf16 v[32:35], v[0:3], a[200:203], v[32:35]
    s_waitcnt vmcnt(21)
    s_waitcnt lgkmcnt(0)
    v_mov_b32 v0, 0
    v_mov_b32 v1, 0
    v_mov_b32 v2, 0
    v_dot2c_f32_bf16 v0, v208, v12
    v_dot2c_f32_bf16 v1, v212, v16
    v_dot2c_f32_bf16 v2, v216, v20
    v_dot2c_f32_bf16 v0, v209, v13
    v_dot2c_f32_bf16 v1, v213, v17
    v_dot2c_f32_bf16 v2, v217, v21
    v_dot2c_f32_bf16 v0, v210, v14
    v_dot2c_f32_bf16 v1, v214, v18
    v_dot2c_f32_bf16 v2, v218, v22
    v_dot2c_f32_bf16 v0, v211, v15
    v_dot2c_f32_bf16 v1, v215, v19
    v_dot2c_f32_bf16 v2, v219, v23
    s_nop 1
    v_add_f32 v0, v0, v1
    v_add_f32 v0, v0, v2
    s_nop 1
    v_add_f32_dpp v0, v0, v0 quad_perm:[1,0,3,2] row_mask:0xf bank_mask:0xf
    s_nop 1
    v_add_f32_dpp v0, v0, v0 quad_perm:[2,3,0,1] row_mask:0xf bank_mask:0xf
    s_nop 1
    v_add_f32_dpp v0, v0, v0 row_half_mirror row_mask:0xf bank_mask:0xf
    v_mul_f32 v0, s60, v0
    v_add_f32 v0, s68, v0
    v_add_f32 v3, v0, v37
    v_cmp_lt_f32 vcc, 0, v3
    s_cbranch_vccz Lskip_55
    s_swappc_b64 s[62:63], s[94:95]
Lskip_55:
    v_exp_f32 v4, v3
    s_nop 0
    v_add_f32 v36, v36, v4
    v_cvt_pk_bf16_f32 v4, v4, v4
    v_and_b32 v0, v4, v8
    v_and_b32 v1, v4, v9
    v_and_b32 v2, v4, v10
    v_and_b32 v3, v4, v11
    s_waitcnt vmcnt(18)
    s_nop 1
    v_mfma_f32_16x16x32_bf16 v[24:27], v[0:3], a[204:207], v[24:27]
    v_mfma_f32_16x16x32_bf16 v[28:31], v[0:3], a[208:211], v[28:31]
    v_mfma_f32_16x16x32_bf16 v[32:35], v[0:3], a[212:215], v[32:35]
    s_nop 7
    v_mov_b32 v88, v40
    v_mov_b32 v100, v52
    v_mov_b32 v89, v41
    v_mov_b32 v101, v53
    v_mov_b32 v90, v42
    v_mov_b32 v102, v54
    v_mov_b32 v91, v43
    v_mov_b32 v103, v55
    v_mov_b32 v92, v44
    v_mov_b32 v104, v56
    v_mov_b32 v93, v45
    v_mov_b32 v105, v57
    v_mov_b32 v94, v46
    v_mov_b32 v106, v58
    v_mov_b32 v95, v47
    v_mov_b32 v107, v59
    v_mov_b32 v96, v48
    v_mov_b32 v108, v60
    v_mov_b32 v97, v49
    v_mov_b32 v109, v61
    v_mov_b32 v98, v50
    v_mov_b32 v110, v62
    v_mov_b32 v99, v51
    v_mov_b32 v111, v63
    s_waitcnt vmcnt(15)
    s_waitcnt lgkmcnt(0)
    v_mov_b32 v0, 0
    v_mov_b32 v1, 0
    v_mov_b32 v2, 0
    v_dot2c_f32_bf16 v0, v220, v12
    v_dot2c_f32_bf16 v1, v224, v16
    v_dot2c_f32_bf16 v2, v228, v20
    v_dot2c_f32_bf16 v0, v221, v13
    v_dot2c_f32_bf16 v1, v225, v17
    v_dot2c_f32_bf16 v2, v229, v21
    v_dot2c_f32_bf16 v0, v222, v14
    v_dot2c_f32_bf16 v1, v226, v18
    v_dot2c_f32_bf16 v2, v230, v22
    v_dot2c_f32_bf16 v0, v223, v15
    v_dot2c_f32_bf16 v1, v227, v19
    v_dot2c_f32_bf16 v2, v231, v23
    s_nop 1
    v_add_f32 v0, v0, v1
    v_add_f32 v0, v0, v2
    s_nop 1
    v_add_f32_dpp v0, v0, v0 quad_perm:[1,0,3,2] row_mask:0xf bank_mask:0xf
    s_nop 1
    v_add_f32_dpp v0, v0, v0 quad_perm:[2,3,0,1] row_mask:0xf bank_mask:0xf
    s_nop 1
    v_add_f32_dpp v0, v0, v0 row_half_mirror row_mask:0xf bank_mask:0xf
    v_mul_f32 v0, s60, v0
    v_add_f32 v0, s68, v0
    v_add_f32 v3, v0, v37
    v_cmp_lt_f32 vcc, 0, v3
    s_cbranch_vccz Lskip_56
    s_swappc_b64 s[62:63], s[94:95]
Lskip_56:
    v_exp_f32 v4, v3
    s_nop 0
    v_add_f32 v36, v36, v4
    v_cvt_pk_bf16_f32 v4, v4, v4
    v_and_b32 v0, v4, v8
    v_and_b32 v1, v4, v9
    v_and_b32 v2, v4, v10
    v_and_b32 v3, v4, v11
    s_waitcnt vmcnt(12)
    s_nop 1
    v_mfma_f32_16x16x32_bf16 v[24:27], v[0:3], a[216:219], v[24:27]
    v_mfma_f32_16x16x32_bf16 v[28:31], v[0:3], a[220:223], v[28:31]
    v_mfma_f32_16x16x32_bf16 v[32:35], v[0:3], a[224:227], v[32:35]
    s_add_u32 s71, s74, 0
    buffer_load_dwordx4 v[40:43], v5, s[52:55], s71 offen offset:0 nt
    buffer_load_dwordx4 v[44:47], v5, s[52:55], s71 offen offset:128 nt
    buffer_load_dwordx4 v[48:51], v5, s[52:55], s71 offen offset:256 nt
    s_add_u32 s71, s74, 0
    buffer_load_dwordx4 v[52:55], v5, s[56:59], s71 offen offset:0 nt
    buffer_load_dwordx4 v[56:59], v5, s[56:59], s71 offen offset:128 nt
    buffer_load_dwordx4 v[60:63], v5, s[56:59], s71 offen offset:256 nt
    s_waitcnt vmcnt(15)
    s_waitcnt lgkmcnt(0)
    v_mov_b32 v0, 0
    v_mov_b32 v1, 0
    v_mov_b32 v2, 0
    v_dot2c_f32_bf16 v0, v232, v12
    v_dot2c_f32_bf16 v1, v236, v16
    v_dot2c_f32_bf16 v2, v240, v20
    v_dot2c_f32_bf16 v0, v233, v13
    v_dot2c_f32_bf16 v1, v237, v17
    v_dot2c_f32_bf16 v2, v241, v21
    v_dot2c_f32_bf16 v0, v234, v14
    v_dot2c_f32_bf16 v1, v238, v18
    v_dot2c_f32_bf16 v2, v242, v22
    v_dot2c_f32_bf16 v0, v235, v15
    v_dot2c_f32_bf16 v1, v239, v19
    v_dot2c_f32_bf16 v2, v243, v23
    s_nop 1
    v_add_f32 v0, v0, v1
    v_add_f32 v0, v0, v2
    s_nop 1
    v_add_f32_dpp v0, v0, v0 quad_perm:[1,0,3,2] row_mask:0xf bank_mask:0xf
    s_nop 1
    v_add_f32_dpp v0, v0, v0 quad_perm:[2,3,0,1] row_mask:0xf bank_mask:0xf
    s_nop 1
    v_add_f32_dpp v0, v0, v0 row_half_mirror row_mask:0xf bank_mask:0xf
    v_mul_f32 v0, s60, v0
    v_add_f32 v0, s68, v0
    v_add_f32 v3, v0, v37
    v_cmp_lt_f32 vcc, 0, v3
    s_cbranch_vccz Lskip_57
    s_swappc_b64 s[62:63], s[94:95]
Lskip_57:
    v_exp_f32 v4, v3
    s_nop 0
    v_add_f32 v36, v36, v4
    v_cvt_pk_bf16_f32 v4, v4, v4
    v_and_b32 v0, v4, v8
    v_and_b32 v1, v4, v9
    v_and_b32 v2, v4, v10
    v_and_b32 v3, v4, v11
    s_waitcnt vmcnt(12)
    s_nop 1
    v_mfma_f32_16x16x32_bf16 v[24:27], v[0:3], a[228:231], v[24:27]
    v_mfma_f32_16x16x32_bf16 v[28:31], v[0:3], a[232:235], v[28:31]
    v_mfma_f32_16x16x32_bf16 v[32:35], v[0:3], a[236:239], v[32:35]
    s_add_u32 s71, s74, 79872
    buffer_load_dwordx4 v[64:67], v5, s[52:55], s71 offen offset:0 nt
    buffer_load_dwordx4 v[68:71], v5, s[52:55], s71 offen offset:128 nt
    buffer_load_dwordx4 v[72:75], v5, s[52:55], s71 offen offset:256 nt
    s_add_u32 s71, s74, 79872
    buffer_load_dwordx4 v[76:79], v5, s[56:59], s71 offen offset:0 nt
    buffer_load_dwordx4 v[80:83], v5, s[56:59], s71 offen offset:128 nt
    buffer_load_dwordx4 v[84:87], v5, s[56:59], s71 offen offset:256 nt
    s_waitcnt vmcnt(15)
    s_waitcnt lgkmcnt(0)
    v_mov_b32 v0, 0
    v_mov_b32 v1, 0
    v_mov_b32 v2, 0
    v_dot2c_f32_bf16 v0, v244, v12
    v_dot2c_f32_bf16 v1, v248, v16
    v_dot2c_f32_bf16 v2, v252, v20
    v_dot2c_f32_bf16 v0, v245, v13
    v_dot2c_f32_bf16 v1, v249, v17
    v_dot2c_f32_bf16 v2, v253, v21
    v_dot2c_f32_bf16 v0, v246, v14
    v_dot2c_f32_bf16 v1, v250, v18
    v_dot2c_f32_bf16 v2, v254, v22
    v_dot2c_f32_bf16 v0, v247, v15
    v_dot2c_f32_bf16 v1, v251, v19
    v_dot2c_f32_bf16 v2, v255, v23
    s_nop 1
    v_add_f32 v0, v0, v1
    v_add_f32 v0, v0, v2
    s_nop 1
    v_add_f32_dpp v0, v0, v0 quad_perm:[1,0,3,2] row_mask:0xf bank_mask:0xf
    s_nop 1
    v_add_f32_dpp v0, v0, v0 quad_perm:[2,3,0,1] row_mask:0xf bank_mask:0xf
    s_nop 1
    v_add_f32_dpp v0, v0, v0 row_half_mirror row_mask:0xf bank_mask:0xf
    v_mul_f32 v0, s60, v0
    v_add_f32 v0, s68, v0
    v_add_f32 v3, v0, v37
    v_cmp_lt_f32 vcc, 0, v3
    s_cbranch_vccz Lskip_58
    s_swappc_b64 s[62:63], s[94:95]
Lskip_58:
    v_exp_f32 v4, v3
    s_nop 0
    v_add_f32 v36, v36, v4
    v_cvt_pk_bf16_f32 v4, v4, v4
    v_and_b32 v0, v4, v8
    v_and_b32 v1, v4, v9
    v_and_b32 v2, v4, v10
    v_and_b32 v3, v4, v11
    s_waitcnt vmcnt(12)
    s_nop 1
    v_mfma_f32_16x16x32_bf16 v[24:27], v[0:3], a[240:243], v[24:27]
    v_mfma_f32_16x16x32_bf16 v[28:31], v[0:3], a[244:247], v[28:31]
    v_mfma_f32_16x16x32_bf16 v[32:35], v[0:3], a[248:251], v[32:35]
    s_cmp_eq_u32 s73, 0
    s_cbranch_scc1 Lnoswap_59
    s_cmp_ge_u32 s73, 4
    s_cbranch_scc1 Lfin_60
    s_mul_i32 s77, s73, 851968
    s_add_u32 s77, s77, s84
    v_accvgpr_read_b32 v4, a253
    s_nop 7
    v_mov_b32 v12, v24
    v_mov_b32 v13, v25
    v_mov_b32 v14, v26
    v_mov_b32 v15, v27
    v_mov_b32 v16, v28
    v_mov_b32 v17, v29
    v_mov_b32 v18, v30
    v_mov_b32 v19, v31
    v_mov_b32 v20, v32
    v_mov_b32 v21, v33
    v_mov_b32 v22, v34
    v_mov_b32 v23, v35
    v_max_f32_dpp v0, v36, v36 row_ror:8 row_mask:0xf bank_mask:0xf
    v_permlane32_swap_b32 v24, v12
    v_permlane32_swap_b32 v25, v13
    v_permlane32_swap_b32 v26, v14
    v_permlane32_swap_b32 v27, v15
    v_permlane32_swap_b32 v28, v16
    v_permlane32_swap_b32 v29, v17
    v_permlane32_swap_b32 v30, v18
    v_permlane32_swap_b32 v31, v19
    v_permlane32_swap_b32 v32, v20
    v_permlane32_swap_b32 v33, v21
    v_permlane32_swap_b32 v34, v22
    v_permlane32_swap_b32 v35, v23
    s_nop 1
    v_add_f32_dpp v24, v12, v24 row_ror:8 row_mask:0xf bank_mask:0xf
    v_add_f32_dpp v25, v13, v25 row_ror:8 row_mask:0xf bank_mask:0xf
    v_add_f32_dpp v26, v14, v26 row_ror:8 row_mask:0xf bank_mask:0xf
    v_add_f32_dpp v27, v15, v27 row_ror:8 row_mask:0xf bank_mask:0xf
    v_add_f32_dpp v28, v16, v28 row_ror:8 row_mask:0xf bank_mask:0xf
    v_add_f32_dpp v29, v17, v29 row_ror:8 row_mask:0xf bank_mask:0xf
    v_add_f32_dpp v30, v18, v30 row_ror:8 row_mask:0xf bank_mask:0xf
    v_add_f32_dpp v31, v19, v31 row_ror:8 row_mask:0xf bank_mask:0xf
    v_add_f32_dpp v32, v20, v32 row_ror:8 row_mask:0xf bank_mask:0xf
    v_add_f32_dpp v33, v21, v33 row_ror:8 row_mask:0xf bank_mask:0xf
    v_add_f32_dpp v34, v22, v34 row_ror:8 row_mask:0xf bank_mask:0xf
    v_add_f32_dpp v35, v23, v35 row_ror:8 row_mask:0xf bank_mask:0xf
    v_add_f32_dpp v0, v36, v36 row_ror:8 row_mask:0xf bank_mask:0xf
    v_mov_b32 v1, v0
    s_nop 1
    v_permlane16_swap_b32 v0, v1
    s_nop 1
    v_add_f32 v0, v0, v1
    v_mov_b32 v1, v0
    s_nop 1
    v_permlane32_swap_b32 v0, v1
    s_nop 1
    v_add_f32 v13, v0, v1
    v_sub_f32 v12, 0, v37
    v_min_u32 v24, -2, v24
    v_min_u32 v25, -2, v25
    v_min_u32 v26, -2, v26
    v_min_u32 v27, -2, v27
    v_min_u32 v28, -2, v28
    v_min_u32 v29, -2, v29
    v_min_u32 v30, -2, v30
    v_min_u32 v31, -2, v31
    v_min_u32 v32, -2, v32
    v_min_u32 v33, -2, v33
    v_min_u32 v34, -2, v34
    v_min_u32 v35, -2, v35
    v_min_u32 v12, -2, v12
    v_min_u32 v13, -2, v13
    s_mov_b64 exec, s[64:65]
    buffer_store_dwordx4 v[24:27], v4, s[28:31], s77 offen offset:0 sc1
    buffer_store_dwordx4 v[28:31], v4, s[28:31], s77 offen offset:256 sc1
    buffer_store_dwordx4 v[32:35], v4, s[28:31], s77 offen offset:512 sc1
    s_mov_b64 exec, 1
    buffer_store_dwordx2 v[12:13], v4, s[28:31], s77 offen offset:768 sc1
    s_mov_b64 exec, -1
    s_nop 1
    s_nop 1
    v_mov_b32 v12, v88
    v_mov_b32 v24, v100
    v_mov_b32 v13, v89
    v_mov_b32 v25, v101
    v_mov_b32 v14, v90
    v_mov_b32 v26, v102
    v_mov_b32 v15, v91
    v_mov_b32 v27, v103
    v_mov_b32 v16, v92
    v_mov_b32 v28, v104
    v_mov_b32 v17, v93
    v_mov_b32 v29, v105
    v_mov_b32 v18, v94
    v_mov_b32 v30, v106
    v_mov_b32 v19, v95
    v_mov_b32 v31, v107
    v_mov_b32 v20, v96
    v_mov_b32 v32, v108
    v_mov_b32 v21, v97
    v_mov_b32 v33, v109
    v_mov_b32 v22, v98
    v_mov_b32 v34, v110
    v_mov_b32 v23, v99
    v_mov_b32 v35, v111
    v_mov_b32 v36, v7
    v_mov_b32 v37, v38
    s_branch Lnoswap_59
Lfin_60:
    s_nop 7
    v_min_f32 v0, v37, v38
    v_sub_f32 v1, v0, v37
    v_sub_f32 v2, v0, v38
    v_exp_f32 v1, v1
    v_exp_f32 v2, v2
    v_mov_b32 v37, v0
    v_mul_f32 v36, v36, v1
    v_fmac_f32 v36, v7, v2
    v_mul_f32 v24, v24, v1
    v_fmac_f32 v24, v100, v2
    v_mul_f32 v25, v25, v1
    v_fmac_f32 v25, v101, v2
    v_mul_f32 v26, v26, v1
    v_fmac_f32 v26, v102, v2
    v_mul_f32 v27, v27, v1
    v_fmac_f32 v27, v103, v2
    v_mul_f32 v28, v28, v1
    v_fmac_f32 v28, v104, v2
    v_mul_f32 v29, v29, v1
    v_fmac_f32 v29, v105, v2
    v_mul_f32 v30, v30, v1
    v_fmac_f32 v30, v106, v2
    v_mul_f32 v31, v31, v1
    v_fmac_f32 v31, v107, v2
    v_mul_f32 v32, v32, v1
    v_fmac_f32 v32, v108, v2
    v_mul_f32 v33, v33, v1
    v_fmac_f32 v33, v109, v2
    v_mul_f32 v34, v34, v1
    v_fmac_f32 v34, v110, v2
    v_mul_f32 v35, v35, v1
    v_fmac_f32 v35, v111, v2
    s_add_u32 s77, s84, 5963776
    v_accvgpr_read_b32 v4, a253
    s_nop 7
    v_mov_b32 v12, v24
    v_mov_b32 v13, v25
    v_mov_b32 v14, v26
    v_mov_b32 v15, v27
    v_mov_b32 v16, v28
    v_mov_b32 v17, v29
    v_mov_b32 v18, v30
    v_mov_b32 v19, v31
    v_mov_b32 v20, v32
    v_mov_b32 v21, v33
    v_mov_b32 v22, v34
    v_mov_b32 v23, v35
    v_max_f32_dpp v0, v36, v36 row_ror:8 row_mask:0xf bank_mask:0xf
    v_permlane32_swap_b32 v24, v12
    v_permlane32_swap_b32 v25, v13
    v_permlane32_swap_b32 v26, v14
    v_permlane32_swap_b32 v27, v15
    v_permlane32_swap_b32 v28, v16
    v_permlane32_swap_b32 v29, v17
    v_permlane32_swap_b32 v30, v18
    v_permlane32_swap_b32 v31, v19
    v_permlane32_swap_b32 v32, v20
    v_permlane32_swap_b32 v33, v21
    v_permlane32_swap_b32 v34, v22
    v_permlane32_swap_b32 v35, v23
    s_nop 1
    v_add_f32_dpp v24, v12, v24 row_ror:8 row_mask:0xf bank_mask:0xf
    v_add_f32_dpp v25, v13, v25 row_ror:8 row_mask:0xf bank_mask:0xf
    v_add_f32_dpp v26, v14, v26 row_ror:8 row_mask:0xf bank_mask:0xf
    v_add_f32_dpp v27, v15, v27 row_ror:8 row_mask:0xf bank_mask:0xf
    v_add_f32_dpp v28, v16, v28 row_ror:8 row_mask:0xf bank_mask:0xf
    v_add_f32_dpp v29, v17, v29 row_ror:8 row_mask:0xf bank_mask:0xf
    v_add_f32_dpp v30, v18, v30 row_ror:8 row_mask:0xf bank_mask:0xf
    v_add_f32_dpp v31, v19, v31 row_ror:8 row_mask:0xf bank_mask:0xf
    v_add_f32_dpp v32, v20, v32 row_ror:8 row_mask:0xf bank_mask:0xf
    v_add_f32_dpp v33, v21, v33 row_ror:8 row_mask:0xf bank_mask:0xf
    v_add_f32_dpp v34, v22, v34 row_ror:8 row_mask:0xf bank_mask:0xf
    v_add_f32_dpp v35, v23, v35 row_ror:8 row_mask:0xf bank_mask:0xf
    v_add_f32_dpp v0, v36, v36 row_ror:8 row_mask:0xf bank_mask:0xf
    v_mov_b32 v1, v0
    s_nop 1
    v_permlane16_swap_b32 v0, v1
    s_nop 1
    v_add_f32 v0, v0, v1
    v_mov_b32 v1, v0
    s_nop 1
    v_permlane32_swap_b32 v0, v1
    s_nop 1
    v_add_f32 v13, v0, v1
    v_sub_f32 v12, 0, v37
    v_min_u32 v24, -2, v24
    v_min_u32 v25, -2, v25
    v_min_u32 v26, -2, v26
    v_min_u32 v27, -2, v27
    v_min_u32 v28, -2, v28
    v_min_u32 v29, -2, v29
    v_min_u32 v30, -2, v30
    v_min_u32 v31, -2, v31
    v_min_u32 v32, -2, v32
    v_min_u32 v33, -2, v33
    v_min_u32 v34, -2, v34
    v_min_u32 v35, -2, v35
    v_min_u32 v12, -2, v12
    v_min_u32 v13, -2, v13
    s_mov_b64 exec, s[64:65]
    buffer_store_dwordx4 v[24:27], v4, s[28:31], s77 offen offset:0 sc1
    buffer_store_dwordx4 v[28:31], v4, s[28:31], s77 offen offset:256 sc1
    buffer_store_dwordx4 v[32:35], v4, s[28:31], s77 offen offset:512 sc1
    s_mov_b64 exec, 1
    buffer_store_dwordx2 v[12:13], v4, s[28:31], s77 offen offset:768 sc1
    s_mov_b64 exec, -1
    s_nop 1
    s_waitcnt vmcnt(0)
    s_branch L_end
Lnoswap_59:
    s_add_u32 s71, s74, 159744
    buffer_load_dwordx4 v[88:91], v5, s[52:55], s71 offen offset:0 nt
    buffer_load_dwordx4 v[92:95], v5, s[52:55], s71 offen offset:128 nt
    buffer_load_dwordx4 v[96:99], v5, s[52:55], s71 offen offset:256 nt
    s_add_u32 s71, s74, 159744
    buffer_load_dwordx4 v[100:103], v5, s[56:59], s71 offen offset:0 nt
    buffer_load_dwordx4 v[104:107], v5, s[56:59], s71 offen offset:128 nt
    buffer_load_dwordx4 v[108:111], v5, s[56:59], s71 offen offset:256 nt
    s_add_u32 s73, s73, 1
    s_mov_b32 s89, 0
    s_mul_i32 s76, s73, 100663296
    s_cmp_ge_u32 s73, 4
    s_cselect_b32 s76, 303826944, s76
L_seg0:
    s_cmp_eq_u32 s92, 1
    s_cbranch_scc1 Linid_61
    buffer_load_dword a254, off, s[32:35], 0 sc1
Linid_61:
    s_add_u32 s44, s72, 1
    s_lshl_b32 s45, s44, 2
    s_lshr_b64 s[82:83], s[80:81], s45
    s_and_b32 s43, s82, 7
    s_bfe_u32 s45, s82, 0x10003
    s_mul_i32 s87, s43, 12288
    s_add_u32 s87, s87, s85
    s_and_b32 s43, s43, 3
    s_mul_i32 s75, s43, 100663296
    s_mul_i32 s43, s45, 638976
    s_add_u32 s75, s75, s43
    s_add_u32 s75, s75, 1837056
    s_cmp_ge_u32 s44, 14
    s_cselect_b32 s75, 2130706432, s75
    s_lshl_b32 s44, s72, 2
    s_lshr_b64 s[82:83], s[80:81], s44
    s_and_b32 s78, s82, 7
    s_bfe_u32 s44, s82, 0x10003
    s_cmp_eq_u32 s44, 1
    s_cselect_b32 s67, s66, 0xff800000
    s_mov_b32 s43, 8844
    s_bitcmp0_b32 s43, s72
    s_cbranch_scc1 Lnoinit_62
    v_accvgpr_read_b32 v1, a252
    v_add_u32 v1, s88, v1
    ds_read_b128 v[12:15], v1 offset:39936
    ds_read_b128 v[16:19], v1 offset:40064
    ds_read_b128 v[20:23], v1 offset:40192
    v_mov_b32 v24, 0
    v_mov_b32 v25, 0
    v_mov_b32 v26, 0
    v_mov_b32 v27, 0
    v_mov_b32 v28, 0
    v_mov_b32 v29, 0
    v_mov_b32 v30, 0
    v_mov_b32 v31, 0
    v_mov_b32 v32, 0
    v_mov_b32 v33, 0
    v_mov_b32 v34, 0
    v_mov_b32 v35, 0
    v_mov_b32 v36, 0
    v_mov_b32 v37, 0x7f800000
    s_waitcnt lgkmcnt(0)
Lnoinit_62:
    s_mov_b32 s43, 9360
    s_bitcmp1_b32 s43, s72
    s_cselect_b32 s90, 1, 0
    s_add_u32 s43, s73, 3
    s_mul_i32 s86, s43, 12288
    s_add_u32 s86, s86, s85
    s_waitcnt vmcnt(15)
    v_mov_b32 v0, 0
    v_mov_b32 v1, 0
    v_mov_b32 v2, 0
    v_dot2c_f32_bf16 v0, v40, v12
    v_dot2c_f32_bf16 v1, v44, v16
    v_dot2c_f32_bf16 v2, v48, v20
    v_dot2c_f32_bf16 v0, v41, v13
    v_dot2c_f32_bf16 v1, v45, v17
    v_dot2c_f32_bf16 v2, v49, v21
    v_dot2c_f32_bf16 v0, v42, v14
    v_dot2c_f32_bf16 v1, v46, v18
    v_dot2c_f32_bf16 v2, v50, v22
    v_dot2c_f32_bf16 v0, v43, v15
    v_dot2c_f32_bf16 v1, v47, v19
    v_dot2c_f32_bf16 v2, v51, v23
    s_add_u32 s71, s74, 239616
    buffer_load_dwordx4 v[40:43], v5, s[52:55], s71 offen offset:0 nt
    buffer_load_dwordx4 v[44:47], v5, s[52:55], s71 offen offset:128 nt
    buffer_load_dwordx4 v[48:51], v5, s[52:55], s71 offen offset:256 nt
    s_nop 1
    v_add_f32 v0, v0, v1
    v_add_f32 v0, v0, v2
    s_nop 1
    v_add_f32_dpp v0, v0, v0 quad_perm:[1,0,3,2] row_mask:0xf bank_mask:0xf
    s_nop 1
    v_add_f32_dpp v0, v0, v0 quad_perm:[2,3,0,1] row_mask:0xf bank_mask:0xf
    s_nop 1
    v_add_f32_dpp v0, v0, v0 row_half_mirror row_mask:0xf bank_mask:0xf
    v_mul_f32 v0, s60, v0
    v_add_f32 v3, v0, v37
    v_cmp_lt_f32 vcc, 0, v3
    s_cbranch_vccz Lskip_63
    s_swappc_b64 s[62:63], s[94:95]
Lskip_63:
    v_exp_f32 v4, v3
    s_nop 0
    v_add_f32 v36, v36, v4
    v_cvt_pk_bf16_f32 v4, v4, v4
    v_and_b32 v0, v4, v8
    v_and_b32 v1, v4, v9
    v_and_b32 v2, v4, v10
    v_and_b32 v3, v4, v11
    s_waitcnt vmcnt(15)
    s_nop 1
    v_mfma_f32_16x16x32_bf16 v[24:27], v[0:3], v[52:55], v[24:27]
    v_mfma_f32_16x16x32_bf16 v[28:31], v[0:3], v[56:59], v[28:31]
    v_mfma_f32_16x16x32_bf16 v[32:35], v[0:3], v[60:63], v[32:35]
    s_add_u32 s71, s74, 239616
    buffer_load_dwordx4 v[52:55], v5, s[56:59], s71 offen offset:0 nt
    buffer_load_dwordx4 v[56:59], v5, s[56:59], s71 offen offset:128 nt
    buffer_load_dwordx4 v[60:63], v5, s[56:59], s71 offen offset:256 nt
    s_waitcnt vmcnt(15)
    v_mov_b32 v0, 0
    v_mov_b32 v1, 0
    v_mov_b32 v2, 0
    v_dot2c_f32_bf16 v0, v64, v12
    v_dot2c_f32_bf16 v1, v68, v16
    v_dot2c_f32_bf16 v2, v72, v20
    v_dot2c_f32_bf16 v0, v65, v13
    v_dot2c_f32_bf16 v1, v69, v17
    v_dot2c_f32_bf16 v2, v73, v21
    v_dot2c_f32_bf16 v0, v66, v14
    v_dot2c_f32_bf16 v1, v70, v18
    v_dot2c_f32_bf16 v2, v74, v22
    v_dot2c_f32_bf16 v0, v67, v15
    v_dot2c_f32_bf16 v1, v71, v19
    v_dot2c_f32_bf16 v2, v75, v23
    s_add_u32 s71, s74, 319488
    buffer_load_dwordx4 v[64:67], v5, s[52:55], s71 offen offset:0 nt
    buffer_load_dwordx4 v[68:71], v5, s[52:55], s71 offen offset:128 nt
    buffer_load_dwordx4 v[72:75], v5, s[52:55], s71 offen offset:256 nt
    s_nop 1
    v_add_f32 v0, v0, v1
    v_add_f32 v0, v0, v2
    s_nop 1
    v_add_f32_dpp v0, v0, v0 quad_perm:[1,0,3,2] row_mask:0xf bank_mask:0xf
    s_nop 1
    v_add_f32_dpp v0, v0, v0 quad_perm:[2,3,0,1] row_mask:0xf bank_mask:0xf
    s_nop 1
    v_add_f32_dpp v0, v0, v0 row_half_mirror row_mask:0xf bank_mask:0xf
    v_mul_f32 v0, s60, v0
    v_add_f32 v3, v0, v37
    v_cmp_lt_f32 vcc, 0, v3
    s_cbranch_vccz Lskip_64
    s_swappc_b64 s[62:63], s[94:95]
Lskip_64:
    v_exp_f32 v4, v3
    s_nop 0
    v_add_f32 v36, v36, v4
    v_cvt_pk_bf16_f32 v4, v4, v4
    v_and_b32 v0, v4, v8
    v_and_b32 v1, v4, v9
    v_and_b32 v2, v4, v10
    v_and_b32 v3, v4, v11
    s_waitcnt vmcnt(15)
    s_nop 1
    v_mfma_f32_16x16x32_bf16 v[24:27], v[0:3], v[76:79], v[24:27]
    v_mfma_f32_16x16x32_bf16 v[28:31], v[0:3], v[80:83], v[28:31]
    v_mfma_f32_16x16x32_bf16 v[32:35], v[0:3], v[84:87], v[32:35]
    s_add_u32 s71, s74, 319488
    buffer_load_dwordx4 v[76:79], v5, s[56:59], s71 offen offset:0 nt
    buffer_load_dwordx4 v[80:83], v5, s[56:59], s71 offen offset:128 nt
    buffer_load_dwordx4 v[84:87], v5, s[56:59], s71 offen offset:256 nt
    s_waitcnt vmcnt(15)
    v_mov_b32 v0, 0
    v_mov_b32 v1, 0
    v_mov_b32 v2, 0
    v_dot2c_f32_bf16 v0, v88, v12
    v_dot2c_f32_bf16 v1, v92, v16
    v_dot2c_f32_bf16 v2, v96, v20
    v_dot2c_f32_bf16 v0, v89, v13
    v_dot2c_f32_bf16 v1, v93, v17
    v_dot2c_f32_bf16 v2, v97, v21
    v_dot2c_f32_bf16 v0, v90, v14
    v_dot2c_f32_bf16 v1, v94, v18
    v_dot2c_f32_bf16 v2, v98, v22
    v_dot2c_f32_bf16 v0, v91, v15
    v_dot2c_f32_bf16 v1, v95, v19
    v_dot2c_f32_bf16 v2, v99, v23
    s_add_u32 s71, s74, 399360
    buffer_load_dwordx4 v[88:91], v5, s[52:55], s71 offen offset:0 nt
    buffer_load_dwordx4 v[92:95], v5, s[52:55], s71 offen offset:128 nt
    buffer_load_dwordx4 v[96:99], v5, s[52:55], s71 offen offset:256 nt
    s_nop 1
    v_add_f32 v0, v0, v1
    v_add_f32 v0, v0, v2
    s_nop 1
    v_add_f32_dpp v0, v0, v0 quad_perm:[1,0,3,2] row_mask:0xf bank_mask:0xf
    s_nop 1
    v_add_f32_dpp v0, v0, v0 quad_perm:[2,3,0,1] row_mask:0xf bank_mask:0xf
    s_nop 1
    v_add_f32_dpp v0, v0, v0 row_half_mirror row_mask:0xf bank_mask:0xf
    v_mul_f32 v0, s60, v0
    v_add_f32 v3, v0, v37
    v_cmp_lt_f32 vcc, 0, v3
    s_cbranch_vccz Lskip_65
    s_swappc_b64 s[62:63], s[94:95]
Lskip_65:
    v_exp_f32 v4, v3
    s_nop 0
    v_add_f32 v36, v36, v4
    v_cvt_pk_bf16_f32 v4, v4, v4
    v_and_b32 v0, v4, v8
    v_and_b32 v1, v4, v9
    v_and_b32 v2, v4, v10
    v_and_b32 v3, v4, v11
    s_waitcnt vmcnt(15)
    s_nop 1
    v_mfma_f32_16x16x32_bf16 v[24:27], v[0:3], v[100:103], v[24:27]
    v_mfma_f32_16x16x32_bf16 v[28:31], v[0:3], v[104:107], v[28:31]
    v_mfma_f32_16x16x32_bf16 v[32:35], v[0:3], v[108:111], v[32:35]
    s_add_u32 s71, s74, 399360
    buffer_load_dwordx4 v[100:103], v5, s[56:59], s71 offen offset:0 nt
    buffer_load_dwordx4 v[104:107], v5, s[56:59], s71 offen offset:128 nt
    buffer_load_dwordx4 v[108:111], v5, s[56:59], s71 offen offset:256 nt
    s_waitcnt vmcnt(15)
    v_mov_b32 v0, 0
    v_mov_b32 v1, 0
    v_mov_b32 v2, 0
    v_dot2c_f32_bf16 v0, v40, v12
    v_dot2c_f32_bf16 v1, v44, v16
    v_dot2c_f32_bf16 v2, v48, v20
    v_dot2c_f32_bf16 v0, v41, v13
    v_dot2c_f32_bf16 v1, v45, v17
    v_dot2c_f32_bf16 v2, v49, v21
    v_dot2c_f32_bf16 v0, v42, v14
    v_dot2c_f32_bf16 v1, v46, v18
    v_dot2c_f32_bf16 v2, v50, v22
    v_dot2c_f32_bf16 v0, v43, v15
    v_dot2c_f32_bf16 v1, v47, v19
    v_dot2c_f32_bf16 v2, v51, v23
    s_add_u32 s71, s74, 479232
    buffer_load_dwordx4 v[40:43], v5, s[52:55], s71 offen offset:0 nt
    buffer_load_dwordx4 v[44:47], v5, s[52:55], s71 offen offset:128 nt
    buffer_load_dwordx4 v[48:51], v5, s[52:55], s71 offen offset:256 nt
    s_nop 1
    v_add_f32 v0, v0, v1
    v_add_f32 v0, v0, v2
    s_nop 1
    v_add_f32_dpp v0, v0, v0 quad_perm:[1,0,3,2] row_mask:0xf bank_mask:0xf
    s_nop 1
    v_add_f32_dpp v0, v0, v0 quad_perm:[2,3,0,1] row_mask:0xf bank_mask:0xf
    s_nop 1
    v_add_f32_dpp v0, v0, v0 row_half_mirror row_mask:0xf bank_mask:0xf
    v_mul_f32 v0, s60, v0
    v_add_f32 v3, v0, v37
    v_cmp_lt_f32 vcc, 0, v3
    s_cbranch_vccz Lskip_66
    s_swappc_b64 s[62:63], s[94:95]
Lskip_66:
    v_exp_f32 v4, v3
    s_nop 0
    v_add_f32 v36, v36, v4
    v_cvt_pk_bf16_f32 v4, v4, v4
    v_and_b32 v0, v4, v8
    v_and_b32 v1, v4, v9
    v_and_b32 v2, v4, v10
    v_and_b32 v3, v4, v11
    s_waitcnt vmcnt(15)
    s_nop 1
    v_mfma_f32_16x16x32_bf16 v[24:27], v[0:3], v[52:55], v[24:27]
    v_mfma_f32_16x16x32_bf16 v[28:31], v[0:3], v[56:59], v[28:31]
    v_mfma_f32_16x16x32_bf16 v[32:35], v[0:3], v[60:63], v[32:35]
    s_add_u32 s71, s74, 479232
    buffer_load_dwordx4 v[52:55], v5, s[56:59], s71 offen offset:0 nt
    buffer_load_dwordx4 v[56:59], v5, s[56:59], s71 offen offset:128 nt
    buffer_load_dwordx4 v[60:63], v5, s[56:59], s71 offen offset:256 nt
    s_cmp_eq_u32 s90, 0
    s_cbranch_scc1 Lnoq2_67
    s_add_u32 m0, s88, 40320
    v_subrev_u32 v1, s88, v6
    s_mov_b64 exec, 0xffffff
    buffer_load_dwordx4 v1, s[28:31], s86 offen sc1 lds
    s_mov_b64 exec, -1
    s_branch Lnoqn_68
Lnoq2_67:
    s_mov_b32 s43, 4422
    s_bitcmp0_b32 s43, s72
    s_cbranch_scc1 Lnoqn_68
    s_add_u32 m0, s88, 39936
    v_subrev_u32 v1, s88, v6
    s_mov_b64 exec, 0xffffff
    buffer_load_dwordx4 v1, s[28:31], s87 offen sc1 lds
    s_mov_b64 exec, -1
Lnoqn_68:
    s_waitcnt vmcnt(15)
    v_mov_b32 v0, 0
    v_mov_b32 v1, 0
    v_mov_b32 v2, 0
    v_dot2c_f32_bf16 v0, v64, v12
    v_dot2c_f32_bf16 v1, v68, v16
    v_dot2c_f32_bf16 v2, v72, v20
    v_dot2c_f32_bf16 v0, v65, v13
    v_dot2c_f32_bf16 v1, v69, v17
    v_dot2c_f32_bf16 v2, v73, v21
    v_dot2c_f32_bf16 v0, v66, v14
    v_dot2c_f32_bf16 v1, v70, v18
    v_dot2c_f32_bf16 v2, v74, v22
    v_dot2c_f32_bf16 v0, v67, v15
    v_dot2c_f32_bf16 v1, v71, v19
    v_dot2c_f32_bf16 v2, v75, v23
    s_add_u32 s71, s74, 559104
    buffer_load_dwordx4 v[64:67], v5, s[52:55], s71 offen offset:0 nt
    buffer_load_dwordx4 v[68:71], v5, s[52:55], s71 offen offset:128 nt
    buffer_load_dwordx4 v[72:75], v5, s[52:55], s71 offen offset:256 nt
    s_nop 1
    v_add_f32 v0, v0, v1
    v_add_f32 v0, v0, v2
    s_nop 1
    v_add_f32_dpp v0, v0, v0 quad_perm:[1,0,3,2] row_mask:0xf bank_mask:0xf
    s_nop 1
    v_add_f32_dpp v0, v0, v0 quad_perm:[2,3,0,1] row_mask:0xf bank_mask:0xf
    s_nop 1
    v_add_f32_dpp v0, v0, v0 row_half_mirror row_mask:0xf bank_mask:0xf
    v_mul_f32 v0, s60, v0
    v_add_f32 v3, v0, v37
    v_cmp_lt_f32 vcc, 0, v3
    s_cbranch_vccz Lskip_69
    s_swappc_b64 s[62:63], s[94:95]
Lskip_69:
    v_exp_f32 v4, v3
    s_nop 0
    v_add_f32 v36, v36, v4
    v_cvt_pk_bf16_f32 v4, v4, v4
    v_and_b32 v0, v4, v8
    v_and_b32 v1, v4, v9
    v_and_b32 v2, v4, v10
    v_and_b32 v3, v4, v11
    s_waitcnt vmcnt(15)
    s_nop 1
    v_mfma_f32_16x16x32_bf16 v[24:27], v[0:3], v[76:79], v[24:27]
    v_mfma_f32_16x16x32_bf16 v[28:31], v[0:3], v[80:83], v[28:31]
    v_mfma_f32_16x16x32_bf16 v[32:35], v[0:3], v[84:87], v[32:35]
    s_add_u32 s71, s74, 559104
    buffer_load_dwordx4 v[76:79], v5, s[56:59], s71 offen offset:0 nt
    buffer_load_dwordx4 v[80:83], v5, s[56:59], s71 offen offset:128 nt
    buffer_load_dwordx4 v[84:87], v5, s[56:59], s71 offen offset:256 nt
    s_waitcnt vmcnt(15)
    v_mov_b32 v0, 0
    v_mov_b32 v1, 0
    v_mov_b32 v2, 0
    v_dot2c_f32_bf16 v0, v88, v12
    v_dot2c_f32_bf16 v1, v92, v16
    v_dot2c_f32_bf16 v2, v96, v20
    v_dot2c_f32_bf16 v0, v89, v13
    v_dot2c_f32_bf16 v1, v93, v17
    v_dot2c_f32_bf16 v2, v97, v21
    v_dot2c_f32_bf16 v0, v90, v14
    v_dot2c_f32_bf16 v1, v94, v18
    v_dot2c_f32_bf16 v2, v98, v22
    v_dot2c_f32_bf16 v0, v91, v15
    v_dot2c_f32_bf16 v1, v95, v19
    v_dot2c_f32_bf16 v2, v99, v23
    s_add_u32 s71, s74, 638976
    s_lshr_b32 s43, s67, 1
    s_max_u32 s71, s71, s43
    buffer_load_dwordx4 v[88:91], v5, s[52:55], s71 offen offset:0 nt
    buffer_load_dwordx4 v[92:95], v5, s[52:55], s71 offen offset:128 nt
    buffer_load_dwordx4 v[96:99], v5, s[52:55], s71 offen offset:256 nt
    s_nop 1
    v_add_f32 v0, v0, v1
    v_add_f32 v0, v0, v2
    s_nop 1
    v_add_f32_dpp v0, v0, v0 quad_perm:[1,0,3,2] row_mask:0xf bank_mask:0xf
    s_nop 1
    v_add_f32_dpp v0, v0, v0 quad_perm:[2,3,0,1] row_mask:0xf bank_mask:0xf
    s_nop 1
    v_add_f32_dpp v0, v0, v0 row_half_mirror row_mask:0xf bank_mask:0xf
    v_mul_f32 v0, s60, v0
    v_add_f32 v3, v0, v37
    v_cmp_lt_f32 vcc, 0, v3
    s_cbranch_vccz Lskip_70
    s_swappc_b64 s[62:63], s[94:95]
Lskip_70:
    v_exp_f32 v4, v3
    s_nop 0
    v_add_f32 v36, v36, v4
    v_cvt_pk_bf16_f32 v4, v4, v4
    v_and_b32 v0, v4, v8
    v_and_b32 v1, v4, v9
    v_and_b32 v2, v4, v10
    v_and_b32 v3, v4, v11
    s_waitcnt vmcnt(15)
    s_nop 1
    v_mfma_f32_16x16x32_bf16 v[24:27], v[0:3], v[100:103], v[24:27]
    v_mfma_f32_16x16x32_bf16 v[28:31], v[0:3], v[104:107], v[28:31]
    v_mfma_f32_16x16x32_bf16 v[32:35], v[0:3], v[108:111], v[32:35]
    s_add_u32 s71, s74, 638976
    s_lshr_b32 s43, s67, 1
    s_max_u32 s71, s71, s43
    buffer_load_dwordx4 v[100:103], v5, s[56:59], s71 offen offset:0 nt
    buffer_load_dwordx4 v[104:107], v5, s[56:59], s71 offen offset:128 nt
    buffer_load_dwordx4 v[108:111], v5, s[56:59], s71 offen offset:256 nt
    s_cmp_eq_u32 s90, 1
    s_cbranch_scc1 L_segtail
    s_waitcnt vmcnt(15)
    v_mov_b32 v0, 0
    v_mov_b32 v1, 0
    v_mov_b32 v2, 0
    v_dot2c_f32_bf16 v0, v40, v12
    v_dot2c_f32_bf16 v1, v44, v16
    v_dot2c_f32_bf16 v2, v48, v20
    v_dot2c_f32_bf16 v0, v41, v13
    v_dot2c_f32_bf16 v1, v45, v17
    v_dot2c_f32_bf16 v2, v49, v21
    v_dot2c_f32_bf16 v0, v42, v14
    v_dot2c_f32_bf16 v1, v46, v18
    v_dot2c_f32_bf16 v2, v50, v22
    v_dot2c_f32_bf16 v0, v43, v15
    v_dot2c_f32_bf16 v1, v47, v19
    v_dot2c_f32_bf16 v2, v51, v23
    s_add_u32 s71, s75, 0
    buffer_load_dwordx4 v[40:43], v5, s[52:55], s71 offen offset:0 nt
    buffer_load_dwordx4 v[44:47], v5, s[52:55], s71 offen offset:128 nt
    buffer_load_dwordx4 v[48:51], v5, s[52:55], s71 offen offset:256 nt
    s_nop 1
    v_add_f32 v0, v0, v1
    v_add_f32 v0, v0, v2
    s_nop 1
    v_add_f32_dpp v0, v0, v0 quad_perm:[1,0,3,2] row_mask:0xf bank_mask:0xf
    s_nop 1
    v_add_f32_dpp v0, v0, v0 quad_perm:[2,3,0,1] row_mask:0xf bank_mask:0xf
    s_nop 1
    v_add_f32_dpp v0, v0, v0 row_half_mirror row_mask:0xf bank_mask:0xf
    v_mul_f32 v0, s60, v0
    v_add_f32 v3, v0, v37
    v_cmp_lt_f32 vcc, 0, v3
    s_cbranch_vccz Lskip_71
    s_swappc_b64 s[62:63], s[94:95]
Lskip_71:
    v_exp_f32 v4, v3
    s_nop 0
    v_add_f32 v36, v36, v4
    v_cvt_pk_bf16_f32 v4, v4, v4
    v_and_b32 v0, v4, v8
    v_and_b32 v1, v4, v9
    v_and_b32 v2, v4, v10
    v_and_b32 v3, v4, v11
    s_waitcnt vmcnt(15)
    s_nop 1
    v_mfma_f32_16x16x32_bf16 v[24:27], v[0:3], v[52:55], v[24:27]
    v_mfma_f32_16x16x32_bf16 v[28:31], v[0:3], v[56:59], v[28:31]
    v_mfma_f32_16x16x32_bf16 v[32:35], v[0:3], v[60:63], v[32:35]
    s_add_u32 s71, s75, 0
    buffer_load_dwordx4 v[52:55], v5, s[56:59], s71 offen offset:0 nt
    buffer_load_dwordx4 v[56:59], v5, s[56:59], s71 offen offset:128 nt
    buffer_load_dwordx4 v[60:63], v5, s[56:59], s71 offen offset:256 nt
    s_waitcnt vmcnt(15)
    v_mov_b32 v0, 0
    v_mov_b32 v1, 0
    v_mov_b32 v2, 0
    v_dot2c_f32_bf16 v0, v64, v12
    v_dot2c_f32_bf16 v1, v68, v16
    v_dot2c_f32_bf16 v2, v72, v20
    v_dot2c_f32_bf16 v0, v65, v13
    v_dot2c_f32_bf16 v1, v69, v17
    v_dot2c_f32_bf16 v2, v73, v21
    v_dot2c_f32_bf16 v0, v66, v14
    v_dot2c_f32_bf16 v1, v70, v18
    v_dot2c_f32_bf16 v2, v74, v22
    v_dot2c_f32_bf16 v0, v67, v15
    v_dot2c_f32_bf16 v1, v71, v19
    v_dot2c_f32_bf16 v2, v75, v23
    s_add_u32 s71, s75, 79872
    buffer_load_dwordx4 v[64:67], v5, s[52:55], s71 offen offset:0 nt
    buffer_load_dwordx4 v[68:71], v5, s[52:55], s71 offen offset:128 nt
    buffer_load_dwordx4 v[72:75], v5, s[52:55], s71 offen offset:256 nt
    s_nop 1
    v_add_f32 v0, v0, v1
    v_add_f32 v0, v0, v2
    s_nop 1
    v_add_f32_dpp v0, v0, v0 quad_perm:[1,0,3,2] row_mask:0xf bank_mask:0xf
    s_nop 1
    v_add_f32_dpp v0, v0, v0 quad_perm:[2,3,0,1] row_mask:0xf bank_mask:0xf
    s_nop 1
    v_add_f32_dpp v0, v0, v0 row_half_mirror row_mask:0xf bank_mask:0xf
    v_mul_f32 v0, s60, v0
    v_add_f32 v3, v0, v37
    v_cmp_lt_f32 vcc, 0, v3
    s_cbranch_vccz Lskip_72
    s_swappc_b64 s[62:63], s[94:95]
Lskip_72:
    v_exp_f32 v4, v3
    s_nop 0
    v_add_f32 v36, v36, v4
    v_cvt_pk_bf16_f32 v4, v4, v4
    v_and_b32 v0, v4, v8
    v_and_b32 v1, v4, v9
    v_and_b32 v2, v4, v10
    v_and_b32 v3, v4, v11
    s_waitcnt vmcnt(15)
    s_nop 1
    v_mfma_f32_16x16x32_bf16 v[24:27], v[0:3], v[76:79], v[24:27]
    v_mfma_f32_16x16x32_bf16 v[28:31], v[0:3], v[80:83], v[28:31]
    v_mfma_f32_16x16x32_bf16 v[32:35], v[0:3], v[84:87], v[32:35]
    s_add_u32 s71, s75, 79872
    buffer_load_dwordx4 v[76:79], v5, s[56:59], s71 offen offset:0 nt
    buffer_load_dwordx4 v[80:83], v5, s[56:59], s71 offen offset:128 nt
    buffer_load_dwordx4 v[84:87], v5, s[56:59], s71 offen offset:256 nt
    s_waitcnt vmcnt(15)
    v_mov_b32 v0, 0
    v_mov_b32 v1, 0
    v_mov_b32 v2, 0
    v_dot2c_f32_bf16 v0, v88, v12
    v_dot2c_f32_bf16 v1, v92, v16
    v_dot2c_f32_bf16 v2, v96, v20
    v_dot2c_f32_bf16 v0, v89, v13
    v_dot2c_f32_bf16 v1, v93, v17
    v_dot2c_f32_bf16 v2, v97, v21
    v_dot2c_f32_bf16 v0, v90, v14
    v_dot2c_f32_bf16 v1, v94, v18
    v_dot2c_f32_bf16 v2, v98, v22
    v_dot2c_f32_bf16 v0, v91, v15
    v_dot2c_f32_bf16 v1, v95, v19
    v_dot2c_f32_bf16 v2, v99, v23
    s_add_u32 s71, s75, 159744
    buffer_load_dwordx4 v[88:91], v5, s[52:55], s71 offen offset:0 nt
    buffer_load_dwordx4 v[92:95], v5, s[52:55], s71 offen offset:128 nt
    buffer_load_dwordx4 v[96:99], v5, s[52:55], s71 offen offset:256 nt
    s_nop 1
    v_add_f32 v0, v0, v1
    v_add_f32 v0, v0, v2
    s_nop 1
    v_add_f32_dpp v0, v0, v0 quad_perm:[1,0,3,2] row_mask:0xf bank_mask:0xf
    s_nop 1
    v_add_f32_dpp v0, v0, v0 quad_perm:[2,3,0,1] row_mask:0xf bank_mask:0xf
    s_nop 1
    v_add_f32_dpp v0, v0, v0 row_half_mirror row_mask:0xf bank_mask:0xf
    v_mul_f32 v0, s60, v0
    v_add_f32 v0, s67, v0
    v_add_f32 v3, v0, v37
    v_cmp_lt_f32 vcc, 0, v3
    s_cbranch_vccz Lskip_73
    s_swappc_b64 s[62:63], s[94:95]
Lskip_73:
    v_exp_f32 v4, v3
    s_nop 0
    v_add_f32 v36, v36, v4
    v_cvt_pk_bf16_f32 v4, v4, v4
    v_and_b32 v0, v4, v8
    v_and_b32 v1, v4, v9
    v_and_b32 v2, v4, v10
    v_and_b32 v3, v4, v11
    s_waitcnt vmcnt(15)
    s_nop 1
    v_mfma_f32_16x16x32_bf16 v[24:27], v[0:3], v[100:103], v[24:27]
    v_mfma_f32_16x16x32_bf16 v[28:31], v[0:3], v[104:107], v[28:31]
    v_mfma_f32_16x16x32_bf16 v[32:35], v[0:3], v[108:111], v[32:35]
    s_add_u32 s71, s75, 159744
    buffer_load_dwordx4 v[100:103], v5, s[56:59], s71 offen offset:0 nt
    buffer_load_dwordx4 v[104:107], v5, s[56:59], s71 offen offset:128 nt
    buffer_load_dwordx4 v[108:111], v5, s[56:59], s71 offen offset:256 nt
    s_mov_b32 s43, 12614
    s_bitcmp0_b32 s43, s72
    s_cbranch_scc1 Lnopub_74
    s_cmp_eq_u32 s92, 1
    s_cbranch_scc1 Linid2_75
    s_mov_b32 s92, 1
    v_accvgpr_read_b32 v4, a254
    s_nop 0
    v_readfirstlane_b32 s43, v4
    s_cmp_ge_u32 s43, 48
    s_cbranch_scc1 Linid2_75
    s_nop 7
    s_mov_b32 s46, 0
    v_mov_b32 v1, 0
Lpoll_76:
    buffer_load_dword v0, v1, s[32:35], 0 offen sc1
    s_waitcnt vmcnt(0)
    v_readfirstlane_b32 s43, v0
    s_cmp_ge_u32 s43, 48
    s_cbranch_scc1 Lok_77
    s_sleep 16
    s_add_u32 s46, s46, 1
    s_cmp_lt_u32 s46, 524288
    s_cbranch_scc1 Lpoll_76
Lok_77:
Linid2_75:
    s_lshr_b32 s44, s78, 2
    s_add_u32 s44, s44, 8
    s_mov_b32 s43, 8196
    s_bitcmp1_b32 s43, s72
    s_cselect_b32 s43, s44, s78
    s_mul_i32 s77, s43, 851968
    s_add_u32 s77, s77, s84
    v_accvgpr_read_b32 v4, a253
    s_nop 7
    v_mov_b32 v12, v24
    v_mov_b32 v13, v25
    v_mov_b32 v14, v26
    v_mov_b32 v15, v27
    v_mov_b32 v16, v28
    v_mov_b32 v17, v29
    v_mov_b32 v18, v30
    v_mov_b32 v19, v31
    v_mov_b32 v20, v32
    v_mov_b32 v21, v33
    v_mov_b32 v22, v34
    v_mov_b32 v23, v35
    v_max_f32_dpp v0, v36, v36 row_ror:8 row_mask:0xf bank_mask:0xf
    v_permlane32_swap_b32 v24, v12
    v_permlane32_swap_b32 v25, v13
    v_permlane32_swap_b32 v26, v14
    v_permlane32_swap_b32 v27, v15
    v_permlane32_swap_b32 v28, v16
    v_permlane32_swap_b32 v29, v17
    v_permlane32_swap_b32 v30, v18
    v_permlane32_swap_b32 v31, v19
    v_permlane32_swap_b32 v32, v20
    v_permlane32_swap_b32 v33, v21
    v_permlane32_swap_b32 v34, v22
    v_permlane32_swap_b32 v35, v23
    s_nop 1
    v_add_f32_dpp v24, v12, v24 row_ror:8 row_mask:0xf bank_mask:0xf
    v_add_f32_dpp v25, v13, v25 row_ror:8 row_mask:0xf bank_mask:0xf
    v_add_f32_dpp v26, v14, v26 row_ror:8 row_mask:0xf bank_mask:0xf
    v_add_f32_dpp v27, v15, v27 row_ror:8 row_mask:0xf bank_mask:0xf
    v_add_f32_dpp v28, v16, v28 row_ror:8 row_mask:0xf bank_mask:0xf
    v_add_f32_dpp v29, v17, v29 row_ror:8 row_mask:0xf bank_mask:0xf
    v_add_f32_dpp v30, v18, v30 row_ror:8 row_mask:0xf bank_mask:0xf
    v_add_f32_dpp v31, v19, v31 row_ror:8 row_mask:0xf bank_mask:0xf
    v_add_f32_dpp v32, v20, v32 row_ror:8 row_mask:0xf bank_mask:0xf
    v_add_f32_dpp v33, v21, v33 row_ror:8 row_mask:0xf bank_mask:0xf
    v_add_f32_dpp v34, v22, v34 row_ror:8 row_mask:0xf bank_mask:0xf
    v_add_f32_dpp v35, v23, v35 row_ror:8 row_mask:0xf bank_mask:0xf
    v_add_f32_dpp v0, v36, v36 row_ror:8 row_mask:0xf bank_mask:0xf
    v_mov_b32 v1, v0
    s_nop 1
    v_permlane16_swap_b32 v0, v1
    s_nop 1
    v_add_f32 v0, v0, v1
    v_mov_b32 v1, v0
    s_nop 1
    v_permlane32_swap_b32 v0, v1
    s_nop 1
    v_add_f32 v13, v0, v1
    v_sub_f32 v12, 0, v37
    v_min_u32 v24, -2, v24
    v_min_u32 v25, -2, v25
    v_min_u32 v26, -2, v26
    v_min_u32 v27, -2, v27
    v_min_u32 v28, -2, v28
    v_min_u32 v29, -2, v29
    v_min_u32 v30, -2, v30
    v_min_u32 v31, -2, v31
    v_min_u32 v32, -2, v32
    v_min_u32 v33, -2, v33
    v_min_u32 v34, -2, v34
    v_min_u32 v35, -2, v35
    v_min_u32 v12, -2, v12
    v_min_u32 v13, -2, v13
    s_mov_b64 exec, s[64:65]
    buffer_store_dwordx4 v[24:27], v4, s[28:31], s77 offen offset:0 sc1
    buffer_store_dwordx4 v[28:31], v4, s[28:31], s77 offen offset:256 sc1
    buffer_store_dwordx4 v[32:35], v4, s[28:31], s77 offen offset:512 sc1
    s_mov_b64 exec, 1
    buffer_store_dwordx2 v[12:13], v4, s[28:31], s77 offen offset:768 sc1
    s_mov_b64 exec, -1
    s_nop 1
Lnopub_74:
    s_add_u32 s72, s72, 1
    s_mov_b32 s74, s75
    s_branch L_seg0
L_segtail:
    s_waitcnt vmcnt(15)
    v_mov_b32 v0, 0
    v_mov_b32 v1, 0
    v_mov_b32 v2, 0
    v_dot2c_f32_bf16 v0, v40, v12
    v_dot2c_f32_bf16 v1, v44, v16
    v_dot2c_f32_bf16 v2, v48, v20
    v_dot2c_f32_bf16 v0, v41, v13
    v_dot2c_f32_bf16 v1, v45, v17
    v_dot2c_f32_bf16 v2, v49, v21
    v_dot2c_f32_bf16 v0, v42, v14
    v_dot2c_f32_bf16 v1, v46, v18
    v_dot2c_f32_bf16 v2, v50, v22
    v_dot2c_f32_bf16 v0, v43, v15
    v_dot2c_f32_bf16 v1, v47, v19
    v_dot2c_f32_bf16 v2, v51, v23
    s_nop 1
    v_add_f32 v0, v0, v1
    v_add_f32 v0, v0, v2
    s_nop 1
    v_add_f32_dpp v0, v0, v0 quad_perm:[1,0,3,2] row_mask:0xf bank_mask:0xf
    s_nop 1
    v_add_f32_dpp v0, v0, v0 quad_perm:[2,3,0,1] row_mask:0xf bank_mask:0xf
    s_nop 1
    v_add_f32_dpp v0, v0, v0 row_half_mirror row_mask:0xf bank_mask:0xf
    v_mul_f32 v0, s60, v0
    v_add_f32 v3, v0, v37
    v_cmp_lt_f32 vcc, 0, v3
    s_cbranch_vccz Lskip_78
    s_swappc_b64 s[62:63], s[94:95]
Lskip_78:
    v_exp_f32 v4, v3
    s_nop 0
    v_add_f32 v36, v36, v4
    v_cvt_pk_bf16_f32 v4, v4, v4
    v_and_b32 v0, v4, v8
    v_and_b32 v1, v4, v9
    v_and_b32 v2, v4, v10
    v_and_b32 v3, v4, v11
    s_waitcnt vmcnt(12)
    s_nop 1
    v_mfma_f32_16x16x32_bf16 v[24:27], v[0:3], v[52:55], v[24:27]
    v_mfma_f32_16x16x32_bf16 v[28:31], v[0:3], v[56:59], v[28:31]
    v_mfma_f32_16x16x32_bf16 v[32:35], v[0:3], v[60:63], v[32:35]
    s_waitcnt vmcnt(12)
    v_accvgpr_read_b32 v1, a252
    v_add_u32 v1, s88, v1
    ds_read_b128 v[40:43], v1 offset:40320
    ds_read_b128 v[44:47], v1 offset:40448
    ds_read_b128 v[48:51], v1 offset:40576
    s_waitcnt lgkmcnt(0)
    v_mov_b32 v0, 0
    v_max3_u32 v0, v40, v41, v0
    v_max3_u32 v0, v42, v43, v0
    v_max3_u32 v0, v44, v45, v0
    v_max3_u32 v0, v46, v47, v0
    v_max3_u32 v0, v48, v49, v0
    v_max3_u32 v0, v50, v51, v0
    v_cmp_eq_u32 vcc, -1, v0
    s_mov_b32 s91, 1
    s_cbranch_vccz Lq2ok_80
    s_mov_b32 s91, 0
    s_mov_b32 s46, 0
    v_accvgpr_read_b32 v1, a252
Lq2_79:
    buffer_load_dwordx4 v[40:43], v1, s[28:31], s86 offen offset:0 sc1
    buffer_load_dwordx4 v[44:47], v1, s[28:31], s86 offen offset:128 sc1
    buffer_load_dwordx4 v[48:51], v1, s[28:31], s86 offen offset:256 sc1
    s_waitcnt vmcnt(0)
    v_mov_b32 v0, 0
    v_max3_u32 v0, v40, v41, v0
    v_max3_u32 v0, v42, v43, v0
    v_max3_u32 v0, v44, v45, v0
    v_max3_u32 v0, v46, v47, v0
    v_max3_u32 v0, v48, v49, v0
    v_max3_u32 v0, v50, v51, v0
    v_cmp_eq_u32 vcc, -1, v0
    s_cbranch_vccz Lq2ok_80
    s_sleep 4
    s_add_u32 s46, s46, 1
    s_cmp_lt_u32 s46, 524288
    s_cbranch_scc1 Lq2_79
Lq2ok_80:
    v_mov_b32 v52, 0
    v_mov_b32 v53, 0
    v_mov_b32 v54, 0
    v_mov_b32 v55, 0
    v_mov_b32 v56, 0
    v_mov_b32 v57, 0
    v_mov_b32 v58, 0
    v_mov_b32 v59, 0
    v_mov_b32 v60, 0
    v_mov_b32 v61, 0
    v_mov_b32 v62, 0
    v_mov_b32 v63, 0
    v_mov_b32 v7, 0
    v_mov_b32 v38, 0x7f800000
    v_mov_b32 v0, 0
    v_mov_b32 v1, 0
    v_mov_b32 v2, 0
    v_dot2c_f32_bf16 v0, v112, v40
    v_dot2c_f32_bf16 v1, v116, v44
    v_dot2c_f32_bf16 v2, v120, v48
    v_dot2c_f32_bf16 v0, v113, v41
    v_dot2c_f32_bf16 v1, v117, v45
    v_dot2c_f32_bf16 v2, v121, v49
    v_dot2c_f32_bf16 v0, v114, v42
    v_dot2c_f32_bf16 v1, v118, v46
    v_dot2c_f32_bf16 v2, v122, v50
    v_dot2c_f32_bf16 v0, v115, v43
    v_dot2c_f32_bf16 v1, v119, v47
    v_dot2c_f32_bf16 v2, v123, v51
    s_nop 1
    v_add_f32 v0, v0, v1
    v_add_f32 v0, v0, v2
    s_nop 1
    v_add_f32_dpp v0, v0, v0 quad_perm:[1,0,3,2] row_mask:0xf bank_mask:0xf
    s_nop 1
    v_add_f32_dpp v0, v0, v0 quad_perm:[2,3,0,1] row_mask:0xf bank_mask:0xf
    s_nop 1
    v_add_f32_dpp v0, v0, v0 row_half_mirror row_mask:0xf bank_mask:0xf
    v_mul_f32 v0, s60, v0
    v_add_f32 v3, v0, v38
    v_cmp_lt_f32 vcc, 0, v3
    s_cbranch_vccz Lskip_81
    s_swappc_b64 s[62:63], s[96:97]
Lskip_81:
    v_exp_f32 v4, v3
    s_nop 0
    v_add_f32 v7, v7, v4
    v_cvt_pk_bf16_f32 v4, v4, v4
    v_and_b32 v0, v4, v8
    v_and_b32 v1, v4, v9
    v_and_b32 v2, v4, v10
    v_and_b32 v3, v4, v11
    s_nop 1
    v_mfma_f32_16x16x32_bf16 v[52:55], v[0:3], a[0:3], v[52:55]
    v_mfma_f32_16x16x32_bf16 v[56:59], v[0:3], a[4:7], v[56:59]
    v_mfma_f32_16x16x32_bf16 v[60:63], v[0:3], a[8:11], v[60:63]
    s_add_u32 s71, s76, 0
    buffer_load_dwordx4 v[112:115], v5, s[52:55], s71 offen offset:0 nt
    buffer_load_dwordx4 v[116:119], v5, s[52:55], s71 offen offset:128 nt
    buffer_load_dwordx4 v[120:123], v5, s[52:55], s71 offen offset:256 nt
    buffer_load_dwordx4 a[0:3], v5, s[56:59], s71 offen offset:0 nt
    buffer_load_dwordx4 a[4:7], v5, s[56:59], s71 offen offset:128 nt
    buffer_load_dwordx4 a[8:11], v5, s[56:59], s71 offen offset:256 nt
    v_mov_b32 v0, 0
    v_mov_b32 v1, 0
    v_mov_b32 v2, 0
    v_dot2c_f32_bf16 v0, v124, v40
    v_dot2c_f32_bf16 v1, v128, v44
    v_dot2c_f32_bf16 v2, v132, v48
    v_dot2c_f32_bf16 v0, v125, v41
    v_dot2c_f32_bf16 v1, v129, v45
    v_dot2c_f32_bf16 v2, v133, v49
    v_dot2c_f32_bf16 v0, v126, v42
    v_dot2c_f32_bf16 v1, v130, v46
    v_dot2c_f32_bf16 v2, v134, v50
    v_dot2c_f32_bf16 v0, v127, v43
    v_dot2c_f32_bf16 v1, v131, v47
    v_dot2c_f32_bf16 v2, v135, v51
    s_nop 1
    v_add_f32 v0, v0, v1
    v_add_f32 v0, v0, v2
    s_nop 1
    v_add_f32_dpp v0, v0, v0 quad_perm:[1,0,3,2] row_mask:0xf bank_mask:0xf
    s_nop 1
    v_add_f32_dpp v0, v0, v0 quad_perm:[2,3,0,1] row_mask:0xf bank_mask:0xf
    s_nop 1
    v_add_f32_dpp v0, v0, v0 row_half_mirror row_mask:0xf bank_mask:0xf
    v_mul_f32 v0, s60, v0
    v_add_f32 v3, v0, v38
    v_cmp_lt_f32 vcc, 0, v3
    s_cbranch_vccz Lskip_82
    s_swappc_b64 s[62:63], s[96:97]
Lskip_82:
    v_exp_f32 v4, v3
    s_nop 0
    v_add_f32 v7, v7, v4
    v_cvt_pk_bf16_f32 v4, v4, v4
    v_and_b32 v0, v4, v8
    v_and_b32 v1, v4, v9
    v_and_b32 v2, v4, v10
    v_and_b32 v3, v4, v11
    s_nop 1
    v_mfma_f32_16x16x32_bf16 v[52:55], v[0:3], a[12:15], v[52:55]
    v_mfma_f32_16x16x32_bf16 v[56:59], v[0:3], a[16:19], v[56:59]
    v_mfma_f32_16x16x32_bf16 v[60:63], v[0:3], a[20:23], v[60:63]
    s_add_u32 s71, s76, 79872
    buffer_load_dwordx4 v[124:127], v5, s[52:55], s71 offen offset:0 nt
    buffer_load_dwordx4 v[128:131], v5, s[52:55], s71 offen offset:128 nt
    buffer_load_dwordx4 v[132:135], v5, s[52:55], s71 offen offset:256 nt
    buffer_load_dwordx4 a[12:15], v5, s[56:59], s71 offen offset:0 nt
    buffer_load_dwordx4 a[16:19], v5, s[56:59], s71 offen offset:128 nt
    buffer_load_dwordx4 a[20:23], v5, s[56:59], s71 offen offset:256 nt
    v_mov_b32 v0, 0
    v_mov_b32 v1, 0
    v_mov_b32 v2, 0
    v_dot2c_f32_bf16 v0, v136, v40
    v_dot2c_f32_bf16 v1, v140, v44
    v_dot2c_f32_bf16 v2, v144, v48
    v_dot2c_f32_bf16 v0, v137, v41
    v_dot2c_f32_bf16 v1, v141, v45
    v_dot2c_f32_bf16 v2, v145, v49
    v_dot2c_f32_bf16 v0, v138, v42
    v_dot2c_f32_bf16 v1, v142, v46
    v_dot2c_f32_bf16 v2, v146, v50
    v_dot2c_f32_bf16 v0, v139, v43
    v_dot2c_f32_bf16 v1, v143, v47
    v_dot2c_f32_bf16 v2, v147, v51
    s_nop 1
    v_add_f32 v0, v0, v1
    v_add_f32 v0, v0, v2
    s_nop 1
    v_add_f32_dpp v0, v0, v0 quad_perm:[1,0,3,2] row_mask:0xf bank_mask:0xf
    s_nop 1
    v_add_f32_dpp v0, v0, v0 quad_perm:[2,3,0,1] row_mask:0xf bank_mask:0xf
    s_nop 1
    v_add_f32_dpp v0, v0, v0 row_half_mirror row_mask:0xf bank_mask:0xf
    v_mul_f32 v0, s60, v0
    v_add_f32 v3, v0, v38
    v_cmp_lt_f32 vcc, 0, v3
    s_cbranch_vccz Lskip_83
    s_swappc_b64 s[62:63], s[96:97]
Lskip_83:
    v_exp_f32 v4, v3
    s_nop 0
    v_add_f32 v7, v7, v4
    v_cvt_pk_bf16_f32 v4, v4, v4
    v_and_b32 v0, v4, v8
    v_and_b32 v1, v4, v9
    v_and_b32 v2, v4, v10
    v_and_b32 v3, v4, v11
    s_nop 1
    v_mfma_f32_16x16x32_bf16 v[52:55], v[0:3], a[24:27], v[52:55]
    v_mfma_f32_16x16x32_bf16 v[56:59], v[0:3], a[28:31], v[56:59]
    v_mfma_f32_16x16x32_bf16 v[60:63], v[0:3], a[32:35], v[60:63]
    s_add_u32 s71, s76, 159744
    buffer_load_dwordx4 v[136:139], v5, s[52:55], s71 offen offset:0 nt
    buffer_load_dwordx4 v[140:143], v5, s[52:55], s71 offen offset:128 nt
    buffer_load_dwordx4 v[144:147], v5, s[52:55], s71 offen offset:256 nt
    buffer_load_dwordx4 a[24:27], v5, s[56:59], s71 offen offset:0 nt
    buffer_load_dwordx4 a[28:31], v5, s[56:59], s71 offen offset:128 nt
    buffer_load_dwordx4 a[32:35], v5, s[56:59], s71 offen offset:256 nt
    v_mov_b32 v0, 0
    v_mov_b32 v1, 0
    v_mov_b32 v2, 0
    v_dot2c_f32_bf16 v0, v148, v40
    v_dot2c_f32_bf16 v1, v152, v44
    v_dot2c_f32_bf16 v2, v156, v48
    v_dot2c_f32_bf16 v0, v149, v41
    v_dot2c_f32_bf16 v1, v153, v45
    v_dot2c_f32_bf16 v2, v157, v49
    v_dot2c_f32_bf16 v0, v150, v42
    v_dot2c_f32_bf16 v1, v154, v46
    v_dot2c_f32_bf16 v2, v158, v50
    v_dot2c_f32_bf16 v0, v151, v43
    v_dot2c_f32_bf16 v1, v155, v47
    v_dot2c_f32_bf16 v2, v159, v51
    s_nop 1
    v_add_f32 v0, v0, v1
    v_add_f32 v0, v0, v2
    s_nop 1
    v_add_f32_dpp v0, v0, v0 quad_perm:[1,0,3,2] row_mask:0xf bank_mask:0xf
    s_nop 1
    v_add_f32_dpp v0, v0, v0 quad_perm:[2,3,0,1] row_mask:0xf bank_mask:0xf
    s_nop 1
    v_add_f32_dpp v0, v0, v0 row_half_mirror row_mask:0xf bank_mask:0xf
    v_mul_f32 v0, s60, v0
    v_add_f32 v3, v0, v38
    v_cmp_lt_f32 vcc, 0, v3
    s_cbranch_vccz Lskip_84
    s_swappc_b64 s[62:63], s[96:97]
Lskip_84:
    v_exp_f32 v4, v3
    s_nop 0
    v_add_f32 v7, v7, v4
    v_cvt_pk_bf16_f32 v4, v4, v4
    v_and_b32 v0, v4, v8
    v_and_b32 v1, v4, v9
    v_and_b32 v2, v4, v10
    v_and_b32 v3, v4, v11
    s_nop 1
    v_mfma_f32_16x16x32_bf16 v[52:55], v[0:3], a[36:39], v[52:55]
    v_mfma_f32_16x16x32_bf16 v[56:59], v[0:3], a[40:43], v[56:59]
    v_mfma_f32_16x16x32_bf16 v[60:63], v[0:3], a[44:47], v[60:63]
    s_add_u32 s71, s76, 239616
    buffer_load_dwordx4 v[148:151], v5, s[52:55], s71 offen offset:0 nt
    buffer_load_dwordx4 v[152:155], v5, s[52:55], s71 offen offset:128 nt
    buffer_load_dwordx4 v[156:159], v5, s[52:55], s71 offen offset:256 nt
    buffer_load_dwordx4 a[36:39], v5, s[56:59], s71 offen offset:0 nt
    buffer_load_dwordx4 a[40:43], v5, s[56:59], s71 offen offset:128 nt
    buffer_load_dwordx4 a[44:47], v5, s[56:59], s71 offen offset:256 nt
    s_waitcnt vmcnt(33)
    v_mov_b32 v0, 0
    v_mov_b32 v1, 0
    v_mov_b32 v2, 0
    v_dot2c_f32_bf16 v0, v64, v12
    v_dot2c_f32_bf16 v1, v68, v16
    v_dot2c_f32_bf16 v2, v72, v20
    v_dot2c_f32_bf16 v0, v65, v13
    v_dot2c_f32_bf16 v1, v69, v17
    v_dot2c_f32_bf16 v2, v73, v21
    v_dot2c_f32_bf16 v0, v66, v14
    v_dot2c_f32_bf16 v1, v70, v18
    v_dot2c_f32_bf16 v2, v74, v22
    v_dot2c_f32_bf16 v0, v67, v15
    v_dot2c_f32_bf16 v1, v71, v19
    v_dot2c_f32_bf16 v2, v75, v23
    s_nop 1
    v_add_f32 v0, v0, v1
    v_add_f32 v0, v0, v2
    s_nop 1
    v_add_f32_dpp v0, v0, v0 quad_perm:[1,0,3,2] row_mask:0xf bank_mask:0xf
    s_nop 1
    v_add_f32_dpp v0, v0, v0 quad_perm:[2,3,0,1] row_mask:0xf bank_mask:0xf
    s_nop 1
    v_add_f32_dpp v0, v0, v0 row_half_mirror row_mask:0xf bank_mask:0xf
    v_mul_f32 v0, s60, v0
    v_add_f32 v3, v0, v37
    v_cmp_lt_f32 vcc, 0, v3
    s_cbranch_vccz Lskip_85
    s_swappc_b64 s[62:63], s[94:95]
Lskip_85:
    v_exp_f32 v4, v3
    s_nop 0
    v_add_f32 v36, v36, v4
    v_cvt_pk_bf16_f32 v4, v4, v4
    v_and_b32 v0, v4, v8
    v_and_b32 v1, v4, v9
    v_and_b32 v2, v4, v10
    v_and_b32 v3, v4, v11
    s_waitcnt vmcnt(30)
    s_nop 1
    v_mfma_f32_16x16x32_bf16 v[24:27], v[0:3], v[76:79], v[24:27]
    v_mfma_f32_16x16x32_bf16 v[28:31], v[0:3], v[80:83], v[28:31]
    v_mfma_f32_16x16x32_bf16 v[32:35], v[0:3], v[84:87], v[32:35]
    s_waitcnt vmcnt(27)
    v_mov_b32 v0, 0
    v_mov_b32 v1, 0
    v_mov_b32 v2, 0
    v_dot2c_f32_bf16 v0, v88, v12
    v_dot2c_f32_bf16 v1, v92, v16
    v_dot2c_f32_bf16 v2, v96, v20
    v_dot2c_f32_bf16 v0, v89, v13
    v_dot2c_f32_bf16 v1, v93, v17
    v_dot2c_f32_bf16 v2, v97, v21
    v_dot2c_f32_bf16 v0, v90, v14
    v_dot2c_f32_bf16 v1, v94, v18
    v_dot2c_f32_bf16 v2, v98, v22
    v_dot2c_f32_bf16 v0, v91, v15
    v_dot2c_f32_bf16 v1, v95, v19
    v_dot2c_f32_bf16 v2, v99, v23
    s_nop 1
    v_add_f32 v0, v0, v1
    v_add_f32 v0, v0, v2
    s_nop 1
    v_add_f32_dpp v0, v0, v0 quad_perm:[1,0,3,2] row_mask:0xf bank_mask:0xf
    s_nop 1
    v_add_f32_dpp v0, v0, v0 quad_perm:[2,3,0,1] row_mask:0xf bank_mask:0xf
    s_nop 1
    v_add_f32_dpp v0, v0, v0 row_half_mirror row_mask:0xf bank_mask:0xf
    v_mul_f32 v0, s60, v0
    v_add_f32 v0, s67, v0
    v_add_f32 v3, v0, v37
    v_cmp_lt_f32 vcc, 0, v3
    s_cbranch_vccz Lskip_86
    s_swappc_b64 s[62:63], s[94:95]
Lskip_86:
    v_exp_f32 v4, v3
    s_nop 0
    v_add_f32 v36, v36, v4
    v_cvt_pk_bf16_f32 v4, v4, v4
    v_and_b32 v0, v4, v8
    v_and_b32 v1, v4, v9
    v_and_b32 v2, v4, v10
    v_and_b32 v3, v4, v11
    s_waitcnt vmcnt(24)
    s_nop 1
    v_mfma_f32_16x16x32_bf16 v[24:27], v[0:3], v[100:103], v[24:27]
    v_mfma_f32_16x16x32_bf16 v[28:31], v[0:3], v[104:107], v[28:31]
    v_mfma_f32_16x16x32_bf16 v[32:35], v[0:3], v[108:111], v[32:35]
    s_mov_b32 s43, 12614
    s_bitcmp0_b32 s43, s72
    s_cbranch_scc1 Lnopub_87
    s_cmp_eq_u32 s92, 1
    s_cbranch_scc1 Linid2_88
    s_mov_b32 s92, 1
    v_accvgpr_read_b32 v4, a254
    s_nop 0
    v_readfirstlane_b32 s43, v4
    s_cmp_ge_u32 s43, 48
    s_cbranch_scc1 Linid2_88
    s_nop 7
    s_mov_b32 s46, 0
    v_mov_b32 v1, 0
Lpoll_89:
    buffer_load_dword v0, v1, s[32:35], 0 offen sc1
    s_waitcnt vmcnt(0)
    v_readfirstlane_b32 s43, v0
    s_cmp_ge_u32 s43, 48
    s_cbranch_scc1 Lok_90
    s_sleep 16
    s_add_u32 s46, s46, 1
    s_cmp_lt_u32 s46, 524288
    s_cbranch_scc1 Lpoll_89
Lok_90:
Linid2_88:
    s_lshr_b32 s44, s78, 2
    s_add_u32 s44, s44, 8
    s_mov_b32 s43, 8196
    s_bitcmp1_b32 s43, s72
    s_cselect_b32 s43, s44, s78
    s_mul_i32 s77, s43, 851968
    s_add_u32 s77, s77, s84
    v_accvgpr_read_b32 v4, a253
    s_nop 7
    v_mov_b32 v12, v24
    v_mov_b32 v13, v25
    v_mov_b32 v14, v26
    v_mov_b32 v15, v27
    v_mov_b32 v16, v28
    v_mov_b32 v17, v29
    v_mov_b32 v18, v30
    v_mov_b32 v19, v31
    v_mov_b32 v20, v32
    v_mov_b32 v21, v33
    v_mov_b32 v22, v34
    v_mov_b32 v23, v35
    v_max_f32_dpp v0, v36, v36 row_ror:8 row_mask:0xf bank_mask:0xf
    v_permlane32_swap_b32 v24, v12
    v_permlane32_swap_b32 v25, v13
    v_permlane32_swap_b32 v26, v14
    v_permlane32_swap_b32 v27, v15
    v_permlane32_swap_b32 v28, v16
    v_permlane32_swap_b32 v29, v17
    v_permlane32_swap_b32 v30, v18
    v_permlane32_swap_b32 v31, v19
    v_permlane32_swap_b32 v32, v20
    v_permlane32_swap_b32 v33, v21
    v_permlane32_swap_b32 v34, v22
    v_permlane32_swap_b32 v35, v23
    s_nop 1
    v_add_f32_dpp v24, v12, v24 row_ror:8 row_mask:0xf bank_mask:0xf
    v_add_f32_dpp v25, v13, v25 row_ror:8 row_mask:0xf bank_mask:0xf
    v_add_f32_dpp v26, v14, v26 row_ror:8 row_mask:0xf bank_mask:0xf
    v_add_f32_dpp v27, v15, v27 row_ror:8 row_mask:0xf bank_mask:0xf
    v_add_f32_dpp v28, v16, v28 row_ror:8 row_mask:0xf bank_mask:0xf
    v_add_f32_dpp v29, v17, v29 row_ror:8 row_mask:0xf bank_mask:0xf
    v_add_f32_dpp v30, v18, v30 row_ror:8 row_mask:0xf bank_mask:0xf
    v_add_f32_dpp v31, v19, v31 row_ror:8 row_mask:0xf bank_mask:0xf
    v_add_f32_dpp v32, v20, v32 row_ror:8 row_mask:0xf bank_mask:0xf
    v_add_f32_dpp v33, v21, v33 row_ror:8 row_mask:0xf bank_mask:0xf
    v_add_f32_dpp v34, v22, v34 row_ror:8 row_mask:0xf bank_mask:0xf
    v_add_f32_dpp v35, v23, v35 row_ror:8 row_mask:0xf bank_mask:0xf
    v_add_f32_dpp v0, v36, v36 row_ror:8 row_mask:0xf bank_mask:0xf
    v_mov_b32 v1, v0
    s_nop 1
    v_permlane16_swap_b32 v0, v1
    s_nop 1
    v_add_f32 v0, v0, v1
    v_mov_b32 v1, v0
    s_nop 1
    v_permlane32_swap_b32 v0, v1
    s_nop 1
    v_add_f32 v13, v0, v1
    v_sub_f32 v12, 0, v37
    v_min_u32 v24, -2, v24
    v_min_u32 v25, -2, v25
    v_min_u32 v26, -2, v26
    v_min_u32 v27, -2, v27
    v_min_u32 v28, -2, v28
    v_min_u32 v29, -2, v29
    v_min_u32 v30, -2, v30
    v_min_u32 v31, -2, v31
    v_min_u32 v32, -2, v32
    v_min_u32 v33, -2, v33
    v_min_u32 v34, -2, v34
    v_min_u32 v35, -2, v35
    v_min_u32 v12, -2, v12
    v_min_u32 v13, -2, v13
    s_mov_b64 exec, s[64:65]
    buffer_store_dwordx4 v[24:27], v4, s[28:31], s77 offen offset:0 sc1
    buffer_store_dwordx4 v[28:31], v4, s[28:31], s77 offen offset:256 sc1
    buffer_store_dwordx4 v[32:35], v4, s[28:31], s77 offen offset:512 sc1
    s_mov_b64 exec, 1
    buffer_store_dwordx2 v[12:13], v4, s[28:31], s77 offen offset:768 sc1
    s_mov_b64 exec, -1
    s_nop 1
Lnopub_87:
    s_add_u32 s72, s72, 1
    s_mov_b32 s74, s75
    v_mov_b32 v0, 0
    v_mov_b32 v1, 0
    v_mov_b32 v2, 0
    v_dot2c_f32_bf16 v0, v160, v40
    v_dot2c_f32_bf16 v1, v164, v44
    v_dot2c_f32_bf16 v2, v168, v48
    v_dot2c_f32_bf16 v0, v161, v41
    v_dot2c_f32_bf16 v1, v165, v45
    v_dot2c_f32_bf16 v2, v169, v49
    v_dot2c_f32_bf16 v0, v162, v42
    v_dot2c_f32_bf16 v1, v166, v46
    v_dot2c_f32_bf16 v2, v170, v50
    v_dot2c_f32_bf16 v0, v163, v43
    v_dot2c_f32_bf16 v1, v167, v47
    v_dot2c_f32_bf16 v2, v171, v51
    s_nop 1
    v_add_f32 v0, v0, v1
    v_add_f32 v0, v0, v2
    s_nop 1
    v_add_f32_dpp v0, v0, v0 quad_perm:[1,0,3,2] row_mask:0xf bank_mask:0xf
    s_nop 1
    v_add_f32_dpp v0, v0, v0 quad_perm:[2,3,0,1] row_mask:0xf bank_mask:0xf
    s_nop 1
    v_add_f32_dpp v0, v0, v0 row_half_mirror row_mask:0xf bank_mask:0xf
    v_mul_f32 v0, s60, v0
    v_add_f32 v3, v0, v38
    v_cmp_lt_f32 vcc, 0, v3
    s_cbranch_vccz Lskip_91
    s_swappc_b64 s[62:63], s[96:97]
Lskip_91:
    v_exp_f32 v4, v3
    s_nop 0
    v_add_f32 v7, v7, v4
    v_cvt_pk_bf16_f32 v4, v4, v4
    v_and_b32 v0, v4, v8
    v_and_b32 v1, v4, v9
    v_and_b32 v2, v4, v10
    v_and_b32 v3, v4, v11
    s_nop 1
    v_mfma_f32_16x16x32_bf16 v[52:55], v[0:3], a[48:51], v[52:55]
    v_mfma_f32_16x16x32_bf16 v[56:59], v[0:3], a[52:55], v[56:59]
    v_mfma_f32_16x16x32_bf16 v[60:63], v[0:3], a[56:59], v[60:63]
    s_cmp_eq_u32 s91, 1
    s_cbranch_scc1 Lthr_92
    s_waitcnt vmcnt(18)
Lthr_92:
    s_add_u32 s71, s76, 319488
    buffer_load_dwordx4 v[160:163], v5, s[52:55], s71 offen offset:0 nt
    buffer_load_dwordx4 v[164:167], v5, s[52:55], s71 offen offset:128 nt
    buffer_load_dwordx4 v[168:171], v5, s[52:55], s71 offen offset:256 nt
    buffer_load_dwordx4 a[48:51], v5, s[56:59], s71 offen offset:0 nt
    buffer_load_dwordx4 a[52:55], v5, s[56:59], s71 offen offset:128 nt
    buffer_load_dwordx4 a[56:59], v5, s[56:59], s71 offen offset:256 nt
    v_mov_b32 v0, 0
    v_mov_b32 v1, 0
    v_mov_b32 v2, 0
    v_dot2c_f32_bf16 v0, v172, v40
    v_dot2c_f32_bf16 v1, v176, v44
    v_dot2c_f32_bf16 v2, v180, v48
    v_dot2c_f32_bf16 v0, v173, v41
    v_dot2c_f32_bf16 v1, v177, v45
    v_dot2c_f32_bf16 v2, v181, v49
    v_dot2c_f32_bf16 v0, v174, v42
    v_dot2c_f32_bf16 v1, v178, v46
    v_dot2c_f32_bf16 v2, v182, v50
    v_dot2c_f32_bf16 v0, v175, v43
    v_dot2c_f32_bf16 v1, v179, v47
    v_dot2c_f32_bf16 v2, v183, v51
    s_nop 1
    v_add_f32 v0, v0, v1
    v_add_f32 v0, v0, v2
    s_nop 1
    v_add_f32_dpp v0, v0, v0 quad_perm:[1,0,3,2] row_mask:0xf bank_mask:0xf
    s_nop 1
    v_add_f32_dpp v0, v0, v0 quad_perm:[2,3,0,1] row_mask:0xf bank_mask:0xf
    s_nop 1
    v_add_f32_dpp v0, v0, v0 row_half_mirror row_mask:0xf bank_mask:0xf
    v_mul_f32 v0, s60, v0
    v_add_f32 v3, v0, v38
    v_cmp_lt_f32 vcc, 0, v3
    s_cbranch_vccz Lskip_93
    s_swappc_b64 s[62:63], s[96:97]
Lskip_93:
    v_exp_f32 v4, v3
    s_nop 0
    v_add_f32 v7, v7, v4
    v_cvt_pk_bf16_f32 v4, v4, v4
    v_and_b32 v0, v4, v8
    v_and_b32 v1, v4, v9
    v_and_b32 v2, v4, v10
    v_and_b32 v3, v4, v11
    s_nop 1
    v_mfma_f32_16x16x32_bf16 v[52:55], v[0:3], a[60:63], v[52:55]
    v_mfma_f32_16x16x32_bf16 v[56:59], v[0:3], a[64:67], v[56:59]
    v_mfma_f32_16x16x32_bf16 v[60:63], v[0:3], a[68:71], v[60:63]
    s_cmp_eq_u32 s91, 1
    s_cbranch_scc1 Lthr_94
    s_waitcnt vmcnt(18)
Lthr_94:
    s_add_u32 s71, s76, 399360
    buffer_load_dwordx4 v[172:175], v5, s[52:55], s71 offen offset:0 nt
    buffer_load_dwordx4 v[176:179], v5, s[52:55], s71 offen offset:128 nt
    buffer_load_dwordx4 v[180:183], v5, s[52:55], s71 offen offset:256 nt
    buffer_load_dwordx4 a[60:63], v5, s[56:59], s71 offen offset:0 nt
    buffer_load_dwordx4 a[64:67], v5, s[56:59], s71 offen offset:128 nt
    buffer_load_dwordx4 a[68:71], v5, s[56:59], s71 offen offset:256 nt
    v_mov_b32 v0, 0
    v_mov_b32 v1, 0
    v_mov_b32 v2, 0
    v_dot2c_f32_bf16 v0, v184, v40
    v_dot2c_f32_bf16 v1, v188, v44
    v_dot2c_f32_bf16 v2, v192, v48
    v_dot2c_f32_bf16 v0, v185, v41
    v_dot2c_f32_bf16 v1, v189, v45
    v_dot2c_f32_bf16 v2, v193, v49
    v_dot2c_f32_bf16 v0, v186, v42
    v_dot2c_f32_bf16 v1, v190, v46
    v_dot2c_f32_bf16 v2, v194, v50
    v_dot2c_f32_bf16 v0, v187, v43
    v_dot2c_f32_bf16 v1, v191, v47
    v_dot2c_f32_bf16 v2, v195, v51
    s_nop 1
    v_add_f32 v0, v0, v1
    v_add_f32 v0, v0, v2
    s_nop 1
    v_add_f32_dpp v0, v0, v0 quad_perm:[1,0,3,2] row_mask:0xf bank_mask:0xf
    s_nop 1
    v_add_f32_dpp v0, v0, v0 quad_perm:[2,3,0,1] row_mask:0xf bank_mask:0xf
    s_nop 1
    v_add_f32_dpp v0, v0, v0 row_half_mirror row_mask:0xf bank_mask:0xf
    v_mul_f32 v0, s60, v0
    v_add_f32 v3, v0, v38
    v_cmp_lt_f32 vcc, 0, v3
    s_cbranch_vccz Lskip_95
    s_swappc_b64 s[62:63], s[96:97]
Lskip_95:
    v_exp_f32 v4, v3
    s_nop 0
    v_add_f32 v7, v7, v4
    v_cvt_pk_bf16_f32 v4, v4, v4
    v_and_b32 v0, v4, v8
    v_and_b32 v1, v4, v9
    v_and_b32 v2, v4, v10
    v_and_b32 v3, v4, v11
    s_nop 1
    v_mfma_f32_16x16x32_bf16 v[52:55], v[0:3], a[72:75], v[52:55]
    v_mfma_f32_16x16x32_bf16 v[56:59], v[0:3], a[76:79], v[56:59]
    v_mfma_f32_16x16x32_bf16 v[60:63], v[0:3], a[80:83], v[60:63]
    s_cmp_eq_u32 s91, 1
    s_cbranch_scc1 Lthr_96
    s_waitcnt vmcnt(18)
Lthr_96:
    s_add_u32 s71, s76, 479232
    buffer_load_dwordx4 v[184:187], v5, s[52:55], s71 offen offset:0 nt
    buffer_load_dwordx4 v[188:191], v5, s[52:55], s71 offen offset:128 nt
    buffer_load_dwordx4 v[192:195], v5, s[52:55], s71 offen offset:256 nt
    buffer_load_dwordx4 a[72:75], v5, s[56:59], s71 offen offset:0 nt
    buffer_load_dwordx4 a[76:79], v5, s[56:59], s71 offen offset:128 nt
    buffer_load_dwordx4 a[80:83], v5, s[56:59], s71 offen offset:256 nt
    v_mov_b32 v0, 0
    v_mov_b32 v1, 0
    v_mov_b32 v2, 0
    v_dot2c_f32_bf16 v0, v196, v40
    v_dot2c_f32_bf16 v1, v200, v44
    v_dot2c_f32_bf16 v2, v204, v48
    v_dot2c_f32_bf16 v0, v197, v41
    v_dot2c_f32_bf16 v1, v201, v45
    v_dot2c_f32_bf16 v2, v205, v49
    v_dot2c_f32_bf16 v0, v198, v42
    v_dot2c_f32_bf16 v1, v202, v46
    v_dot2c_f32_bf16 v2, v206, v50
    v_dot2c_f32_bf16 v0, v199, v43
    v_dot2c_f32_bf16 v1, v203, v47
    v_dot2c_f32_bf16 v2, v207, v51
    s_nop 1
    v_add_f32 v0, v0, v1
    v_add_f32 v0, v0, v2
    s_nop 1
    v_add_f32_dpp v0, v0, v0 quad_perm:[1,0,3,2] row_mask:0xf bank_mask:0xf
    s_nop 1
    v_add_f32_dpp v0, v0, v0 quad_perm:[2,3,0,1] row_mask:0xf bank_mask:0xf
    s_nop 1
    v_add_f32_dpp v0, v0, v0 row_half_mirror row_mask:0xf bank_mask:0xf
    v_mul_f32 v0, s60, v0
    v_add_f32 v3, v0, v38
    v_cmp_lt_f32 vcc, 0, v3
    s_cbranch_vccz Lskip_97
    s_swappc_b64 s[62:63], s[96:97]
Lskip_97:
    v_exp_f32 v4, v3
    s_nop 0
    v_add_f32 v7, v7, v4
    v_cvt_pk_bf16_f32 v4, v4, v4
    v_and_b32 v0, v4, v8
    v_and_b32 v1, v4, v9
    v_and_b32 v2, v4, v10
    v_and_b32 v3, v4, v11
    s_nop 1
    v_mfma_f32_16x16x32_bf16 v[52:55], v[0:3], a[84:87], v[52:55]
    v_mfma_f32_16x16x32_bf16 v[56:59], v[0:3], a[88:91], v[56:59]
    v_mfma_f32_16x16x32_bf16 v[60:63], v[0:3], a[92:95], v[60:63]
    s_cmp_eq_u32 s91, 1
    s_cbranch_scc1 Lthr_98
    s_waitcnt vmcnt(18)
Lthr_98:
    s_add_u32 s71, s76, 559104
    buffer_load_dwordx4 v[196:199], v5, s[52:55], s71 offen offset:0 nt
    buffer_load_dwordx4 v[200:203], v5, s[52:55], s71 offen offset:128 nt
    buffer_load_dwordx4 v[204:207], v5, s[52:55], s71 offen offset:256 nt
    buffer_load_dwordx4 a[84:87], v5, s[56:59], s71 offen offset:0 nt
    buffer_load_dwordx4 a[88:91], v5, s[56:59], s71 offen offset:128 nt
    buffer_load_dwordx4 a[92:95], v5, s[56:59], s71 offen offset:256 nt
    s_branch L_rphase
L_rareA:
    s_nop 7
    v_max_f32_dpp v1, v0, v0 row_ror:8 row_mask:0xf bank_mask:0xf
    v_mov_b32 v2, v1
    s_nop 1
    v_permlane16_swap_b32 v1, v2
    s_nop 1
    v_max_f32 v1, v1, v2
    v_mov_b32 v2, v1
    s_nop 1
    v_permlane32_swap_b32 v1, v2
    s_nop 1
    v_max_f32 v1, v1, v2
    v_max_f32 v1, v1, -v37
    v_add_f32 v2, v1, v37
    v_exp_f32 v2, -v2
    v_sub_f32 v37, 0, v1
    v_mul_f32 v36, v36, v2
    v_mul_f32 v24, v24, v2
    v_mul_f32 v25, v25, v2
    v_mul_f32 v26, v26, v2
    v_mul_f32 v27, v27, v2
    v_mul_f32 v28, v28, v2
    v_mul_f32 v29, v29, v2
    v_mul_f32 v30, v30, v2
    v_mul_f32 v31, v31, v2
    v_mul_f32 v32, v32, v2
    v_mul_f32 v33, v33, v2
    v_mul_f32 v34, v34, v2
    v_mul_f32 v35, v35, v2
    v_add_f32 v3, v0, v37
    s_setpc_b64 s[62:63]
L_rareB:
    s_nop 7
    v_max_f32_dpp v1, v0, v0 row_ror:8 row_mask:0xf bank_mask:0xf
    v_mov_b32 v2, v1
    s_nop 1
    v_permlane16_swap_b32 v1, v2
    s_nop 1
    v_max_f32 v1, v1, v2
    v_mov_b32 v2, v1
    s_nop 1
    v_permlane32_swap_b32 v1, v2
    s_nop 1
    v_max_f32 v1, v1, v2
    v_max_f32 v1, v1, -v38
    v_add_f32 v2, v1, v38
    v_exp_f32 v2, -v2
    v_sub_f32 v38, 0, v1
    v_mul_f32 v7, v7, v2
    v_mul_f32 v52, v52, v2
    v_mul_f32 v53, v53, v2
    v_mul_f32 v54, v54, v2
    v_mul_f32 v55, v55, v2
    v_mul_f32 v56, v56, v2
    v_mul_f32 v57, v57, v2
    v_mul_f32 v58, v58, v2
    v_mul_f32 v59, v59, v2
    v_mul_f32 v60, v60, v2
    v_mul_f32 v61, v61, v2
    v_mul_f32 v62, v62, v2
    v_mul_f32 v63, v63, v2
    v_add_f32 v3, v0, v38
    s_setpc_b64 s[62:63]
L_rareB2:
    s_nop 7
    v_max_f32_dpp v77, v76, v76 row_ror:8 row_mask:0xf bank_mask:0xf
    v_mov_b32 v78, v77
    s_nop 1
    v_permlane16_swap_b32 v77, v78
    s_nop 1
    v_max_f32 v77, v77, v78
    v_mov_b32 v78, v77
    s_nop 1
    v_permlane32_swap_b32 v77, v78
    s_nop 1
    v_max_f32 v77, v77, v78
    v_max_f32 v77, v77, -v38
    v_add_f32 v78, v77, v38
    v_exp_f32 v78, -v78
    v_sub_f32 v38, 0, v77
    v_mul_f32 v7, v7, v78
    v_mul_f32 v52, v52, v78
    v_mul_f32 v53, v53, v78
    v_mul_f32 v54, v54, v78
    v_mul_f32 v55, v55, v78
    v_mul_f32 v56, v56, v78
    v_mul_f32 v57, v57, v78
    v_mul_f32 v58, v58, v78
    v_mul_f32 v59, v59, v78
    v_mul_f32 v60, v60, v78
    v_mul_f32 v61, v61, v78
    v_mul_f32 v62, v62, v78
    v_mul_f32 v63, v63, v78
    v_add_f32 v79, v76, v38
    s_setpc_b64 s[62:63]
L_svc:
    s_sub_u32 s64, s2, 208
    s_mov_b32 s60, s4
    s_mov_b32 s61, s5
    s_mov_b32 s62, 5120
    s_mov_b32 s63, 0x00020000
    v_lshrrev_b32 v19, 3, v0
    v_and_b32 v20, 7, v0
    v_lshlrev_b32 v20, 4, v20
    v_lshlrev_b32 v16, 4, v0
    v_lshlrev_b32 v17, 3, v0
    v_mov_b32 v18, 0
    s_cmp_ge_u32 s64, 32
    s_cbranch_scc1 L_f_early
    s_mul_i32 s65, s42, 1280
    buffer_load_dwordx2 v[54:55], v17, s[60:63], s65 offen
    buffer_load_dwordx2 v[56:57], v17, s[60:63], s65 offen offset:512
    v_lshlrev_b32 v31, 2, v0
    buffer_load_dword v58, v31, s[60:63], s65 offen offset:1024
    s_mov_b32 s52, s10
    s_mov_b32 s53, s11
    s_mov_b32 s54, 7864320
    s_mov_b32 s55, 0x00020000
    v_mul_u32_u24 v33, 12288, v19
    v_add_u32 v33, v33, v20
    s_mul_i32 s65, s42, 1966080
    s_mul_i32 s43, s64, 384
    s_add_u32 s65, s65, s43
    s_mul_i32 s44, s42, 28672
    buffer_load_dwordx4 a[240:243], v33, s[52:55], s65 offen offset:0 nt
    buffer_load_dwordx4 a[244:247], v33, s[52:55], s65 offen offset:128 nt
    buffer_load_dwordx4 a[248:251], v33, s[52:55], s65 offen offset:256 nt
    s_add_u32 s65, s65, 98304
    buffer_load_dwordx4 a[252:255], v33, s[52:55], s65 offen offset:0 nt
    buffer_load_dwordx4 v[144:147], v33, s[52:55], s65 offen offset:128 nt
    buffer_load_dwordx4 v[148:151], v33, s[52:55], s65 offen offset:256 nt
    s_add_u32 s65, s65, 98304
    buffer_load_dwordx4 v[152:155], v33, s[52:55], s65 offen offset:0 nt
    buffer_load_dwordx4 v[156:159], v33, s[52:55], s65 offen offset:128 nt
    buffer_load_dwordx4 v[160:163], v33, s[52:55], s65 offen offset:256 nt
    s_add_u32 s65, s65, 98304
    buffer_load_dwordx4 v[164:167], v33, s[52:55], s65 offen offset:0 nt
    buffer_load_dwordx4 v[168:171], v33, s[52:55], s65 offen offset:128 nt
    buffer_load_dwordx4 v[172:175], v33, s[52:55], s65 offen offset:256 nt
    s_add_u32 s65, s65, 98304
    buffer_load_dwordx4 v[176:179], v33, s[52:55], s65 offen offset:0 nt
    buffer_load_dwordx4 v[180:183], v33, s[52:55], s65 offen offset:128 nt
    buffer_load_dwordx4 v[184:187], v33, s[52:55], s65 offen offset:256 nt
    s_add_u32 s65, s65, 98304
    buffer_load_dwordx4 v[188:191], v33, s[52:55], s65 offen offset:0 nt
    buffer_load_dwordx4 v[192:195], v33, s[52:55], s65 offen offset:128 nt
    buffer_load_dwordx4 v[196:199], v33, s[52:55], s65 offen offset:256 nt
    s_add_u32 s65, s65, 98304
    buffer_load_dwordx4 v[200:203], v33, s[52:55], s65 offen offset:0 nt
    buffer_load_dwordx4 v[204:207], v33, s[52:55], s65 offen offset:128 nt
    buffer_load_dwordx4 v[208:211], v33, s[52:55], s65 offen offset:256 nt
    s_add_u32 s65, s65, 98304
    buffer_load_dwordx4 v[212:215], v33, s[52:55], s65 offen offset:0 nt
    buffer_load_dwordx4 v[216:219], v33, s[52:55], s65 offen offset:128 nt
    buffer_load_dwordx4 v[220:223], v33, s[52:55], s65 offen offset:256 nt
    s_add_u32 s65, s65, 98304
    buffer_load_dwordx4 v[224:227], v33, s[52:55], s65 offen offset:0 nt
    buffer_load_dwordx4 v[228:231], v33, s[52:55], s65 offen offset:128 nt
    buffer_load_dwordx4 v[232:235], v33, s[52:55], s65 offen offset:256 nt
    s_add_u32 s65, s65, 98304
    buffer_load_dwordx4 v[236:239], v33, s[52:55], s65 offen offset:0 nt
    buffer_load_dwordx4 v[240:243], v33, s[52:55], s65 offen offset:128 nt
    buffer_load_dwordx4 v[244:247], v33, s[52:55], s65 offen offset:256 nt
    s_add_u32 s65, s65, 98304
    buffer_load_dwordx4 v[248:251], v33, s[52:55], s65 offen offset:0 nt
    buffer_load_dwordx4 v[252:255], v33, s[52:55], s65 offen offset:128 nt
    s_add_u32 m0, s44, 0
    s_nop 0
    buffer_load_dwordx4 v33, s[52:55], s65 offen offset:256 nt lds
    s_add_u32 s65, s65, 98304
    s_add_u32 m0, s44, 1280
    s_nop 0
    buffer_load_dwordx4 v33, s[52:55], s65 offen offset:0 nt lds
    s_add_u32 m0, s44, 2176
    s_nop 0
    buffer_load_dwordx4 v33, s[52:55], s65 offen offset:128 nt lds
    s_add_u32 m0, s44, 3072
    s_nop 0
    buffer_load_dwordx4 v33, s[52:55], s65 offen offset:256 nt lds
    s_add_u32 s65, s65, 98304
    s_add_u32 m0, s44, 4352
    s_nop 0
    buffer_load_dwordx4 v33, s[52:55], s65 offen offset:0 nt lds
    s_add_u32 m0, s44, 5248
    s_nop 0
    buffer_load_dwordx4 v33, s[52:55], s65 offen offset:128 nt lds
    s_add_u32 m0, s44, 6144
    s_nop 0
    buffer_load_dwordx4 v33, s[52:55], s65 offen offset:256 nt lds
    s_add_u32 s65, s65, 98304
    s_add_u32 m0, s44, 7424
    s_nop 0
    buffer_load_dwordx4 v33, s[52:55], s65 offen offset:0 nt lds
    s_add_u32 m0, s44, 8320
    s_nop 0
    buffer_load_dwordx4 v33, s[52:55], s65 offen offset:128 nt lds
    s_add_u32 m0, s44, 9216
    s_nop 0
    buffer_load_dwordx4 v33, s[52:55], s65 offen offset:256 nt lds
    s_add_u32 s65, s65, 98304
    s_add_u32 m0, s44, 10496
    s_nop 0
    buffer_load_dwordx4 v33, s[52:55], s65 offen offset:0 nt lds
    s_add_u32 m0, s44, 11392
    s_nop 0
    buffer_load_dwordx4 v33, s[52:55], s65 offen offset:128 nt lds
    s_add_u32 m0, s44, 12288
    s_nop 0
    buffer_load_dwordx4 v33, s[52:55], s65 offen offset:256 nt lds
    s_add_u32 s65, s65, 98304
    s_add_u32 m0, s44, 13568
    s_nop 0
    buffer_load_dwordx4 v33, s[52:55], s65 offen offset:0 nt lds
    s_add_u32 m0, s44, 14464
    s_nop 0
    buffer_load_dwordx4 v33, s[52:55], s65 offen offset:128 nt lds
    s_add_u32 m0, s44, 15360
    s_nop 0
    buffer_load_dwordx4 v33, s[52:55], s65 offen offset:256 nt lds
    s_add_u32 s65, s65, 98304
    s_add_u32 m0, s44, 16640
    s_nop 0
    buffer_load_dwordx4 v33, s[52:55], s65 offen offset:0 nt lds
    s_add_u32 m0, s44, 17536
    s_nop 0
    buffer_load_dwordx4 v33, s[52:55], s65 offen offset:128 nt lds
    s_add_u32 m0, s44, 18432
    s_nop 0
    buffer_load_dwordx4 v33, s[52:55], s65 offen offset:256 nt lds
    s_add_u32 s65, s65, 98304
    s_add_u32 m0, s44, 19712
    s_nop 0
    buffer_load_dwordx4 v33, s[52:55], s65 offen offset:0 nt lds
    s_add_u32 m0, s44, 20608
    s_nop 0
    buffer_load_dwordx4 v33, s[52:55], s65 offen offset:128 nt lds
    s_add_u32 m0, s44, 21504
    s_nop 0
    buffer_load_dwordx4 v33, s[52:55], s65 offen offset:256 nt lds
    s_add_u32 s65, s65, 98304
    s_add_u32 m0, s44, 22784
    s_nop 0
    buffer_load_dwordx4 v33, s[52:55], s65 offen offset:0 nt lds
    s_add_u32 m0, s44, 23680
    s_nop 0
    buffer_load_dwordx4 v33, s[52:55], s65 offen offset:128 nt lds
    s_add_u32 m0, s44, 24576
    s_nop 0
    buffer_load_dwordx4 v33, s[52:55], s65 offen offset:256 nt lds
    s_add_u32 s65, s65, 98304
    s_add_u32 m0, s44, 25856
    s_nop 0
    buffer_load_dwordx4 v33, s[52:55], s65 offen offset:0 nt lds
    s_add_u32 m0, s44, 26752
    s_nop 0
    buffer_load_dwordx4 v33, s[52:55], s65 offen offset:128 nt lds
    s_add_u32 m0, s44, 27648
    s_nop 0
    buffer_load_dwordx4 v33, s[52:55], s65 offen offset:256 nt lds
    s_add_u32 s65, s65, 98304
L_f_early:
    v_and_b32 v33, 1, v0
    v_lshlrev_b32 v33, 4, v33
    v_mov_b32 v34, 0xffff
    v_lshlrev_b32 v34, v33, v34
    v_bfe_u32 v33, v0, 1, 2
    v_cmp_eq_u32 vcc, 0, v33
    s_nop 1
    v_cndmask_b32 v4, 0, v34, vcc
    v_cmp_eq_u32 vcc, 1, v33
    s_nop 1
    v_cndmask_b32 v5, 0, v34, vcc
    v_cmp_eq_u32 vcc, 2, v33
    s_nop 1
    v_cndmask_b32 v6, 0, v34, vcc
    v_cmp_eq_u32 vcc, 3, v33
    s_nop 1
    v_cndmask_b32 v7, 0, v34, vcc
    s_mul_i32 s43, s42, 2560
    s_add_u32 s44, s43, 149760
    v_add_u32 v21, s44, v16
    v_add_u32 v22, s44, v17
    s_mul_i32 s45, s42, 640
    v_lshlrev_b32 v33, 2, v19
    s_add_u32 s44, s44, s45
    v_add_u32 v23, s44, v33
    s_add_u32 s44, s45, 149760
    v_add_u32 v24, s44, v33
    s_add_u32 s44, s43, 139520
    v_add_u32 v25, s44, v16
    v_add_u32 v26, s44, v17
    v_add_u32 v27, 139520, v16
    v_add_u32 v28, 139520, v17
    v_and_b32 v33, 7, v0
    v_lshlrev_b32 v33, 5, v33
    v_bfe_u32 v34, v0, 4, 1
    v_lshlrev_b32 v34, 4, v34
    v_add_u32 v29, v33, v34
    v_lshrrev_b32 v30, 5, v0
    s_lshl_b32 s43, s42, 1
    v_add_u32 v30, s43, v30
    s_mov_b32 s74, 0x00ff00ff
    s_mov_b32 s75, 0xff00ff00
    s_getpc_b64 s[76:77]
L_pc1:
    s_add_u32 s78, s76, L_g16-L_pc1
    s_addc_u32 s79, s77, 0
    s_add_u32 s80, s76, L_s1pass-L_pc1
    s_addc_u32 s81, s77, 0
    s_add_u32 s82, s76, L_pollx-L_pc1
    s_addc_u32 s83, s77, 0
    s_add_u32 s76, s76, L_ln-L_pc1
    s_addc_u32 s77, s77, 0
    s_cmp_ge_u32 s64, 32
    s_cbranch_scc1 L_frole
    v_mul_u32_u24 v37, 768, v30
    v_add_u32 v37, v37, v29
    v_add_u32 v37, 114944, v37
    v_mul_u32_u24 v38, 1280, v30
    v_add_u32 v38, v38, v29
    v_add_u32 v38, 114944, v38
    s_mul_i32 s43, s42, 28672
    v_add_u32 v42, s43, v16
    v_lshrrev_b32 v33, 5, v0
    v_lshlrev_b32 v33, 10, v33
    v_and_b32 v34, 31, v0
    v_mul_u32_u24 v34, 12, v34
    v_add_u32 v40, 768, v33
    v_add_u32 v39, v33, v34
    s_and_b32 s43, s42, 1
    s_mul_i32 s43, s43, 384
    v_add_u32 v39, s43, v39
    v_lshlrev_b32 v41, 10, v0
    v_add_u32 v41, 768, v41
    s_and_b32 s69, s64, 30
    s_lshr_b32 s43, s42, 1
    s_add_u32 s69, s69, s43
    s_waitcnt vmcnt(60)
    v_lshlrev_b32 v44, 16, v54
    v_and_b32 v45, 0xffff0000, v54
    v_lshlrev_b32 v46, 16, v55
    v_and_b32 v47, 0xffff0000, v55
    v_lshlrev_b32 v48, 16, v56
    v_and_b32 v49, 0xffff0000, v56
    v_lshlrev_b32 v50, 16, v57
    v_and_b32 v51, 0xffff0000, v57
    v_lshlrev_b32 v52, 16, v58
    v_and_b32 v53, 0xffff0000, v58
    s_swappc_b64 s[84:85], s[76:77]
    s_barrier
    s_waitcnt vmcnt(57)
    ds_read_b32 v64, v24 offset:0
    ds_read_b32 v65, v24 offset:2560
    ds_read_b32 v66, v24 offset:5120
    ds_read_b32 v67, v24 offset:7680
    s_waitcnt vmcnt(54)
    ds_read_b32 v68, v24 offset:32
    ds_read_b32 v69, v24 offset:2592
    ds_read_b32 v70, v24 offset:5152
    ds_read_b32 v71, v24 offset:7712
    s_waitcnt lgkmcnt(4)
    v_and_b32 v8, v64, v4
    v_and_b32 v9, v64, v5
    v_and_b32 v10, v64, v6
    v_and_b32 v11, v64, v7
    s_nop 1
    v_mfma_f32_16x16x32_bf16 v[84:87], v[8:11], a[240:243], 0
    v_mfma_f32_16x16x32_bf16 v[88:91], v[8:11], a[244:247], 0
    v_mfma_f32_16x16x32_bf16 v[92:95], v[8:11], a[248:251], 0
    v_and_b32 v12, v65, v4
    v_and_b32 v13, v65, v5
    v_and_b32 v14, v65, v6
    v_and_b32 v15, v65, v7
    s_nop 1
    v_mfma_f32_16x16x32_bf16 v[96:99], v[12:15], a[240:243], 0
    v_mfma_f32_16x16x32_bf16 v[100:103], v[12:15], a[244:247], 0
    v_mfma_f32_16x16x32_bf16 v[104:107], v[12:15], a[248:251], 0
    v_and_b32 v8, v66, v4
    v_and_b32 v9, v66, v5
    v_and_b32 v10, v66, v6
    v_and_b32 v11, v66, v7
    s_nop 1
    v_mfma_f32_16x16x32_bf16 v[108:111], v[8:11], a[240:243], 0
    v_mfma_f32_16x16x32_bf16 v[112:115], v[8:11], a[244:247], 0
    v_mfma_f32_16x16x32_bf16 v[116:119], v[8:11], a[248:251], 0
    v_and_b32 v12, v67, v4
    v_and_b32 v13, v67, v5
    v_and_b32 v14, v67, v6
    v_and_b32 v15, v67, v7
    s_nop 1
    v_mfma_f32_16x16x32_bf16 v[120:123], v[12:15], a[240:243], 0
    v_mfma_f32_16x16x32_bf16 v[124:127], v[12:15], a[244:247], 0
    v_mfma_f32_16x16x32_bf16 v[128:131], v[12:15], a[248:251], 0
    s_waitcnt vmcnt(51)
    ds_read_b32 v64, v24 offset:64
    ds_read_b32 v65, v24 offset:2624
    ds_read_b32 v66, v24 offset:5184
    ds_read_b32 v67, v24 offset:7744
    s_waitcnt lgkmcnt(4)
    v_and_b32 v8, v68, v4
    v_and_b32 v9, v68, v5
    v_and_b32 v10, v68, v6
    v_and_b32 v11, v68, v7
    s_nop 1
    v_mfma_f32_16x16x32_bf16 v[84:87], v[8:11], a[252:255], v[84:87]
    v_mfma_f32_16x16x32_bf16 v[88:91], v[8:11], v[144:147], v[88:91]
    v_mfma_f32_16x16x32_bf16 v[92:95], v[8:11], v[148:151], v[92:95]
    v_and_b32 v12, v69, v4
    v_and_b32 v13, v69, v5
    v_and_b32 v14, v69, v6
    v_and_b32 v15, v69, v7
    s_nop 1
    v_mfma_f32_16x16x32_bf16 v[96:99], v[12:15], a[252:255], v[96:99]
    v_mfma_f32_16x16x32_bf16 v[100:103], v[12:15], v[144:147], v[100:103]
    v_mfma_f32_16x16x32_bf16 v[104:107], v[12:15], v[148:151], v[104:107]
    v_and_b32 v8, v70, v4
    v_and_b32 v9, v70, v5
    v_and_b32 v10, v70, v6
    v_and_b32 v11, v70, v7
    s_nop 1
    v_mfma_f32_16x16x32_bf16 v[108:111], v[8:11], a[252:255], v[108:111]
    v_mfma_f32_16x16x32_bf16 v[112:115], v[8:11], v[144:147], v[112:115]
    v_mfma_f32_16x16x32_bf16 v[116:119], v[8:11], v[148:151], v[116:119]
    v_and_b32 v12, v71, v4
    v_and_b32 v13, v71, v5
    v_and_b32 v14, v71, v6
    v_and_b32 v15, v71, v7
    s_nop 1
    v_mfma_f32_16x16x32_bf16 v[120:123], v[12:15], a[252:255], v[120:123]
    v_mfma_f32_16x16x32_bf16 v[124:127], v[12:15], v[144:147], v[124:127]
    v_mfma_f32_16x16x32_bf16 v[128:131], v[12:15], v[148:151], v[128:131]
    s_waitcnt vmcnt(48)
    ds_read_b32 v68, v24 offset:96
    ds_read_b32 v69, v24 offset:2656
    ds_read_b32 v70, v24 offset:5216
    ds_read_b32 v71, v24 offset:7776
    s_waitcnt lgkmcnt(4)
    v_and_b32 v8, v64, v4
    v_and_b32 v9, v64, v5
    v_and_b32 v10, v64, v6
    v_and_b32 v11, v64, v7
    s_nop 1
    v_mfma_f32_16x16x32_bf16 v[84:87], v[8:11], v[152:155], v[84:87]
    v_mfma_f32_16x16x32_bf16 v[88:91], v[8:11], v[156:159], v[88:91]
    v_mfma_f32_16x16x32_bf16 v[92:95], v[8:11], v[160:163], v[92:95]
    v_and_b32 v12, v65, v4
    v_and_b32 v13, v65, v5
    v_and_b32 v14, v65, v6
    v_and_b32 v15, v65, v7
    s_nop 1
    v_mfma_f32_16x16x32_bf16 v[96:99], v[12:15], v[152:155], v[96:99]
    v_mfma_f32_16x16x32_bf16 v[100:103], v[12:15], v[156:159], v[100:103]
    v_mfma_f32_16x16x32_bf16 v[104:107], v[12:15], v[160:163], v[104:107]
    v_and_b32 v8, v66, v4
    v_and_b32 v9, v66, v5
    v_and_b32 v10, v66, v6
    v_and_b32 v11, v66, v7
    s_nop 1
    v_mfma_f32_16x16x32_bf16 v[108:111], v[8:11], v[152:155], v[108:111]
    v_mfma_f32_16x16x32_bf16 v[112:115], v[8:11], v[156:159], v[112:115]
    v_mfma_f32_16x16x32_bf16 v[116:119], v[8:11], v[160:163], v[116:119]
    v_and_b32 v12, v67, v4
    v_and_b32 v13, v67, v5
    v_and_b32 v14, v67, v6
    v_and_b32 v15, v67, v7
    s_nop 1
    v_mfma_f32_16x16x32_bf16 v[120:123], v[12:15], v[152:155], v[120:123]
    v_mfma_f32_16x16x32_bf16 v[124:127], v[12:15], v[156:159], v[124:127]
    v_mfma_f32_16x16x32_bf16 v[128:131], v[12:15], v[160:163], v[128:131]
    s_waitcnt vmcnt(45)
    ds_read_b32 v64, v24 offset:128
    ds_read_b32 v65, v24 offset:2688
    ds_read_b32 v66, v24 offset:5248
    ds_read_b32 v67, v24 offset:7808
    s_waitcnt lgkmcnt(4)
    v_and_b32 v8, v68, v4
    v_and_b32 v9, v68, v5
    v_and_b32 v10, v68, v6
    v_and_b32 v11, v68, v7
    s_nop 1
    v_mfma_f32_16x16x32_bf16 v[84:87], v[8:11], v[164:167], v[84:87]
    v_mfma_f32_16x16x32_bf16 v[88:91], v[8:11], v[168:171], v[88:91]
    v_mfma_f32_16x16x32_bf16 v[92:95], v[8:11], v[172:175], v[92:95]
    v_and_b32 v12, v69, v4
    v_and_b32 v13, v69, v5
    v_and_b32 v14, v69, v6
    v_and_b32 v15, v69, v7
    s_nop 1
    v_mfma_f32_16x16x32_bf16 v[96:99], v[12:15], v[164:167], v[96:99]
    v_mfma_f32_16x16x32_bf16 v[100:103], v[12:15], v[168:171], v[100:103]
    v_mfma_f32_16x16x32_bf16 v[104:107], v[12:15], v[172:175], v[104:107]
    v_and_b32 v8, v70, v4
    v_and_b32 v9, v70, v5
    v_and_b32 v10, v70, v6
    v_and_b32 v11, v70, v7
    s_nop 1
    v_mfma_f32_16x16x32_bf16 v[108:111], v[8:11], v[164:167], v[108:111]
    v_mfma_f32_16x16x32_bf16 v[112:115], v[8:11], v[168:171], v[112:115]
    v_mfma_f32_16x16x32_bf16 v[116:119], v[8:11], v[172:175], v[116:119]
    v_and_b32 v12, v71, v4
    v_and_b32 v13, v71, v5
    v_and_b32 v14, v71, v6
    v_and_b32 v15, v71, v7
    s_nop 1
    v_mfma_f32_16x16x32_bf16 v[120:123], v[12:15], v[164:167], v[120:123]
    v_mfma_f32_16x16x32_bf16 v[124:127], v[12:15], v[168:171], v[124:127]
    v_mfma_f32_16x16x32_bf16 v[128:131], v[12:15], v[172:175], v[128:131]
    s_waitcnt vmcnt(42)
    ds_read_b32 v68, v24 offset:160
    ds_read_b32 v69, v24 offset:2720
    ds_read_b32 v70, v24 offset:5280
    ds_read_b32 v71, v24 offset:7840
    s_waitcnt lgkmcnt(4)
    v_and_b32 v8, v64, v4
    v_and_b32 v9, v64, v5
    v_and_b32 v10, v64, v6
    v_and_b32 v11, v64, v7
    s_nop 1
    v_mfma_f32_16x16x32_bf16 v[84:87], v[8:11], v[176:179], v[84:87]
    v_mfma_f32_16x16x32_bf16 v[88:91], v[8:11], v[180:183], v[88:91]
    v_mfma_f32_16x16x32_bf16 v[92:95], v[8:11], v[184:187], v[92:95]
    v_and_b32 v12, v65, v4
    v_and_b32 v13, v65, v5
    v_and_b32 v14, v65, v6
    v_and_b32 v15, v65, v7
    s_nop 1
    v_mfma_f32_16x16x32_bf16 v[96:99], v[12:15], v[176:179], v[96:99]
    v_mfma_f32_16x16x32_bf16 v[100:103], v[12:15], v[180:183], v[100:103]
    v_mfma_f32_16x16x32_bf16 v[104:107], v[12:15], v[184:187], v[104:107]
    v_and_b32 v8, v66, v4
    v_and_b32 v9, v66, v5
    v_and_b32 v10, v66, v6
    v_and_b32 v11, v66, v7
    s_nop 1
    v_mfma_f32_16x16x32_bf16 v[108:111], v[8:11], v[176:179], v[108:111]
    v_mfma_f32_16x16x32_bf16 v[112:115], v[8:11], v[180:183], v[112:115]
    v_mfma_f32_16x16x32_bf16 v[116:119], v[8:11], v[184:187], v[116:119]
    v_and_b32 v12, v67, v4
    v_and_b32 v13, v67, v5
    v_and_b32 v14, v67, v6
    v_and_b32 v15, v67, v7
    s_nop 1
    v_mfma_f32_16x16x32_bf16 v[120:123], v[12:15], v[176:179], v[120:123]
    v_mfma_f32_16x16x32_bf16 v[124:127], v[12:15], v[180:183], v[124:127]
    v_mfma_f32_16x16x32_bf16 v[128:131], v[12:15], v[184:187], v[128:131]
    s_waitcnt vmcnt(39)
    ds_read_b32 v64, v24 offset:192
    ds_read_b32 v65, v24 offset:2752
    ds_read_b32 v66, v24 offset:5312
    ds_read_b32 v67, v24 offset:7872
    s_waitcnt lgkmcnt(4)
    v_and_b32 v8, v68, v4
    v_and_b32 v9, v68, v5
    v_and_b32 v10, v68, v6
    v_and_b32 v11, v68, v7
    s_nop 1
    v_mfma_f32_16x16x32_bf16 v[84:87], v[8:11], v[188:191], v[84:87]
    v_mfma_f32_16x16x32_bf16 v[88:91], v[8:11], v[192:195], v[88:91]
    v_mfma_f32_16x16x32_bf16 v[92:95], v[8:11], v[196:199], v[92:95]
    v_and_b32 v12, v69, v4
    v_and_b32 v13, v69, v5
    v_and_b32 v14, v69, v6
    v_and_b32 v15, v69, v7
    s_nop 1
    v_mfma_f32_16x16x32_bf16 v[96:99], v[12:15], v[188:191], v[96:99]
    v_mfma_f32_16x16x32_bf16 v[100:103], v[12:15], v[192:195], v[100:103]
    v_mfma_f32_16x16x32_bf16 v[104:107], v[12:15], v[196:199], v[104:107]
    v_and_b32 v8, v70, v4
    v_and_b32 v9, v70, v5
    v_and_b32 v10, v70, v6
    v_and_b32 v11, v70, v7
    s_nop 1
    v_mfma_f32_16x16x32_bf16 v[108:111], v[8:11], v[188:191], v[108:111]
    v_mfma_f32_16x16x32_bf16 v[112:115], v[8:11], v[192:195], v[112:115]
    v_mfma_f32_16x16x32_bf16 v[116:119], v[8:11], v[196:199], v[116:119]
    v_and_b32 v12, v71, v4
    v_and_b32 v13, v71, v5
    v_and_b32 v14, v71, v6
    v_and_b32 v15, v71, v7
    s_nop 1
    v_mfma_f32_16x16x32_bf16 v[120:123], v[12:15], v[188:191], v[120:123]
    v_mfma_f32_16x16x32_bf16 v[124:127], v[12:15], v[192:195], v[124:127]
    v_mfma_f32_16x16x32_bf16 v[128:131], v[12:15], v[196:199], v[128:131]
    s_waitcnt vmcnt(36)
    ds_read_b32 v68, v24 offset:224
    ds_read_b32 v69, v24 offset:2784
    ds_read_b32 v70, v24 offset:5344
    ds_read_b32 v71, v24 offset:7904
    s_waitcnt lgkmcnt(4)
    v_and_b32 v8, v64, v4
    v_and_b32 v9, v64, v5
    v_and_b32 v10, v64, v6
    v_and_b32 v11, v64, v7
    s_nop 1
    v_mfma_f32_16x16x32_bf16 v[84:87], v[8:11], v[200:203], v[84:87]
    v_mfma_f32_16x16x32_bf16 v[88:91], v[8:11], v[204:207], v[88:91]
    v_mfma_f32_16x16x32_bf16 v[92:95], v[8:11], v[208:211], v[92:95]
    v_and_b32 v12, v65, v4
    v_and_b32 v13, v65, v5
    v_and_b32 v14, v65, v6
    v_and_b32 v15, v65, v7
    s_nop 1
    v_mfma_f32_16x16x32_bf16 v[96:99], v[12:15], v[200:203], v[96:99]
    v_mfma_f32_16x16x32_bf16 v[100:103], v[12:15], v[204:207], v[100:103]
    v_mfma_f32_16x16x32_bf16 v[104:107], v[12:15], v[208:211], v[104:107]
    v_and_b32 v8, v66, v4
    v_and_b32 v9, v66, v5
    v_and_b32 v10, v66, v6
    v_and_b32 v11, v66, v7
    s_nop 1
    v_mfma_f32_16x16x32_bf16 v[108:111], v[8:11], v[200:203], v[108:111]
    v_mfma_f32_16x16x32_bf16 v[112:115], v[8:11], v[204:207], v[112:115]
    v_mfma_f32_16x16x32_bf16 v[116:119], v[8:11], v[208:211], v[116:119]
    v_and_b32 v12, v67, v4
    v_and_b32 v13, v67, v5
    v_and_b32 v14, v67, v6
    v_and_b32 v15, v67, v7
    s_nop 1
    v_mfma_f32_16x16x32_bf16 v[120:123], v[12:15], v[200:203], v[120:123]
    v_mfma_f32_16x16x32_bf16 v[124:127], v[12:15], v[204:207], v[124:127]
    v_mfma_f32_16x16x32_bf16 v[128:131], v[12:15], v[208:211], v[128:131]
    s_waitcnt vmcnt(33)
    ds_read_b32 v64, v24 offset:256
    ds_read_b32 v65, v24 offset:2816
    ds_read_b32 v66, v24 offset:5376
    ds_read_b32 v67, v24 offset:7936
    s_waitcnt lgkmcnt(4)
    v_and_b32 v8, v68, v4
    v_and_b32 v9, v68, v5
    v_and_b32 v10, v68, v6
    v_and_b32 v11, v68, v7
    s_nop 1
    v_mfma_f32_16x16x32_bf16 v[84:87], v[8:11], v[212:215], v[84:87]
    v_mfma_f32_16x16x32_bf16 v[88:91], v[8:11], v[216:219], v[88:91]
    v_mfma_f32_16x16x32_bf16 v[92:95], v[8:11], v[220:223], v[92:95]
    v_and_b32 v12, v69, v4
    v_and_b32 v13, v69, v5
    v_and_b32 v14, v69, v6
    v_and_b32 v15, v69, v7
    s_nop 1
    v_mfma_f32_16x16x32_bf16 v[96:99], v[12:15], v[212:215], v[96:99]
    v_mfma_f32_16x16x32_bf16 v[100:103], v[12:15], v[216:219], v[100:103]
    v_mfma_f32_16x16x32_bf16 v[104:107], v[12:15], v[220:223], v[104:107]
    v_and_b32 v8, v70, v4
    v_and_b32 v9, v70, v5
    v_and_b32 v10, v70, v6
    v_and_b32 v11, v70, v7
    s_nop 1
    v_mfma_f32_16x16x32_bf16 v[108:111], v[8:11], v[212:215], v[108:111]
    v_mfma_f32_16x16x32_bf16 v[112:115], v[8:11], v[216:219], v[112:115]
    v_mfma_f32_16x16x32_bf16 v[116:119], v[8:11], v[220:223], v[116:119]
    v_and_b32 v12, v71, v4
    v_and_b32 v13, v71, v5
    v_and_b32 v14, v71, v6
    v_and_b32 v15, v71, v7
    s_nop 1
    v_mfma_f32_16x16x32_bf16 v[120:123], v[12:15], v[212:215], v[120:123]
    v_mfma_f32_16x16x32_bf16 v[124:127], v[12:15], v[216:219], v[124:127]
    v_mfma_f32_16x16x32_bf16 v[128:131], v[12:15], v[220:223], v[128:131]
    s_waitcnt vmcnt(30)
    ds_read_b32 v68, v24 offset:288
    ds_read_b32 v69, v24 offset:2848
    ds_read_b32 v70, v24 offset:5408
    ds_read_b32 v71, v24 offset:7968
    s_waitcnt lgkmcnt(4)
    v_and_b32 v8, v64, v4
    v_and_b32 v9, v64, v5
    v_and_b32 v10, v64, v6
    v_and_b32 v11, v64, v7
    s_nop 1
    v_mfma_f32_16x16x32_bf16 v[84:87], v[8:11], v[224:227], v[84:87]
    v_mfma_f32_16x16x32_bf16 v[88:91], v[8:11], v[228:231], v[88:91]
    v_mfma_f32_16x16x32_bf16 v[92:95], v[8:11], v[232:235], v[92:95]
    v_and_b32 v12, v65, v4
    v_and_b32 v13, v65, v5
    v_and_b32 v14, v65, v6
    v_and_b32 v15, v65, v7
    s_nop 1
    v_mfma_f32_16x16x32_bf16 v[96:99], v[12:15], v[224:227], v[96:99]
    v_mfma_f32_16x16x32_bf16 v[100:103], v[12:15], v[228:231], v[100:103]
    v_mfma_f32_16x16x32_bf16 v[104:107], v[12:15], v[232:235], v[104:107]
    v_and_b32 v8, v66, v4
    v_and_b32 v9, v66, v5
    v_and_b32 v10, v66, v6
    v_and_b32 v11, v66, v7
    s_nop 1
    v_mfma_f32_16x16x32_bf16 v[108:111], v[8:11], v[224:227], v[108:111]
    v_mfma_f32_16x16x32_bf16 v[112:115], v[8:11], v[228:231], v[112:115]
    v_mfma_f32_16x16x32_bf16 v[116:119], v[8:11], v[232:235], v[116:119]
    v_and_b32 v12, v67, v4
    v_and_b32 v13, v67, v5
    v_and_b32 v14, v67, v6
    v_and_b32 v15, v67, v7
    s_nop 1
    v_mfma_f32_16x16x32_bf16 v[120:123], v[12:15], v[224:227], v[120:123]
    v_mfma_f32_16x16x32_bf16 v[124:127], v[12:15], v[228:231], v[124:127]
    v_mfma_f32_16x16x32_bf16 v[128:131], v[12:15], v[232:235], v[128:131]
    s_waitcnt vmcnt(27)
    ds_read_b32 v64, v24 offset:320
    ds_read_b32 v65, v24 offset:2880
    ds_read_b32 v66, v24 offset:5440
    ds_read_b32 v67, v24 offset:8000
    ds_read_b128 v[52:55], v42 offset:256
    s_waitcnt lgkmcnt(5)
    v_and_b32 v8, v68, v4
    v_and_b32 v9, v68, v5
    v_and_b32 v10, v68, v6
    v_and_b32 v11, v68, v7
    s_nop 1
    v_mfma_f32_16x16x32_bf16 v[84:87], v[8:11], v[236:239], v[84:87]
    v_mfma_f32_16x16x32_bf16 v[88:91], v[8:11], v[240:243], v[88:91]
    v_mfma_f32_16x16x32_bf16 v[92:95], v[8:11], v[244:247], v[92:95]
    v_and_b32 v12, v69, v4
    v_and_b32 v13, v69, v5
    v_and_b32 v14, v69, v6
    v_and_b32 v15, v69, v7
    s_nop 1
    v_mfma_f32_16x16x32_bf16 v[96:99], v[12:15], v[236:239], v[96:99]
    v_mfma_f32_16x16x32_bf16 v[100:103], v[12:15], v[240:243], v[100:103]
    v_mfma_f32_16x16x32_bf16 v[104:107], v[12:15], v[244:247], v[104:107]
    v_and_b32 v8, v70, v4
    v_and_b32 v9, v70, v5
    v_and_b32 v10, v70, v6
    v_and_b32 v11, v70, v7
    s_nop 1
    v_mfma_f32_16x16x32_bf16 v[108:111], v[8:11], v[236:239], v[108:111]
    v_mfma_f32_16x16x32_bf16 v[112:115], v[8:11], v[240:243], v[112:115]
    v_mfma_f32_16x16x32_bf16 v[116:119], v[8:11], v[244:247], v[116:119]
    v_and_b32 v12, v71, v4
    v_and_b32 v13, v71, v5
    v_and_b32 v14, v71, v6
    v_and_b32 v15, v71, v7
    s_nop 1
    v_mfma_f32_16x16x32_bf16 v[120:123], v[12:15], v[236:239], v[120:123]
    v_mfma_f32_16x16x32_bf16 v[124:127], v[12:15], v[240:243], v[124:127]
    v_mfma_f32_16x16x32_bf16 v[128:131], v[12:15], v[244:247], v[128:131]
    s_waitcnt vmcnt(24)
    ds_read_b32 v68, v24 offset:352
    ds_read_b32 v69, v24 offset:2912
    ds_read_b32 v70, v24 offset:5472
    ds_read_b32 v71, v24 offset:8032
    ds_read_b128 v[132:135], v42 offset:1280
    ds_read_b128 v[136:139], v42 offset:2304
    ds_read_b128 v[140:143], v42 offset:3328
    s_waitcnt lgkmcnt(7)
    v_and_b32 v8, v64, v4
    v_and_b32 v9, v64, v5
    v_and_b32 v10, v64, v6
    v_and_b32 v11, v64, v7
    s_nop 1
    v_mfma_f32_16x16x32_bf16 v[84:87], v[8:11], v[248:251], v[84:87]
    v_mfma_f32_16x16x32_bf16 v[88:91], v[8:11], v[252:255], v[88:91]
    v_mfma_f32_16x16x32_bf16 v[92:95], v[8:11], v[52:55], v[92:95]
    v_and_b32 v12, v65, v4
    v_and_b32 v13, v65, v5
    v_and_b32 v14, v65, v6
    v_and_b32 v15, v65, v7
    s_nop 1
    v_mfma_f32_16x16x32_bf16 v[96:99], v[12:15], v[248:251], v[96:99]
    v_mfma_f32_16x16x32_bf16 v[100:103], v[12:15], v[252:255], v[100:103]
    v_mfma_f32_16x16x32_bf16 v[104:107], v[12:15], v[52:55], v[104:107]
    v_and_b32 v8, v66, v4
    v_and_b32 v9, v66, v5
    v_and_b32 v10, v66, v6
    v_and_b32 v11, v66, v7
    s_nop 1
    v_mfma_f32_16x16x32_bf16 v[108:111], v[8:11], v[248:251], v[108:111]
    v_mfma_f32_16x16x32_bf16 v[112:115], v[8:11], v[252:255], v[112:115]
    v_mfma_f32_16x16x32_bf16 v[116:119], v[8:11], v[52:55], v[116:119]
    v_and_b32 v12, v67, v4
    v_and_b32 v13, v67, v5
    v_and_b32 v14, v67, v6
    v_and_b32 v15, v67, v7
    s_nop 1
    v_mfma_f32_16x16x32_bf16 v[120:123], v[12:15], v[248:251], v[120:123]
    v_mfma_f32_16x16x32_bf16 v[124:127], v[12:15], v[252:255], v[124:127]
    v_mfma_f32_16x16x32_bf16 v[128:131], v[12:15], v[52:55], v[128:131]
    s_waitcnt vmcnt(21)
    ds_read_b32 v64, v24 offset:384
    ds_read_b32 v65, v24 offset:2944
    ds_read_b32 v66, v24 offset:5504
    ds_read_b32 v67, v24 offset:8064
    ds_read_b128 v[44:47], v42 offset:4352
    ds_read_b128 v[48:51], v42 offset:5376
    ds_read_b128 v[52:55], v42 offset:6400
    s_waitcnt lgkmcnt(7)
    v_and_b32 v8, v68, v4
    v_and_b32 v9, v68, v5
    v_and_b32 v10, v68, v6
    v_and_b32 v11, v68, v7
    s_nop 1
    v_mfma_f32_16x16x32_bf16 v[84:87], v[8:11], v[132:135], v[84:87]
    v_mfma_f32_16x16x32_bf16 v[88:91], v[8:11], v[136:139], v[88:91]
    v_mfma_f32_16x16x32_bf16 v[92:95], v[8:11], v[140:143], v[92:95]
    v_and_b32 v12, v69, v4
    v_and_b32 v13, v69, v5
    v_and_b32 v14, v69, v6
    v_and_b32 v15, v69, v7
    s_nop 1
    v_mfma_f32_16x16x32_bf16 v[96:99], v[12:15], v[132:135], v[96:99]
    v_mfma_f32_16x16x32_bf16 v[100:103], v[12:15], v[136:139], v[100:103]
    v_mfma_f32_16x16x32_bf16 v[104:107], v[12:15], v[140:143], v[104:107]
    v_and_b32 v8, v70, v4
    v_and_b32 v9, v70, v5
    v_and_b32 v10, v70, v6
    v_and_b32 v11, v70, v7
    s_nop 1
    v_mfma_f32_16x16x32_bf16 v[108:111], v[8:11], v[132:135], v[108:111]
    v_mfma_f32_16x16x32_bf16 v[112:115], v[8:11], v[136:139], v[112:115]
    v_mfma_f32_16x16x32_bf16 v[116:119], v[8:11], v[140:143], v[116:119]
    v_and_b32 v12, v71, v4
    v_and_b32 v13, v71, v5
    v_and_b32 v14, v71, v6
    v_and_b32 v15, v71, v7
    s_nop 1
    v_mfma_f32_16x16x32_bf16 v[120:123], v[12:15], v[132:135], v[120:123]
    v_mfma_f32_16x16x32_bf16 v[124:127], v[12:15], v[136:139], v[124:127]
    v_mfma_f32_16x16x32_bf16 v[128:131], v[12:15], v[140:143], v[128:131]
    s_waitcnt vmcnt(18)
    ds_read_b32 v68, v24 offset:416
    ds_read_b32 v69, v24 offset:2976
    ds_read_b32 v70, v24 offset:5536
    ds_read_b32 v71, v24 offset:8096
    ds_read_b128 v[132:135], v42 offset:7424
    ds_read_b128 v[136:139], v42 offset:8448
    ds_read_b128 v[140:143], v42 offset:9472
    s_waitcnt lgkmcnt(7)
    v_and_b32 v8, v64, v4
    v_and_b32 v9, v64, v5
    v_and_b32 v10, v64, v6
    v_and_b32 v11, v64, v7
    s_nop 1
    v_mfma_f32_16x16x32_bf16 v[84:87], v[8:11], v[44:47], v[84:87]
    v_mfma_f32_16x16x32_bf16 v[88:91], v[8:11], v[48:51], v[88:91]
    v_mfma_f32_16x16x32_bf16 v[92:95], v[8:11], v[52:55], v[92:95]
    v_and_b32 v12, v65, v4
    v_and_b32 v13, v65, v5
    v_and_b32 v14, v65, v6
    v_and_b32 v15, v65, v7
    s_nop 1
    v_mfma_f32_16x16x32_bf16 v[96:99], v[12:15], v[44:47], v[96:99]
    v_mfma_f32_16x16x32_bf16 v[100:103], v[12:15], v[48:51], v[100:103]
    v_mfma_f32_16x16x32_bf16 v[104:107], v[12:15], v[52:55], v[104:107]
    v_and_b32 v8, v66, v4
    v_and_b32 v9, v66, v5
    v_and_b32 v10, v66, v6
    v_and_b32 v11, v66, v7
    s_nop 1
    v_mfma_f32_16x16x32_bf16 v[108:111], v[8:11], v[44:47], v[108:111]
    v_mfma_f32_16x16x32_bf16 v[112:115], v[8:11], v[48:51], v[112:115]
    v_mfma_f32_16x16x32_bf16 v[116:119], v[8:11], v[52:55], v[116:119]
    v_and_b32 v12, v67, v4
    v_and_b32 v13, v67, v5
    v_and_b32 v14, v67, v6
    v_and_b32 v15, v67, v7
    s_nop 1
    v_mfma_f32_16x16x32_bf16 v[120:123], v[12:15], v[44:47], v[120:123]
    v_mfma_f32_16x16x32_bf16 v[124:127], v[12:15], v[48:51], v[124:127]
    v_mfma_f32_16x16x32_bf16 v[128:131], v[12:15], v[52:55], v[128:131]
    s_waitcnt vmcnt(15)
    ds_read_b32 v64, v24 offset:448
    ds_read_b32 v65, v24 offset:3008
    ds_read_b32 v66, v24 offset:5568
    ds_read_b32 v67, v24 offset:8128
    ds_read_b128 v[44:47], v42 offset:10496
    ds_read_b128 v[48:51], v42 offset:11520
    ds_read_b128 v[52:55], v42 offset:12544
    s_waitcnt lgkmcnt(7)
    v_and_b32 v8, v68, v4
    v_and_b32 v9, v68, v5
    v_and_b32 v10, v68, v6
    v_and_b32 v11, v68, v7
    s_nop 1
    v_mfma_f32_16x16x32_bf16 v[84:87], v[8:11], v[132:135], v[84:87]
    v_mfma_f32_16x16x32_bf16 v[88:91], v[8:11], v[136:139], v[88:91]
    v_mfma_f32_16x16x32_bf16 v[92:95], v[8:11], v[140:143], v[92:95]
    v_and_b32 v12, v69, v4
    v_and_b32 v13, v69, v5
    v_and_b32 v14, v69, v6
    v_and_b32 v15, v69, v7
    s_nop 1
    v_mfma_f32_16x16x32_bf16 v[96:99], v[12:15], v[132:135], v[96:99]
    v_mfma_f32_16x16x32_bf16 v[100:103], v[12:15], v[136:139], v[100:103]
    v_mfma_f32_16x16x32_bf16 v[104:107], v[12:15], v[140:143], v[104:107]
    v_and_b32 v8, v70, v4
    v_and_b32 v9, v70, v5
    v_and_b32 v10, v70, v6
    v_and_b32 v11, v70, v7
    s_nop 1
    v_mfma_f32_16x16x32_bf16 v[108:111], v[8:11], v[132:135], v[108:111]
    v_mfma_f32_16x16x32_bf16 v[112:115], v[8:11], v[136:139], v[112:115]
    v_mfma_f32_16x16x32_bf16 v[116:119], v[8:11], v[140:143], v[116:119]
    v_and_b32 v12, v71, v4
    v_and_b32 v13, v71, v5
    v_and_b32 v14, v71, v6
    v_and_b32 v15, v71, v7
    s_nop 1
    v_mfma_f32_16x16x32_bf16 v[120:123], v[12:15], v[132:135], v[120:123]
    v_mfma_f32_16x16x32_bf16 v[124:127], v[12:15], v[136:139], v[124:127]
    v_mfma_f32_16x16x32_bf16 v[128:131], v[12:15], v[140:143], v[128:131]
    s_waitcnt vmcnt(12)
    ds_read_b32 v68, v24 offset:480
    ds_read_b32 v69, v24 offset:3040
    ds_read_b32 v70, v24 offset:5600
    ds_read_b32 v71, v24 offset:8160
    ds_read_b128 v[132:135], v42 offset:13568
    ds_read_b128 v[136:139], v42 offset:14592
    ds_read_b128 v[140:143], v42 offset:15616
    s_waitcnt lgkmcnt(7)
    v_and_b32 v8, v64, v4
    v_and_b32 v9, v64, v5
    v_and_b32 v10, v64, v6
    v_and_b32 v11, v64, v7
    s_nop 1
    v_mfma_f32_16x16x32_bf16 v[84:87], v[8:11], v[44:47], v[84:87]
    v_mfma_f32_16x16x32_bf16 v[88:91], v[8:11], v[48:51], v[88:91]
    v_mfma_f32_16x16x32_bf16 v[92:95], v[8:11], v[52:55], v[92:95]
    v_and_b32 v12, v65, v4
    v_and_b32 v13, v65, v5
    v_and_b32 v14, v65, v6
    v_and_b32 v15, v65, v7
    s_nop 1
    v_mfma_f32_16x16x32_bf16 v[96:99], v[12:15], v[44:47], v[96:99]
    v_mfma_f32_16x16x32_bf16 v[100:103], v[12:15], v[48:51], v[100:103]
    v_mfma_f32_16x16x32_bf16 v[104:107], v[12:15], v[52:55], v[104:107]
    v_and_b32 v8, v66, v4
    v_and_b32 v9, v66, v5
    v_and_b32 v10, v66, v6
    v_and_b32 v11, v66, v7
    s_nop 1
    v_mfma_f32_16x16x32_bf16 v[108:111], v[8:11], v[44:47], v[108:111]
    v_mfma_f32_16x16x32_bf16 v[112:115], v[8:11], v[48:51], v[112:115]
    v_mfma_f32_16x16x32_bf16 v[116:119], v[8:11], v[52:55], v[116:119]
    v_and_b32 v12, v67, v4
    v_and_b32 v13, v67, v5
    v_and_b32 v14, v67, v6
    v_and_b32 v15, v67, v7
    s_nop 1
    v_mfma_f32_16x16x32_bf16 v[120:123], v[12:15], v[44:47], v[120:123]
    v_mfma_f32_16x16x32_bf16 v[124:127], v[12:15], v[48:51], v[124:127]
    v_mfma_f32_16x16x32_bf16 v[128:131], v[12:15], v[52:55], v[128:131]
    s_waitcnt vmcnt(9)
    ds_read_b32 v64, v24 offset:512
    ds_read_b32 v65, v24 offset:3072
    ds_read_b32 v66, v24 offset:5632
    ds_read_b32 v67, v24 offset:8192
    ds_read_b128 v[44:47], v42 offset:16640
    ds_read_b128 v[48:51], v42 offset:17664
    ds_read_b128 v[52:55], v42 offset:18688
    s_waitcnt lgkmcnt(7)
    v_and_b32 v8, v68, v4
    v_and_b32 v9, v68, v5
    v_and_b32 v10, v68, v6
    v_and_b32 v11, v68, v7
    s_nop 1
    v_mfma_f32_16x16x32_bf16 v[84:87], v[8:11], v[132:135], v[84:87]
    v_mfma_f32_16x16x32_bf16 v[88:91], v[8:11], v[136:139], v[88:91]
    v_mfma_f32_16x16x32_bf16 v[92:95], v[8:11], v[140:143], v[92:95]
    v_and_b32 v12, v69, v4
    v_and_b32 v13, v69, v5
    v_and_b32 v14, v69, v6
    v_and_b32 v15, v69, v7
    s_nop 1
    v_mfma_f32_16x16x32_bf16 v[96:99], v[12:15], v[132:135], v[96:99]
    v_mfma_f32_16x16x32_bf16 v[100:103], v[12:15], v[136:139], v[100:103]
    v_mfma_f32_16x16x32_bf16 v[104:107], v[12:15], v[140:143], v[104:107]
    v_and_b32 v8, v70, v4
    v_and_b32 v9, v70, v5
    v_and_b32 v10, v70, v6
    v_and_b32 v11, v70, v7
    s_nop 1
    v_mfma_f32_16x16x32_bf16 v[108:111], v[8:11], v[132:135], v[108:111]
    v_mfma_f32_16x16x32_bf16 v[112:115], v[8:11], v[136:139], v[112:115]
    v_mfma_f32_16x16x32_bf16 v[116:119], v[8:11], v[140:143], v[116:119]
    v_and_b32 v12, v71, v4
    v_and_b32 v13, v71, v5
    v_and_b32 v14, v71, v6
    v_and_b32 v15, v71, v7
    s_nop 1
    v_mfma_f32_16x16x32_bf16 v[120:123], v[12:15], v[132:135], v[120:123]
    v_mfma_f32_16x16x32_bf16 v[124:127], v[12:15], v[136:139], v[124:127]
    v_mfma_f32_16x16x32_bf16 v[128:131], v[12:15], v[140:143], v[128:131]
    s_waitcnt vmcnt(6)
    ds_read_b32 v68, v24 offset:544
    ds_read_b32 v69, v24 offset:3104
    ds_read_b32 v70, v24 offset:5664
    ds_read_b32 v71, v24 offset:8224
    ds_read_b128 v[132:135], v42 offset:19712
    ds_read_b128 v[136:139], v42 offset:20736
    ds_read_b128 v[140:143], v42 offset:21760
    s_waitcnt lgkmcnt(7)
    v_and_b32 v8, v64, v4
    v_and_b32 v9, v64, v5
    v_and_b32 v10, v64, v6
    v_and_b32 v11, v64, v7
    s_nop 1
    v_mfma_f32_16x16x32_bf16 v[84:87], v[8:11], v[44:47], v[84:87]
    v_mfma_f32_16x16x32_bf16 v[88:91], v[8:11], v[48:51], v[88:91]
    v_mfma_f32_16x16x32_bf16 v[92:95], v[8:11], v[52:55], v[92:95]
    v_and_b32 v12, v65, v4
    v_and_b32 v13, v65, v5
    v_and_b32 v14, v65, v6
    v_and_b32 v15, v65, v7
    s_nop 1
    v_mfma_f32_16x16x32_bf16 v[96:99], v[12:15], v[44:47], v[96:99]
    v_mfma_f32_16x16x32_bf16 v[100:103], v[12:15], v[48:51], v[100:103]
    v_mfma_f32_16x16x32_bf16 v[104:107], v[12:15], v[52:55], v[104:107]
    v_and_b32 v8, v66, v4
    v_and_b32 v9, v66, v5
    v_and_b32 v10, v66, v6
    v_and_b32 v11, v66, v7
    s_nop 1
    v_mfma_f32_16x16x32_bf16 v[108:111], v[8:11], v[44:47], v[108:111]
    v_mfma_f32_16x16x32_bf16 v[112:115], v[8:11], v[48:51], v[112:115]
    v_mfma_f32_16x16x32_bf16 v[116:119], v[8:11], v[52:55], v[116:119]
    v_and_b32 v12, v67, v4
    v_and_b32 v13, v67, v5
    v_and_b32 v14, v67, v6
    v_and_b32 v15, v67, v7
    s_nop 1
    v_mfma_f32_16x16x32_bf16 v[120:123], v[12:15], v[44:47], v[120:123]
    v_mfma_f32_16x16x32_bf16 v[124:127], v[12:15], v[48:51], v[124:127]
    v_mfma_f32_16x16x32_bf16 v[128:131], v[12:15], v[52:55], v[128:131]
    s_waitcnt vmcnt(3)
    ds_read_b32 v64, v24 offset:576
    ds_read_b32 v65, v24 offset:3136
    ds_read_b32 v66, v24 offset:5696
    ds_read_b32 v67, v24 offset:8256
    ds_read_b128 v[44:47], v42 offset:22784
    ds_read_b128 v[48:51], v42 offset:23808
    ds_read_b128 v[52:55], v42 offset:24832
    s_waitcnt lgkmcnt(7)
    v_and_b32 v8, v68, v4
    v_and_b32 v9, v68, v5
    v_and_b32 v10, v68, v6
    v_and_b32 v11, v68, v7
    s_nop 1
    v_mfma_f32_16x16x32_bf16 v[84:87], v[8:11], v[132:135], v[84:87]
    v_mfma_f32_16x16x32_bf16 v[88:91], v[8:11], v[136:139], v[88:91]
    v_mfma_f32_16x16x32_bf16 v[92:95], v[8:11], v[140:143], v[92:95]
    v_and_b32 v12, v69, v4
    v_and_b32 v13, v69, v5
    v_and_b32 v14, v69, v6
    v_and_b32 v15, v69, v7
    s_nop 1
    v_mfma_f32_16x16x32_bf16 v[96:99], v[12:15], v[132:135], v[96:99]
    v_mfma_f32_16x16x32_bf16 v[100:103], v[12:15], v[136:139], v[100:103]
    v_mfma_f32_16x16x32_bf16 v[104:107], v[12:15], v[140:143], v[104:107]
    v_and_b32 v8, v70, v4
    v_and_b32 v9, v70, v5
    v_and_b32 v10, v70, v6
    v_and_b32 v11, v70, v7
    s_nop 1
    v_mfma_f32_16x16x32_bf16 v[108:111], v[8:11], v[132:135], v[108:111]
    v_mfma_f32_16x16x32_bf16 v[112:115], v[8:11], v[136:139], v[112:115]
    v_mfma_f32_16x16x32_bf16 v[116:119], v[8:11], v[140:143], v[116:119]
    v_and_b32 v12, v71, v4
    v_and_b32 v13, v71, v5
    v_and_b32 v14, v71, v6
    v_and_b32 v15, v71, v7
    s_nop 1
    v_mfma_f32_16x16x32_bf16 v[120:123], v[12:15], v[132:135], v[120:123]
    v_mfma_f32_16x16x32_bf16 v[124:127], v[12:15], v[136:139], v[124:127]
    v_mfma_f32_16x16x32_bf16 v[128:131], v[12:15], v[140:143], v[128:131]
    s_waitcnt vmcnt(0)
    ds_read_b32 v68, v24 offset:608
    ds_read_b32 v69, v24 offset:3168
    ds_read_b32 v70, v24 offset:5728
    ds_read_b32 v71, v24 offset:8288
    ds_read_b128 v[132:135], v42 offset:25856
    ds_read_b128 v[136:139], v42 offset:26880
    ds_read_b128 v[140:143], v42 offset:27904
    s_waitcnt lgkmcnt(7)
    v_and_b32 v8, v64, v4
    v_and_b32 v9, v64, v5
    v_and_b32 v10, v64, v6
    v_and_b32 v11, v64, v7
    s_nop 1
    v_mfma_f32_16x16x32_bf16 v[84:87], v[8:11], v[44:47], v[84:87]
    v_mfma_f32_16x16x32_bf16 v[88:91], v[8:11], v[48:51], v[88:91]
    v_mfma_f32_16x16x32_bf16 v[92:95], v[8:11], v[52:55], v[92:95]
    v_and_b32 v12, v65, v4
    v_and_b32 v13, v65, v5
    v_and_b32 v14, v65, v6
    v_and_b32 v15, v65, v7
    s_nop 1
    v_mfma_f32_16x16x32_bf16 v[96:99], v[12:15], v[44:47], v[96:99]
    v_mfma_f32_16x16x32_bf16 v[100:103], v[12:15], v[48:51], v[100:103]
    v_mfma_f32_16x16x32_bf16 v[104:107], v[12:15], v[52:55], v[104:107]
    v_and_b32 v8, v66, v4
    v_and_b32 v9, v66, v5
    v_and_b32 v10, v66, v6
    v_and_b32 v11, v66, v7
    s_nop 1
    v_mfma_f32_16x16x32_bf16 v[108:111], v[8:11], v[44:47], v[108:111]
    v_mfma_f32_16x16x32_bf16 v[112:115], v[8:11], v[48:51], v[112:115]
    v_mfma_f32_16x16x32_bf16 v[116:119], v[8:11], v[52:55], v[116:119]
    v_and_b32 v12, v67, v4
    v_and_b32 v13, v67, v5
    v_and_b32 v14, v67, v6
    v_and_b32 v15, v67, v7
    s_nop 1
    v_mfma_f32_16x16x32_bf16 v[120:123], v[12:15], v[44:47], v[120:123]
    v_mfma_f32_16x16x32_bf16 v[124:127], v[12:15], v[48:51], v[124:127]
    v_mfma_f32_16x16x32_bf16 v[128:131], v[12:15], v[52:55], v[128:131]
    s_waitcnt lgkmcnt(0)
    v_and_b32 v8, v68, v4
    v_and_b32 v9, v68, v5
    v_and_b32 v10, v68, v6
    v_and_b32 v11, v68, v7
    s_nop 1
    v_mfma_f32_16x16x32_bf16 v[84:87], v[8:11], v[132:135], v[84:87]
    v_mfma_f32_16x16x32_bf16 v[88:91], v[8:11], v[136:139], v[88:91]
    v_mfma_f32_16x16x32_bf16 v[92:95], v[8:11], v[140:143], v[92:95]
    v_and_b32 v12, v69, v4
    v_and_b32 v13, v69, v5
    v_and_b32 v14, v69, v6
    v_and_b32 v15, v69, v7
    s_nop 1
    v_mfma_f32_16x16x32_bf16 v[96:99], v[12:15], v[132:135], v[96:99]
    v_mfma_f32_16x16x32_bf16 v[100:103], v[12:15], v[136:139], v[100:103]
    v_mfma_f32_16x16x32_bf16 v[104:107], v[12:15], v[140:143], v[104:107]
    v_and_b32 v8, v70, v4
    v_and_b32 v9, v70, v5
    v_and_b32 v10, v70, v6
    v_and_b32 v11, v70, v7
    s_nop 1
    v_mfma_f32_16x16x32_bf16 v[108:111], v[8:11], v[132:135], v[108:111]
    v_mfma_f32_16x16x32_bf16 v[112:115], v[8:11], v[136:139], v[112:115]
    v_mfma_f32_16x16x32_bf16 v[116:119], v[8:11], v[140:143], v[116:119]
    v_and_b32 v12, v71, v4
    v_and_b32 v13, v71, v5
    v_and_b32 v14, v71, v6
    v_and_b32 v15, v71, v7
    s_nop 1
    v_mfma_f32_16x16x32_bf16 v[120:123], v[12:15], v[132:135], v[120:123]
    v_mfma_f32_16x16x32_bf16 v[124:127], v[12:15], v[136:139], v[124:127]
    v_mfma_f32_16x16x32_bf16 v[128:131], v[12:15], v[140:143], v[128:131]
    s_nop 7
    s_mov_b64 exec, s[74:75]
    ds_write_b128 v37, v[84:87] offset:0
    ds_write_b128 v37, v[88:91] offset:256
    ds_write_b128 v37, v[92:95] offset:512
    ds_write_b128 v37, v[96:99] offset:6144
    ds_write_b128 v37, v[100:103] offset:6400
    ds_write_b128 v37, v[104:107] offset:6656
    ds_write_b128 v37, v[108:111] offset:12288
    ds_write_b128 v37, v[112:115] offset:12544
    ds_write_b128 v37, v[116:119] offset:12800
    ds_write_b128 v37, v[120:123] offset:18432
    ds_write_b128 v37, v[124:127] offset:18688
    ds_write_b128 v37, v[128:131] offset:18944
    s_mov_b64 exec, -1
    s_waitcnt lgkmcnt(0)
    s_barrier
    s_mul_i32 s43, s42, 6144
    s_add_u32 s43, s43, 114944
    v_add_u32 v34, s43, v16
    s_mul_i32 s43, s64, 384
    s_mul_i32 s44, s42, 12288
    s_add_u32 s65, s43, s44
    s_mov_b32 exec_lo, -1
    s_mov_b32 exec_hi, 0xffff
    ds_read_b128 v[84:87], v34 offset:0
    ds_read_b128 v[88:91], v34 offset:768
    ds_read_b128 v[92:95], v34 offset:1536
    ds_read_b128 v[96:99], v34 offset:2304
    ds_read_b128 v[100:103], v34 offset:3072
    ds_read_b128 v[104:107], v34 offset:3840
    ds_read_b128 v[108:111], v34 offset:4608
    ds_read_b128 v[112:115], v34 offset:5376
    s_waitcnt lgkmcnt(0)
    v_add_f32 v84, v84, v88
    v_add_f32 v84, v84, v92
    v_add_f32 v84, v84, v96
    v_add_f32 v84, v84, v100
    v_add_f32 v84, v84, v104
    v_add_f32 v84, v84, v108
    v_add_f32 v84, v84, v112
    v_add_f32 v85, v85, v89
    v_add_f32 v85, v85, v93
    v_add_f32 v85, v85, v97
    v_add_f32 v85, v85, v101
    v_add_f32 v85, v85, v105
    v_add_f32 v85, v85, v109
    v_add_f32 v85, v85, v113
    v_add_f32 v86, v86, v90
    v_add_f32 v86, v86, v94
    v_add_f32 v86, v86, v98
    v_add_f32 v86, v86, v102
    v_add_f32 v86, v86, v106
    v_add_f32 v86, v86, v110
    v_add_f32 v86, v86, v114
    v_add_f32 v87, v87, v91
    v_add_f32 v87, v87, v95
    v_add_f32 v87, v87, v99
    v_add_f32 v87, v87, v103
    v_add_f32 v87, v87, v107
    v_add_f32 v87, v87, v111
    v_add_f32 v87, v87, v115
    v_cvt_pk_bf16_f32 v88, v84, v85
    v_cvt_pk_bf16_f32 v89, v86, v87
    v_min_u32 v88, -2, v88
    v_min_u32 v89, -2, v89
    buffer_store_dwordx2 v[88:89], v17, s[28:31], s65 offen sc1
    s_mov_b64 exec, -1
    s_waitcnt vmcnt(0)
    s_barrier
    s_cmp_lg_u32 s42, 0
    s_cbranch_scc1 Lq1f_99
    v_mov_b32 v84, 1
    s_lshl_b32 s43, s64, 2
    s_add_u32 s43, s43, 64
    s_mov_b64 exec, 1
    buffer_atomic_add v84, v18, s[32:35], s43 offen
    s_mov_b64 exec, -1
Lq1f_99:
    v_mov_b32 v84, -1
    v_mov_b32 v85, -1
    v_mov_b32 v86, -1
    v_mov_b32 v87, -1
    v_lshlrev_b32 v34, 4, v2
    s_lshl_b32 s43, s64, 12
    s_add_u32 s43, s43, 49152
Lfill_100:
    buffer_store_dwordx4 v[84:87], v34, s[36:39], s43 offen sc1
    s_add_u32 s43, s43, 196608
    s_cmp_lt_u32 s43, 9314304
    s_cbranch_scc1 Lfill_100
    s_waitcnt vmcnt(0)
    s_barrier
    s_cmp_lg_u32 s42, 0
    s_cbranch_scc1 Larr_101
    v_mov_b32 v84, 1
    s_mov_b64 exec, 1
    buffer_atomic_add v84, v18, s[32:35], 0 offen
    s_mov_b64 exec, -1
Larr_101:
    s_mov_b32 s52, s12
    s_mov_b32 s53, s13
    s_mov_b32 s54, 7864320
    s_mov_b32 s55, 0x00020000
    v_mul_u32_u24 v33, 1280, v19
    v_add_u32 v33, v33, v20
    s_lshr_b32 s43, s64, 1
    s_mul_i32 s43, s43, 384
    s_mul_i32 s44, s42, 96
    s_add_u32 s43, s43, s44
    s_mul_i32 s65, s43, 1280
    s_and_b32 s44, s64, 1
    s_mul_i32 s44, s44, 640
    s_add_u32 s65, s65, s44
    buffer_load_dwordx4 a[0:3], v33, s[52:55], s65 offen offset:0 nt
    buffer_load_dwordx4 a[4:7], v33, s[52:55], s65 offen offset:128 nt
    buffer_load_dwordx4 a[8:11], v33, s[52:55], s65 offen offset:256 nt
    buffer_load_dwordx4 a[12:15], v33, s[52:55], s65 offen offset:384 nt
    buffer_load_dwordx4 a[16:19], v33, s[52:55], s65 offen offset:512 nt
    s_add_u32 s65, s65, 10240
    buffer_load_dwordx4 a[20:23], v33, s[52:55], s65 offen offset:0 nt
    buffer_load_dwordx4 a[24:27], v33, s[52:55], s65 offen offset:128 nt
    buffer_load_dwordx4 a[28:31], v33, s[52:55], s65 offen offset:256 nt
    buffer_load_dwordx4 a[32:35], v33, s[52:55], s65 offen offset:384 nt
    buffer_load_dwordx4 a[36:39], v33, s[52:55], s65 offen offset:512 nt
    s_add_u32 s65, s65, 10240
    buffer_load_dwordx4 a[40:43], v33, s[52:55], s65 offen offset:0 nt
    buffer_load_dwordx4 a[44:47], v33, s[52:55], s65 offen offset:128 nt
    buffer_load_dwordx4 a[48:51], v33, s[52:55], s65 offen offset:256 nt
    buffer_load_dwordx4 a[52:55], v33, s[52:55], s65 offen offset:384 nt
    buffer_load_dwordx4 a[56:59], v33, s[52:55], s65 offen offset:512 nt
    s_add_u32 s65, s65, 10240
    buffer_load_dwordx4 a[60:63], v33, s[52:55], s65 offen offset:0 nt
    buffer_load_dwordx4 a[64:67], v33, s[52:55], s65 offen offset:128 nt
    buffer_load_dwordx4 a[68:71], v33, s[52:55], s65 offen offset:256 nt
    buffer_load_dwordx4 a[72:75], v33, s[52:55], s65 offen offset:384 nt
    buffer_load_dwordx4 a[76:79], v33, s[52:55], s65 offen offset:512 nt
    s_add_u32 s65, s65, 10240
    buffer_load_dwordx4 a[80:83], v33, s[52:55], s65 offen offset:0 nt
    buffer_load_dwordx4 a[84:87], v33, s[52:55], s65 offen offset:128 nt
    buffer_load_dwordx4 a[88:91], v33, s[52:55], s65 offen offset:256 nt
    buffer_load_dwordx4 a[92:95], v33, s[52:55], s65 offen offset:384 nt
    buffer_load_dwordx4 a[96:99], v33, s[52:55], s65 offen offset:512 nt
    s_add_u32 s65, s65, 10240
    buffer_load_dwordx4 a[100:103], v33, s[52:55], s65 offen offset:0 nt
    buffer_load_dwordx4 a[104:107], v33, s[52:55], s65 offen offset:128 nt
    buffer_load_dwordx4 a[108:111], v33, s[52:55], s65 offen offset:256 nt
    buffer_load_dwordx4 a[112:115], v33, s[52:55], s65 offen offset:384 nt
    buffer_load_dwordx4 a[116:119], v33, s[52:55], s65 offen offset:512 nt
    s_add_u32 s65, s65, 10240
    buffer_load_dwordx4 a[120:123], v33, s[52:55], s65 offen offset:0 nt
    buffer_load_dwordx4 a[124:127], v33, s[52:55], s65 offen offset:128 nt
    buffer_load_dwordx4 a[128:131], v33, s[52:55], s65 offen offset:256 nt
    buffer_load_dwordx4 a[132:135], v33, s[52:55], s65 offen offset:384 nt
    buffer_load_dwordx4 a[136:139], v33, s[52:55], s65 offen offset:512 nt
    s_add_u32 s65, s65, 10240
    buffer_load_dwordx4 a[140:143], v33, s[52:55], s65 offen offset:0 nt
    buffer_load_dwordx4 a[144:147], v33, s[52:55], s65 offen offset:128 nt
    buffer_load_dwordx4 a[148:151], v33, s[52:55], s65 offen offset:256 nt
    buffer_load_dwordx4 a[152:155], v33, s[52:55], s65 offen offset:384 nt
    buffer_load_dwordx4 a[156:159], v33, s[52:55], s65 offen offset:512 nt
    s_add_u32 s65, s65, 10240
    buffer_load_dwordx4 a[160:163], v33, s[52:55], s65 offen offset:0 nt
    buffer_load_dwordx4 a[164:167], v33, s[52:55], s65 offen offset:128 nt
    buffer_load_dwordx4 a[168:171], v33, s[52:55], s65 offen offset:256 nt
    buffer_load_dwordx4 a[172:175], v33, s[52:55], s65 offen offset:384 nt
    buffer_load_dwordx4 a[176:179], v33, s[52:55], s65 offen offset:512 nt
    s_add_u32 s65, s65, 10240
    buffer_load_dwordx4 a[180:183], v33, s[52:55], s65 offen offset:0 nt
    buffer_load_dwordx4 a[184:187], v33, s[52:55], s65 offen offset:128 nt
    buffer_load_dwordx4 a[188:191], v33, s[52:55], s65 offen offset:256 nt
    buffer_load_dwordx4 a[192:195], v33, s[52:55], s65 offen offset:384 nt
    buffer_load_dwordx4 a[196:199], v33, s[52:55], s65 offen offset:512 nt
    s_add_u32 s65, s65, 10240
    buffer_load_dwordx4 a[200:203], v33, s[52:55], s65 offen offset:0 nt
    buffer_load_dwordx4 a[204:207], v33, s[52:55], s65 offen offset:128 nt
    buffer_load_dwordx4 a[208:211], v33, s[52:55], s65 offen offset:256 nt
    buffer_load_dwordx4 a[212:215], v33, s[52:55], s65 offen offset:384 nt
    buffer_load_dwordx4 a[216:219], v33, s[52:55], s65 offen offset:512 nt
    s_add_u32 s65, s65, 10240
    buffer_load_dwordx4 a[220:223], v33, s[52:55], s65 offen offset:0 nt
    buffer_load_dwordx4 a[224:227], v33, s[52:55], s65 offen offset:128 nt
    buffer_load_dwordx4 a[228:231], v33, s[52:55], s65 offen offset:256 nt
    buffer_load_dwordx4 a[232:235], v33, s[52:55], s65 offen offset:384 nt
    buffer_load_dwordx4 a[236:239], v33, s[52:55], s65 offen offset:512 nt
    s_add_u32 s65, s65, 10240
    s_waitcnt vmcnt(0)
    s_cmp_lg_u32 s42, 0
    s_cbranch_scc1 Liniw_102
    s_mov_b32 s46, 0
    v_mov_b32 v85, 0
Lpoll_103:
    buffer_load_dword v84, v85, s[32:35], 0 offen sc1
    s_waitcnt vmcnt(0)
    v_readfirstlane_b32 s43, v84
    s_cmp_ge_u32 s43, 48
    s_cbranch_scc1 Lok_104
    s_sleep 8
    s_add_u32 s46, s46, 1
    s_cmp_lt_u32 s46, 524288
    s_cbranch_scc1 Lpoll_103
Lok_104:
Liniw_102:
    s_barrier
    s_mov_b32 s67, 0
L_ptask:
    s_barrier
    s_lshl_b32 s43, s67, 2
    s_lshr_b32 s66, 0x75634210, s43
    s_and_b32 s66, s66, 15
    s_and_b32 s68, s66, 3
    s_mov_b32 s43, 36
    s_bitcmp0_b32 s43, s66
    s_cbranch_scc1 Ls1one_105
    s_lshr_b32 s72, s66, 2
    s_add_u32 s72, s72, 8
    s_swappc_b64 s[84:85], s[80:81]
    v_mov_b32 v54, v31
    v_mov_b32 v55, v32
    v_mov_b32 v56, v44
    v_mov_b32 v57, v45
    v_mov_b32 v58, v46
    s_mov_b32 s72, s66
    s_swappc_b64 s[84:85], s[80:81]
    v_max_f32 v33, v31, v54
    v_sub_f32 v31, v31, v33
    v_sub_f32 v34, v54, v33
    v_exp_f32 v31, v31
    v_exp_f32 v34, v34
    s_nop 0
    v_mul_f32 v32, v32, v31
    v_fmac_f32 v32, v55, v34
    v_mul_f32 v44, v44, v31
    v_fmac_f32 v44, v56, v34
    v_mul_f32 v45, v45, v31
    v_fmac_f32 v45, v57, v34
    v_mul_f32 v46, v46, v31
    v_fmac_f32 v46, v58, v34
    s_branch Ls1done_106
Ls1one_105:
    s_mov_b32 s72, s66
    s_swappc_b64 s[84:85], s[80:81]
Ls1done_106:
    v_rcp_f32 v32, v32
    s_nop 0
    v_mul_f32 v44, v44, v32
    v_cvt_pk_bf16_f32 v44, v44, v44
    v_mul_f32 v45, v45, v32
    v_cvt_pk_bf16_f32 v45, v45, v45
    v_mul_f32 v46, v46, v32
    v_cvt_pk_bf16_f32 v46, v46, v46
    s_mul_i32 s43, s42, 384
    s_add_u32 s43, s43, 160000
    v_and_b32 v33, 31, v0
    v_mul_u32_u24 v33, 12, v33
    v_add_u32 v33, s43, v33
    ds_write_b32 v33, v44 offset:0
    ds_write_b32 v33, v45 offset:4
    ds_write_b32 v33, v46 offset:8
    v_lshlrev_b32 v34, 2, v19
    v_add_u32 v34, s43, v34
    s_waitcnt lgkmcnt(0)
    ds_read_b32 v64, v34 offset:0
    ds_read_b32 v65, v34 offset:32
    ds_read_b32 v66, v34 offset:64
    ds_read_b32 v67, v34 offset:96
    ds_read_b32 v68, v34 offset:128
    ds_read_b32 v69, v34 offset:160
    ds_read_b32 v70, v34 offset:192
    ds_read_b32 v71, v34 offset:224
    ds_read_b32 v72, v34 offset:256
    ds_read_b32 v73, v34 offset:288
    ds_read_b32 v74, v34 offset:320
    ds_read_b32 v75, v34 offset:352
    s_waitcnt lgkmcnt(0)
    s_waitcnt lgkmcnt(0)
    v_and_b32 v8, v64, v4
    v_and_b32 v9, v64, v5
    v_and_b32 v10, v64, v6
    v_and_b32 v11, v64, v7
    s_nop 1
    v_mfma_f32_16x16x32_bf16 v[84:87], v[8:11], a[0:3], 0
    v_mfma_f32_16x16x32_bf16 v[88:91], v[8:11], a[4:7], 0
    v_mfma_f32_16x16x32_bf16 v[92:95], v[8:11], a[8:11], 0
    v_mfma_f32_16x16x32_bf16 v[96:99], v[8:11], a[12:15], 0
    v_mfma_f32_16x16x32_bf16 v[100:103], v[8:11], a[16:19], 0
    v_and_b32 v12, v65, v4
    v_and_b32 v13, v65, v5
    v_and_b32 v14, v65, v6
    v_and_b32 v15, v65, v7
    s_nop 1
    v_mfma_f32_16x16x32_bf16 v[84:87], v[12:15], a[20:23], v[84:87]
    v_mfma_f32_16x16x32_bf16 v[88:91], v[12:15], a[24:27], v[88:91]
    v_mfma_f32_16x16x32_bf16 v[92:95], v[12:15], a[28:31], v[92:95]
    v_mfma_f32_16x16x32_bf16 v[96:99], v[12:15], a[32:35], v[96:99]
    v_mfma_f32_16x16x32_bf16 v[100:103], v[12:15], a[36:39], v[100:103]
    v_and_b32 v8, v66, v4
    v_and_b32 v9, v66, v5
    v_and_b32 v10, v66, v6
    v_and_b32 v11, v66, v7
    s_nop 1
    v_mfma_f32_16x16x32_bf16 v[84:87], v[8:11], a[40:43], v[84:87]
    v_mfma_f32_16x16x32_bf16 v[88:91], v[8:11], a[44:47], v[88:91]
    v_mfma_f32_16x16x32_bf16 v[92:95], v[8:11], a[48:51], v[92:95]
    v_mfma_f32_16x16x32_bf16 v[96:99], v[8:11], a[52:55], v[96:99]
    v_mfma_f32_16x16x32_bf16 v[100:103], v[8:11], a[56:59], v[100:103]
    v_and_b32 v12, v67, v4
    v_and_b32 v13, v67, v5
    v_and_b32 v14, v67, v6
    v_and_b32 v15, v67, v7
    s_nop 1
    v_mfma_f32_16x16x32_bf16 v[84:87], v[12:15], a[60:63], v[84:87]
    v_mfma_f32_16x16x32_bf16 v[88:91], v[12:15], a[64:67], v[88:91]
    v_mfma_f32_16x16x32_bf16 v[92:95], v[12:15], a[68:71], v[92:95]
    v_mfma_f32_16x16x32_bf16 v[96:99], v[12:15], a[72:75], v[96:99]
    v_mfma_f32_16x16x32_bf16 v[100:103], v[12:15], a[76:79], v[100:103]
    v_and_b32 v8, v68, v4
    v_and_b32 v9, v68, v5
    v_and_b32 v10, v68, v6
    v_and_b32 v11, v68, v7
    s_nop 1
    v_mfma_f32_16x16x32_bf16 v[84:87], v[8:11], a[80:83], v[84:87]
    v_mfma_f32_16x16x32_bf16 v[88:91], v[8:11], a[84:87], v[88:91]
    v_mfma_f32_16x16x32_bf16 v[92:95], v[8:11], a[88:91], v[92:95]
    v_mfma_f32_16x16x32_bf16 v[96:99], v[8:11], a[92:95], v[96:99]
    v_mfma_f32_16x16x32_bf16 v[100:103], v[8:11], a[96:99], v[100:103]
    v_and_b32 v12, v69, v4
    v_and_b32 v13, v69, v5
    v_and_b32 v14, v69, v6
    v_and_b32 v15, v69, v7
    s_nop 1
    v_mfma_f32_16x16x32_bf16 v[84:87], v[12:15], a[100:103], v[84:87]
    v_mfma_f32_16x16x32_bf16 v[88:91], v[12:15], a[104:107], v[88:91]
    v_mfma_f32_16x16x32_bf16 v[92:95], v[12:15], a[108:111], v[92:95]
    v_mfma_f32_16x16x32_bf16 v[96:99], v[12:15], a[112:115], v[96:99]
    v_mfma_f32_16x16x32_bf16 v[100:103], v[12:15], a[116:119], v[100:103]
    v_and_b32 v8, v70, v4
    v_and_b32 v9, v70, v5
    v_and_b32 v10, v70, v6
    v_and_b32 v11, v70, v7
    s_nop 1
    v_mfma_f32_16x16x32_bf16 v[84:87], v[8:11], a[120:123], v[84:87]
    v_mfma_f32_16x16x32_bf16 v[88:91], v[8:11], a[124:127], v[88:91]
    v_mfma_f32_16x16x32_bf16 v[92:95], v[8:11], a[128:131], v[92:95]
    v_mfma_f32_16x16x32_bf16 v[96:99], v[8:11], a[132:135], v[96:99]
    v_mfma_f32_16x16x32_bf16 v[100:103], v[8:11], a[136:139], v[100:103]
    v_and_b32 v12, v71, v4
    v_and_b32 v13, v71, v5
    v_and_b32 v14, v71, v6
    v_and_b32 v15, v71, v7
    s_nop 1
    v_mfma_f32_16x16x32_bf16 v[84:87], v[12:15], a[140:143], v[84:87]
    v_mfma_f32_16x16x32_bf16 v[88:91], v[12:15], a[144:147], v[88:91]
    v_mfma_f32_16x16x32_bf16 v[92:95], v[12:15], a[148:151], v[92:95]
    v_mfma_f32_16x16x32_bf16 v[96:99], v[12:15], a[152:155], v[96:99]
    v_mfma_f32_16x16x32_bf16 v[100:103], v[12:15], a[156:159], v[100:103]
    v_and_b32 v8, v72, v4
    v_and_b32 v9, v72, v5
    v_and_b32 v10, v72, v6
    v_and_b32 v11, v72, v7
    s_nop 1
    v_mfma_f32_16x16x32_bf16 v[84:87], v[8:11], a[160:163], v[84:87]
    v_mfma_f32_16x16x32_bf16 v[88:91], v[8:11], a[164:167], v[88:91]
    v_mfma_f32_16x16x32_bf16 v[92:95], v[8:11], a[168:171], v[92:95]
    v_mfma_f32_16x16x32_bf16 v[96:99], v[8:11], a[172:175], v[96:99]
    v_mfma_f32_16x16x32_bf16 v[100:103], v[8:11], a[176:179], v[100:103]
    v_and_b32 v12, v73, v4
    v_and_b32 v13, v73, v5
    v_and_b32 v14, v73, v6
    v_and_b32 v15, v73, v7
    s_nop 1
    v_mfma_f32_16x16x32_bf16 v[84:87], v[12:15], a[180:183], v[84:87]
    v_mfma_f32_16x16x32_bf16 v[88:91], v[12:15], a[184:187], v[88:91]
    v_mfma_f32_16x16x32_bf16 v[92:95], v[12:15], a[188:191], v[92:95]
    v_mfma_f32_16x16x32_bf16 v[96:99], v[12:15], a[192:195], v[96:99]
    v_mfma_f32_16x16x32_bf16 v[100:103], v[12:15], a[196:199], v[100:103]
    v_and_b32 v8, v74, v4
    v_and_b32 v9, v74, v5
    v_and_b32 v10, v74, v6
    v_and_b32 v11, v74, v7
    s_nop 1
    v_mfma_f32_16x16x32_bf16 v[84:87], v[8:11], a[200:203], v[84:87]
    v_mfma_f32_16x16x32_bf16 v[88:91], v[8:11], a[204:207], v[88:91]
    v_mfma_f32_16x16x32_bf16 v[92:95], v[8:11], a[208:211], v[92:95]
    v_mfma_f32_16x16x32_bf16 v[96:99], v[8:11], a[212:215], v[96:99]
    v_mfma_f32_16x16x32_bf16 v[100:103], v[8:11], a[216:219], v[100:103]
    v_and_b32 v12, v75, v4
    v_and_b32 v13, v75, v5
    v_and_b32 v14, v75, v6
    v_and_b32 v15, v75, v7
    s_nop 1
    v_mfma_f32_16x16x32_bf16 v[84:87], v[12:15], a[220:223], v[84:87]
    v_mfma_f32_16x16x32_bf16 v[88:91], v[12:15], a[224:227], v[88:91]
    v_mfma_f32_16x16x32_bf16 v[92:95], v[12:15], a[228:231], v[92:95]
    v_mfma_f32_16x16x32_bf16 v[96:99], v[12:15], a[232:235], v[96:99]
    v_mfma_f32_16x16x32_bf16 v[100:103], v[12:15], a[236:239], v[100:103]
    s_nop 7
    s_mov_b64 exec, s[74:75]
    ds_write_b128 v38, v[84:87] offset:0
    ds_write_b128 v38, v[88:91] offset:256
    ds_write_b128 v38, v[92:95] offset:512
    ds_write_b128 v38, v[96:99] offset:768
    ds_write_b128 v38, v[100:103] offset:1024
    s_mov_b64 exec, -1
    s_waitcnt lgkmcnt(0)
    s_barrier
    s_cmp_ge_u32 s42, 2
    s_cbranch_scc1 Lnoao_107
    s_cmp_eq_u32 s42, 0
    s_cselect_b64 exec, -1, 0xffff
    v_lshlrev_b32 v33, 4, v2
    v_add_u32 v34, 114944, v33
    ds_read_b128 v[84:87], v34 offset:0
    ds_read_b128 v[88:91], v34 offset:1280
    ds_read_b128 v[92:95], v34 offset:2560
    ds_read_b128 v[96:99], v34 offset:3840
    ds_read_b128 v[100:103], v34 offset:5120
    ds_read_b128 v[104:107], v34 offset:6400
    ds_read_b128 v[108:111], v34 offset:7680
    ds_read_b128 v[112:115], v34 offset:8960
    s_waitcnt lgkmcnt(0)
    v_add_f32 v84, v84, v88
    v_add_f32 v84, v84, v92
    v_add_f32 v84, v84, v96
    v_add_f32 v84, v84, v100
    v_add_f32 v84, v84, v104
    v_add_f32 v84, v84, v108
    v_add_f32 v84, v84, v112
    v_min_u32 v84, -2, v84
    v_add_f32 v85, v85, v89
    v_add_f32 v85, v85, v93
    v_add_f32 v85, v85, v97
    v_add_f32 v85, v85, v101
    v_add_f32 v85, v85, v105
    v_add_f32 v85, v85, v109
    v_add_f32 v85, v85, v113
    v_min_u32 v85, -2, v85
    v_add_f32 v86, v86, v90
    v_add_f32 v86, v86, v94
    v_add_f32 v86, v86, v98
    v_add_f32 v86, v86, v102
    v_add_f32 v86, v86, v106
    v_add_f32 v86, v86, v110
    v_add_f32 v86, v86, v114
    v_min_u32 v86, -2, v86
    v_add_f32 v87, v87, v91
    v_add_f32 v87, v87, v95
    v_add_f32 v87, v87, v99
    v_add_f32 v87, v87, v103
    v_add_f32 v87, v87, v107
    v_add_f32 v87, v87, v111
    v_add_f32 v87, v87, v115
    v_min_u32 v87, -2, v87
    s_mul_i32 s43, s66, 40960
    s_mul_i32 s44, s64, 1280
    s_add_u32 s43, s43, s44
    s_add_u32 s43, s43, 139264
    buffer_store_dwordx4 v[84:87], v33, s[28:31], s43 offen sc1
    s_mov_b64 exec, -1
Lnoao_107:
    s_cmp_ge_u32 s66, 4
    s_cbranch_scc1 Lpnext_108
    s_mul_i32 s65, s66, 5120
    s_add_u32 s65, s65, 98304
    s_swappc_b64 s[84:85], s[82:83]
    s_mul_i32 s71, s66, 40960
    s_add_u32 s71, s71, 466944
    s_swappc_b64 s[84:85], s[78:79]
    s_add_u32 s43, s64, s42
    s_cmp_lg_u32 s43, 0
    s_cbranch_scc1 Lnox2_109
    s_add_u32 s65, s65, 2560
    buffer_store_dwordx4 v[44:47], v16, s[28:31], s65 offen sc1
    buffer_store_dwordx4 v[48:51], v16, s[28:31], s65 offen offset:1024 sc1
    buffer_store_dwordx2 v[52:53], v17, s[28:31], s65 offen offset:2048 sc1
Lnox2_109:
    s_swappc_b64 s[84:85], s[76:77]
    ds_read_b32 v64, v23 offset:0
    ds_read_b32 v65, v23 offset:32
    ds_read_b32 v66, v23 offset:64
    ds_read_b32 v67, v23 offset:96
    ds_read_b32 v68, v23 offset:128
    ds_read_b32 v69, v23 offset:160
    ds_read_b32 v70, v23 offset:192
    ds_read_b32 v71, v23 offset:224
    ds_read_b32 v72, v23 offset:256
    ds_read_b32 v73, v23 offset:288
    ds_read_b32 v74, v23 offset:320
    ds_read_b32 v75, v23 offset:352
    s_waitcnt lgkmcnt(0)
    ds_read_b32 v76, v23 offset:384
    ds_read_b32 v77, v23 offset:416
    ds_read_b32 v78, v23 offset:448
    ds_read_b32 v79, v23 offset:480
    ds_read_b32 v80, v23 offset:512
    ds_read_b32 v81, v23 offset:544
    ds_read_b32 v82, v23 offset:576
    ds_read_b32 v83, v23 offset:608
    s_waitcnt lgkmcnt(0)
    v_and_b32 v8, v64, v4
    v_and_b32 v9, v64, v5
    v_and_b32 v10, v64, v6
    v_and_b32 v11, v64, v7
    s_nop 1
    v_mfma_f32_16x16x32_bf16 v[84:87], v[8:11], a[240:243], 0
    v_mfma_f32_16x16x32_bf16 v[88:91], v[8:11], a[244:247], 0
    v_mfma_f32_16x16x32_bf16 v[92:95], v[8:11], a[248:251], 0
    v_and_b32 v12, v65, v4
    v_and_b32 v13, v65, v5
    v_and_b32 v14, v65, v6
    v_and_b32 v15, v65, v7
    s_nop 1
    v_mfma_f32_16x16x32_bf16 v[84:87], v[12:15], a[252:255], v[84:87]
    v_mfma_f32_16x16x32_bf16 v[88:91], v[12:15], v[144:147], v[88:91]
    v_mfma_f32_16x16x32_bf16 v[92:95], v[12:15], v[148:151], v[92:95]
    v_and_b32 v8, v66, v4
    v_and_b32 v9, v66, v5
    v_and_b32 v10, v66, v6
    v_and_b32 v11, v66, v7
    s_nop 1
    v_mfma_f32_16x16x32_bf16 v[84:87], v[8:11], v[152:155], v[84:87]
    v_mfma_f32_16x16x32_bf16 v[88:91], v[8:11], v[156:159], v[88:91]
    v_mfma_f32_16x16x32_bf16 v[92:95], v[8:11], v[160:163], v[92:95]
    v_and_b32 v12, v67, v4
    v_and_b32 v13, v67, v5
    v_and_b32 v14, v67, v6
    v_and_b32 v15, v67, v7
    s_nop 1
    v_mfma_f32_16x16x32_bf16 v[84:87], v[12:15], v[164:167], v[84:87]
    v_mfma_f32_16x16x32_bf16 v[88:91], v[12:15], v[168:171], v[88:91]
    v_mfma_f32_16x16x32_bf16 v[92:95], v[12:15], v[172:175], v[92:95]
    v_and_b32 v8, v68, v4
    v_and_b32 v9, v68, v5
    v_and_b32 v10, v68, v6
    v_and_b32 v11, v68, v7
    s_nop 1
    v_mfma_f32_16x16x32_bf16 v[84:87], v[8:11], v[176:179], v[84:87]
    v_mfma_f32_16x16x32_bf16 v[88:91], v[8:11], v[180:183], v[88:91]
    v_mfma_f32_16x16x32_bf16 v[92:95], v[8:11], v[184:187], v[92:95]
    v_and_b32 v12, v69, v4
    v_and_b32 v13, v69, v5
    v_and_b32 v14, v69, v6
    v_and_b32 v15, v69, v7
    s_nop 1
    v_mfma_f32_16x16x32_bf16 v[84:87], v[12:15], v[188:191], v[84:87]
    v_mfma_f32_16x16x32_bf16 v[88:91], v[12:15], v[192:195], v[88:91]
    v_mfma_f32_16x16x32_bf16 v[92:95], v[12:15], v[196:199], v[92:95]
    v_and_b32 v8, v70, v4
    v_and_b32 v9, v70, v5
    v_and_b32 v10, v70, v6
    v_and_b32 v11, v70, v7
    s_nop 1
    v_mfma_f32_16x16x32_bf16 v[84:87], v[8:11], v[200:203], v[84:87]
    v_mfma_f32_16x16x32_bf16 v[88:91], v[8:11], v[204:207], v[88:91]
    v_mfma_f32_16x16x32_bf16 v[92:95], v[8:11], v[208:211], v[92:95]
    v_and_b32 v12, v71, v4
    v_and_b32 v13, v71, v5
    v_and_b32 v14, v71, v6
    v_and_b32 v15, v71, v7
    s_nop 1
    v_mfma_f32_16x16x32_bf16 v[84:87], v[12:15], v[212:215], v[84:87]
    v_mfma_f32_16x16x32_bf16 v[88:91], v[12:15], v[216:219], v[88:91]
    v_mfma_f32_16x16x32_bf16 v[92:95], v[12:15], v[220:223], v[92:95]
    v_and_b32 v8, v72, v4
    v_and_b32 v9, v72, v5
    v_and_b32 v10, v72, v6
    v_and_b32 v11, v72, v7
    s_nop 1
    v_mfma_f32_16x16x32_bf16 v[84:87], v[8:11], v[224:227], v[84:87]
    v_mfma_f32_16x16x32_bf16 v[88:91], v[8:11], v[228:231], v[88:91]
    v_mfma_f32_16x16x32_bf16 v[92:95], v[8:11], v[232:235], v[92:95]
    ds_read_b128 v[52:55], v42 offset:256
    v_and_b32 v12, v73, v4
    v_and_b32 v13, v73, v5
    v_and_b32 v14, v73, v6
    v_and_b32 v15, v73, v7
    s_nop 1
    v_mfma_f32_16x16x32_bf16 v[84:87], v[12:15], v[236:239], v[84:87]
    v_mfma_f32_16x16x32_bf16 v[88:91], v[12:15], v[240:243], v[88:91]
    v_mfma_f32_16x16x32_bf16 v[92:95], v[12:15], v[244:247], v[92:95]
    ds_read_b128 v[132:135], v42 offset:1280
    ds_read_b128 v[136:139], v42 offset:2304
    ds_read_b128 v[140:143], v42 offset:3328
    v_and_b32 v8, v74, v4
    v_and_b32 v9, v74, v5
    v_and_b32 v10, v74, v6
    v_and_b32 v11, v74, v7
    s_waitcnt lgkmcnt(3)
    s_nop 1
    v_mfma_f32_16x16x32_bf16 v[84:87], v[8:11], v[248:251], v[84:87]
    v_mfma_f32_16x16x32_bf16 v[88:91], v[8:11], v[252:255], v[88:91]
    v_mfma_f32_16x16x32_bf16 v[92:95], v[8:11], v[52:55], v[92:95]
    ds_read_b128 v[44:47], v42 offset:4352
    ds_read_b128 v[48:51], v42 offset:5376
    ds_read_b128 v[52:55], v42 offset:6400
    v_and_b32 v12, v75, v4
    v_and_b32 v13, v75, v5
    v_and_b32 v14, v75, v6
    v_and_b32 v15, v75, v7
    s_waitcnt lgkmcnt(3)
    s_nop 1
    v_mfma_f32_16x16x32_bf16 v[84:87], v[12:15], v[132:135], v[84:87]
    v_mfma_f32_16x16x32_bf16 v[88:91], v[12:15], v[136:139], v[88:91]
    v_mfma_f32_16x16x32_bf16 v[92:95], v[12:15], v[140:143], v[92:95]
    ds_read_b128 v[132:135], v42 offset:7424
    ds_read_b128 v[136:139], v42 offset:8448
    ds_read_b128 v[140:143], v42 offset:9472
    v_and_b32 v8, v76, v4
    v_and_b32 v9, v76, v5
    v_and_b32 v10, v76, v6
    v_and_b32 v11, v76, v7
    s_waitcnt lgkmcnt(3)
    s_nop 1
    v_mfma_f32_16x16x32_bf16 v[84:87], v[8:11], v[44:47], v[84:87]
    v_mfma_f32_16x16x32_bf16 v[88:91], v[8:11], v[48:51], v[88:91]
    v_mfma_f32_16x16x32_bf16 v[92:95], v[8:11], v[52:55], v[92:95]
    ds_read_b128 v[44:47], v42 offset:10496
    ds_read_b128 v[48:51], v42 offset:11520
    ds_read_b128 v[52:55], v42 offset:12544
    v_and_b32 v12, v77, v4
    v_and_b32 v13, v77, v5
    v_and_b32 v14, v77, v6
    v_and_b32 v15, v77, v7
    s_waitcnt lgkmcnt(3)
    s_nop 1
    v_mfma_f32_16x16x32_bf16 v[84:87], v[12:15], v[132:135], v[84:87]
    v_mfma_f32_16x16x32_bf16 v[88:91], v[12:15], v[136:139], v[88:91]
    v_mfma_f32_16x16x32_bf16 v[92:95], v[12:15], v[140:143], v[92:95]
    ds_read_b128 v[132:135], v42 offset:13568
    ds_read_b128 v[136:139], v42 offset:14592
    ds_read_b128 v[140:143], v42 offset:15616
    v_and_b32 v8, v78, v4
    v_and_b32 v9, v78, v5
    v_and_b32 v10, v78, v6
    v_and_b32 v11, v78, v7
    s_waitcnt lgkmcnt(3)
    s_nop 1
    v_mfma_f32_16x16x32_bf16 v[84:87], v[8:11], v[44:47], v[84:87]
    v_mfma_f32_16x16x32_bf16 v[88:91], v[8:11], v[48:51], v[88:91]
    v_mfma_f32_16x16x32_bf16 v[92:95], v[8:11], v[52:55], v[92:95]
    ds_read_b128 v[44:47], v42 offset:16640
    ds_read_b128 v[48:51], v42 offset:17664
    ds_read_b128 v[52:55], v42 offset:18688
    v_and_b32 v12, v79, v4
    v_and_b32 v13, v79, v5
    v_and_b32 v14, v79, v6
    v_and_b32 v15, v79, v7
    s_waitcnt lgkmcnt(3)
    s_nop 1
    v_mfma_f32_16x16x32_bf16 v[84:87], v[12:15], v[132:135], v[84:87]
    v_mfma_f32_16x16x32_bf16 v[88:91], v[12:15], v[136:139], v[88:91]
    v_mfma_f32_16x16x32_bf16 v[92:95], v[12:15], v[140:143], v[92:95]
    ds_read_b128 v[132:135], v42 offset:19712
    ds_read_b128 v[136:139], v42 offset:20736
    ds_read_b128 v[140:143], v42 offset:21760
    v_and_b32 v8, v80, v4
    v_and_b32 v9, v80, v5
    v_and_b32 v10, v80, v6
    v_and_b32 v11, v80, v7
    s_waitcnt lgkmcnt(3)
    s_nop 1
    v_mfma_f32_16x16x32_bf16 v[84:87], v[8:11], v[44:47], v[84:87]
    v_mfma_f32_16x16x32_bf16 v[88:91], v[8:11], v[48:51], v[88:91]
    v_mfma_f32_16x16x32_bf16 v[92:95], v[8:11], v[52:55], v[92:95]
    ds_read_b128 v[44:47], v42 offset:22784
    ds_read_b128 v[48:51], v42 offset:23808
    ds_read_b128 v[52:55], v42 offset:24832
    v_and_b32 v12, v81, v4
    v_and_b32 v13, v81, v5
    v_and_b32 v14, v81, v6
    v_and_b32 v15, v81, v7
    s_waitcnt lgkmcnt(3)
    s_nop 1
    v_mfma_f32_16x16x32_bf16 v[84:87], v[12:15], v[132:135], v[84:87]
    v_mfma_f32_16x16x32_bf16 v[88:91], v[12:15], v[136:139], v[88:91]
    v_mfma_f32_16x16x32_bf16 v[92:95], v[12:15], v[140:143], v[92:95]
    ds_read_b128 v[132:135], v42 offset:25856
    ds_read_b128 v[136:139], v42 offset:26880
    ds_read_b128 v[140:143], v42 offset:27904
    v_and_b32 v8, v82, v4
    v_and_b32 v9, v82, v5
    v_and_b32 v10, v82, v6
    v_and_b32 v11, v82, v7
    s_waitcnt lgkmcnt(3)
    s_nop 1
    v_mfma_f32_16x16x32_bf16 v[84:87], v[8:11], v[44:47], v[84:87]
    v_mfma_f32_16x16x32_bf16 v[88:91], v[8:11], v[48:51], v[88:91]
    v_mfma_f32_16x16x32_bf16 v[92:95], v[8:11], v[52:55], v[92:95]
    v_and_b32 v12, v83, v4
    v_and_b32 v13, v83, v5
    v_and_b32 v14, v83, v6
    v_and_b32 v15, v83, v7
    s_waitcnt lgkmcnt(0)
    s_nop 1
    v_mfma_f32_16x16x32_bf16 v[84:87], v[12:15], v[132:135], v[84:87]
    v_mfma_f32_16x16x32_bf16 v[88:91], v[12:15], v[136:139], v[88:91]
    v_mfma_f32_16x16x32_bf16 v[92:95], v[12:15], v[140:143], v[92:95]
    s_nop 7
    s_mov_b64 exec, s[74:75]
    ds_write_b128 v37, v[84:87] offset:12288
    ds_write_b128 v37, v[88:91] offset:12544
    ds_write_b128 v37, v[92:95] offset:12800
    s_mov_b64 exec, -1
    s_waitcnt lgkmcnt(0)
    s_barrier
    s_cmp_lg_u32 s42, 0
    s_cbranch_scc1 Lpnext_108
    v_add_u32 v34, 127232, v16
    s_add_u32 s44, s66, 4
    s_mul_i32 s44, s44, 12288
    s_mul_i32 s43, s64, 384
    s_add_u32 s65, s43, s44
    s_mov_b32 exec_lo, -1
    s_mov_b32 exec_hi, 0xffff
    ds_read_b128 v[84:87], v34 offset:0
    ds_read_b128 v[88:91], v34 offset:768
    ds_read_b128 v[92:95], v34 offset:1536
    ds_read_b128 v[96:99], v34 offset:2304
    ds_read_b128 v[100:103], v34 offset:3072
    ds_read_b128 v[104:107], v34 offset:3840
    ds_read_b128 v[108:111], v34 offset:4608
    ds_read_b128 v[112:115], v34 offset:5376
    s_waitcnt lgkmcnt(0)
    v_add_f32 v84, v84, v88
    v_add_f32 v84, v84, v92
    v_add_f32 v84, v84, v96
    v_add_f32 v84, v84, v100
    v_add_f32 v84, v84, v104
    v_add_f32 v84, v84, v108
    v_add_f32 v84, v84, v112
    v_add_f32 v85, v85, v89
    v_add_f32 v85, v85, v93
    v_add_f32 v85, v85, v97
    v_add_f32 v85, v85, v101
    v_add_f32 v85, v85, v105
    v_add_f32 v85, v85, v109
    v_add_f32 v85, v85, v113
    v_add_f32 v86, v86, v90
    v_add_f32 v86, v86, v94
    v_add_f32 v86, v86, v98
    v_add_f32 v86, v86, v102
    v_add_f32 v86, v86, v106
    v_add_f32 v86, v86, v110
    v_add_f32 v86, v86, v114
    v_add_f32 v87, v87, v91
    v_add_f32 v87, v87, v95
    v_add_f32 v87, v87, v99
    v_add_f32 v87, v87, v103
    v_add_f32 v87, v87, v107
    v_add_f32 v87, v87, v111
    v_add_f32 v87, v87, v115
    v_cvt_pk_bf16_f32 v88, v84, v85
    v_cvt_pk_bf16_f32 v89, v86, v87
    v_min_u32 v88, -2, v88
    v_min_u32 v89, -2, v89
    buffer_store_dwordx2 v[88:89], v17, s[28:31], s65 offen sc1
    s_mov_b64 exec, -1
Lpnext_108:
    s_add_u32 s67, s67, 1
    s_cmp_lt_u32 s67, 8
    s_cbranch_scc1 L_ptask
    s_waitcnt vmcnt(0)
    s_branch L_end
L_s1pass:
    s_lshl_b32 s43, s72, 5
    s_add_u32 s43, s43, s69
    s_mul_i32 s43, s43, 26624
    s_add_u32 s43, s43, 794624
    s_add_u32 s52, s26, s43
    s_addc_u32 s53, s27, 0
    s_mov_b32 s54, 26624
    s_mov_b32 s55, 0x00020000
    s_mov_b32 s46, 0
Lc_110:
    buffer_load_dwordx2 v[84:85], v41, s[52:55], 0 offen sc1
    s_waitcnt vmcnt(0)
    v_max_u32 v31, v84, v85
    v_cmp_eq_u32 vcc, -1, v31
    s_bcnt1_i32_b64 s43, vcc
    s_cmp_le_u32 s43, 2
    s_cbranch_scc1 Lc2_111
    s_sleep 8
    s_add_u32 s46, s46, 1
    s_cmp_lt_u32 s46, 524288
    s_cbranch_scc1 Lc_110
Lc2_111:
    s_mov_b32 s65, 0
    buffer_load_dwordx2 v[64:65], v40, s[52:55], s65 offen sc1
    buffer_load_dwordx3 v[84:86], v39, s[52:55], s65 offen sc1
    s_add_u32 s65, s65, 2048
    buffer_load_dwordx2 v[66:67], v40, s[52:55], s65 offen sc1
    buffer_load_dwordx3 v[88:90], v39, s[52:55], s65 offen sc1
    s_add_u32 s65, s65, 2048
    buffer_load_dwordx2 v[68:69], v40, s[52:55], s65 offen sc1
    buffer_load_dwordx3 v[92:94], v39, s[52:55], s65 offen sc1
    s_add_u32 s65, s65, 2048
    buffer_load_dwordx2 v[70:71], v40, s[52:55], s65 offen sc1
    buffer_load_dwordx3 v[96:98], v39, s[52:55], s65 offen sc1
    s_add_u32 s65, s65, 2048
    buffer_load_dwordx2 v[72:73], v40, s[52:55], s65 offen sc1
    buffer_load_dwordx3 v[100:102], v39, s[52:55], s65 offen sc1
    s_add_u32 s65, s65, 2048
    buffer_load_dwordx2 v[74:75], v40, s[52:55], s65 offen sc1
    buffer_load_dwordx3 v[104:106], v39, s[52:55], s65 offen sc1
    s_add_u32 s65, s65, 2048
    buffer_load_dwordx2 v[76:77], v40, s[52:55], s65 offen sc1
    buffer_load_dwordx3 v[108:110], v39, s[52:55], s65 offen sc1
    s_add_u32 s65, s65, 2048
    buffer_load_dwordx2 v[78:79], v40, s[52:55], s65 offen sc1
    buffer_load_dwordx3 v[112:114], v39, s[52:55], s65 offen sc1
    s_add_u32 s65, s65, 2048
    buffer_load_dwordx2 v[80:81], v40, s[52:55], s65 offen sc1
    buffer_load_dwordx3 v[116:118], v39, s[52:55], s65 offen sc1
    s_add_u32 s65, s65, 2048
    buffer_load_dwordx2 v[82:83], v40, s[52:55], s65 offen sc1
    buffer_load_dwordx3 v[120:122], v39, s[52:55], s65 offen sc1
    s_add_u32 s65, s65, 2048
    buffer_load_dwordx2 v[136:137], v40, s[52:55], s65 offen sc1
    buffer_load_dwordx3 v[124:126], v39, s[52:55], s65 offen sc1
    s_add_u32 s65, s65, 2048
    buffer_load_dwordx2 v[138:139], v40, s[52:55], s65 offen sc1
    buffer_load_dwordx3 v[128:130], v39, s[52:55], s65 offen sc1
    s_add_u32 s65, s65, 2048
    buffer_load_dwordx2 v[140:141], v40, s[52:55], s65 offen sc1
    buffer_load_dwordx3 v[132:134], v39, s[52:55], s65 offen sc1
    s_waitcnt vmcnt(0)
    v_mov_b32 v31, 0
    v_max3_u32 v31, v64, v65, v31
    v_max3_u32 v31, v84, v85, v31
    v_max_u32 v31, v86, v31
    v_max3_u32 v31, v66, v67, v31
    v_max3_u32 v31, v88, v89, v31
    v_max_u32 v31, v90, v31
    v_max3_u32 v31, v68, v69, v31
    v_max3_u32 v31, v92, v93, v31
    v_max_u32 v31, v94, v31
    v_max3_u32 v31, v70, v71, v31
    v_max3_u32 v31, v96, v97, v31
    v_max_u32 v31, v98, v31
    v_max3_u32 v31, v72, v73, v31
    v_max3_u32 v31, v100, v101, v31
    v_max_u32 v31, v102, v31
    v_max3_u32 v31, v74, v75, v31
    v_max3_u32 v31, v104, v105, v31
    v_max_u32 v31, v106, v31
    v_max3_u32 v31, v76, v77, v31
    v_max3_u32 v31, v108, v109, v31
    v_max_u32 v31, v110, v31
    v_max3_u32 v31, v78, v79, v31
    v_max3_u32 v31, v112, v113, v31
    v_max_u32 v31, v114, v31
    v_max3_u32 v31, v80, v81, v31
    v_max3_u32 v31, v116, v117, v31
    v_max_u32 v31, v118, v31
    v_max3_u32 v31, v82, v83, v31
    v_max3_u32 v31, v120, v121, v31
    v_max_u32 v31, v122, v31
    v_max3_u32 v31, v136, v137, v31
    v_max3_u32 v31, v124, v125, v31
    v_max_u32 v31, v126, v31
    v_max3_u32 v31, v138, v139, v31
    v_max3_u32 v31, v128, v129, v31
    v_max_u32 v31, v130, v31
    v_max3_u32 v31, v140, v141, v31
    v_max3_u32 v31, v132, v133, v31
    v_max_u32 v31, v134, v31
    v_cmp_eq_u32 vcc, -1, v31
    s_cbranch_vccz Lcok_112
    s_add_u32 s46, s46, 1
    s_cmp_lt_u32 s46, 524288
    s_cbranch_scc1 Lc2_111
Lcok_112:
    v_max_f32 v31, v64, v66
    v_max3_f32 v31, v68, v70, v31
    v_max3_f32 v31, v72, v74, v31
    v_max3_f32 v31, v76, v78, v31
    v_max3_f32 v31, v80, v82, v31
    v_max3_f32 v31, v136, v138, v31
    v_max_f32 v31, v140, v31
    v_mov_b32 v32, v31
    s_nop 1
    v_permlane32_swap_b32 v31, v32
    s_nop 1
    v_max_f32 v31, v31, v32
    v_sub_f32 v64, v64, v31
    v_sub_f32 v66, v66, v31
    v_sub_f32 v68, v68, v31
    v_sub_f32 v70, v70, v31
    v_sub_f32 v72, v72, v31
    v_sub_f32 v74, v74, v31
    v_sub_f32 v76, v76, v31
    v_sub_f32 v78, v78, v31
    v_sub_f32 v80, v80, v31
    v_sub_f32 v82, v82, v31
    v_sub_f32 v136, v136, v31
    v_sub_f32 v138, v138, v31
    v_sub_f32 v140, v140, v31
    v_exp_f32 v64, v64
    v_exp_f32 v66, v66
    v_exp_f32 v68, v68
    v_exp_f32 v70, v70
    v_exp_f32 v72, v72
    v_exp_f32 v74, v74
    v_exp_f32 v76, v76
    v_exp_f32 v78, v78
    v_exp_f32 v80, v80
    v_exp_f32 v82, v82
    v_exp_f32 v136, v136
    v_exp_f32 v138, v138
    v_exp_f32 v140, v140
    s_nop 0
    v_mul_f32 v32, v64, v65
    v_mul_f32 v44, v64, v84
    v_mul_f32 v45, v64, v85
    v_mul_f32 v46, v64, v86
    v_fmac_f32 v32, v66, v67
    v_fmac_f32 v44, v66, v88
    v_fmac_f32 v45, v66, v89
    v_fmac_f32 v46, v66, v90
    v_fmac_f32 v32, v68, v69
    v_fmac_f32 v44, v68, v92
    v_fmac_f32 v45, v68, v93
    v_fmac_f32 v46, v68, v94
    v_fmac_f32 v32, v70, v71
    v_fmac_f32 v44, v70, v96
    v_fmac_f32 v45, v70, v97
    v_fmac_f32 v46, v70, v98
    v_fmac_f32 v32, v72, v73
    v_fmac_f32 v44, v72, v100
    v_fmac_f32 v45, v72, v101
    v_fmac_f32 v46, v72, v102
    v_fmac_f32 v32, v74, v75
    v_fmac_f32 v44, v74, v104
    v_fmac_f32 v45, v74, v105
    v_fmac_f32 v46, v74, v106
    v_fmac_f32 v32, v76, v77
    v_fmac_f32 v44, v76, v108
    v_fmac_f32 v45, v76, v109
    v_fmac_f32 v46, v76, v110
    v_fmac_f32 v32, v78, v79
    v_fmac_f32 v44, v78, v112
    v_fmac_f32 v45, v78, v113
    v_fmac_f32 v46, v78, v114
    v_fmac_f32 v32, v80, v81
    v_fmac_f32 v44, v80, v116
    v_fmac_f32 v45, v80, v117
    v_fmac_f32 v46, v80, v118
    v_fmac_f32 v32, v82, v83
    v_fmac_f32 v44, v82, v120
    v_fmac_f32 v45, v82, v121
    v_fmac_f32 v46, v82, v122
    v_fmac_f32 v32, v136, v137
    v_fmac_f32 v44, v136, v124
    v_fmac_f32 v45, v136, v125
    v_fmac_f32 v46, v136, v126
    v_fmac_f32 v32, v138, v139
    v_fmac_f32 v44, v138, v128
    v_fmac_f32 v45, v138, v129
    v_fmac_f32 v46, v138, v130
    v_fmac_f32 v32, v140, v141
    v_fmac_f32 v44, v140, v132
    v_fmac_f32 v45, v140, v133
    v_fmac_f32 v46, v140, v134
    v_mov_b32 v33, v32
    s_nop 1
    v_permlane32_swap_b32 v32, v33
    s_nop 1
    v_add_f32 v32, v32, v33
    v_mov_b32 v33, v44
    s_nop 1
    v_permlane32_swap_b32 v44, v33
    s_nop 1
    v_add_f32 v44, v44, v33
    v_mov_b32 v33, v45
    s_nop 1
    v_permlane32_swap_b32 v45, v33
    s_nop 1
    v_add_f32 v45, v45, v33
    v_mov_b32 v33, v46
    s_nop 1
    v_permlane32_swap_b32 v46, v33
    s_nop 1
    v_add_f32 v46, v46, v33
    s_setpc_b64 s[84:85]
L_pollx:
    s_mov_b32 s46, 0
Lpx_113:
    buffer_load_dwordx4 v[54:57], v16, s[28:31], s65 offen sc1
    buffer_load_dwordx4 v[58:61], v16, s[28:31], s65 offen offset:1024 sc1
    buffer_load_dwordx2 v[62:63], v17, s[28:31], s65 offen offset:2048 sc1
    s_waitcnt vmcnt(0)
    v_max_u32 v31, v54, v55
    v_max3_u32 v31, v56, v57, v31
    v_max3_u32 v31, v58, v59, v31
    v_max3_u32 v31, v60, v61, v31
    v_max3_u32 v31, v62, v63, v31
    v_cmp_eq_u32 vcc, -1, v31
    s_cbranch_vccz Lpxok_114
    s_sleep 2
    s_add_u32 s46, s46, 1
    s_cmp_lt_u32 s46, 524288
    s_cbranch_scc1 Lpx_113
Lpxok_114:
    s_setpc_b64 s[84:85]
L_g16:
    s_mul_i32 s43, s42, 10240
    s_add_u32 s71, s71, s43
    s_mov_b32 s70, 15
    s_mov_b32 s46, 0
Lg_115:
    s_bitcmp0_b32 s70, 0
    s_cbranch_scc1 Lgi_117
    s_add_u32 s43, s71, 0
    buffer_load_dwordx4 v[84:87], v16, s[28:31], s43 offen sc1
    buffer_load_dwordx4 v[88:91], v16, s[28:31], s43 offen offset:1024 sc1
    buffer_load_dwordx2 v[92:93], v17, s[28:31], s43 offen offset:2048 sc1
Lgi_117:
    s_bitcmp0_b32 s70, 1
    s_cbranch_scc1 Lgi_118
    s_add_u32 s43, s71, 2560
    buffer_load_dwordx4 v[94:97], v16, s[28:31], s43 offen sc1
    buffer_load_dwordx4 v[98:101], v16, s[28:31], s43 offen offset:1024 sc1
    buffer_load_dwordx2 v[102:103], v17, s[28:31], s43 offen offset:2048 sc1
Lgi_118:
    s_bitcmp0_b32 s70, 2
    s_cbranch_scc1 Lgi_119
    s_add_u32 s43, s71, 5120
    buffer_load_dwordx4 v[104:107], v16, s[28:31], s43 offen sc1
    buffer_load_dwordx4 v[108:111], v16, s[28:31], s43 offen offset:1024 sc1
    buffer_load_dwordx2 v[112:113], v17, s[28:31], s43 offen offset:2048 sc1
Lgi_119:
    s_bitcmp0_b32 s70, 3
    s_cbranch_scc1 Lgi_120
    s_add_u32 s43, s71, 7680
    buffer_load_dwordx4 v[114:117], v16, s[28:31], s43 offen sc1
    buffer_load_dwordx4 v[118:121], v16, s[28:31], s43 offen offset:1024 sc1
    buffer_load_dwordx2 v[122:123], v17, s[28:31], s43 offen offset:2048 sc1
Lgi_120:
    s_waitcnt vmcnt(0)
    s_bitcmp0_b32 s70, 0
    s_cbranch_scc1 Lgc_121
    v_max_u32 v31, v84, v85
    v_max3_u32 v31, v86, v87, v31
    v_max3_u32 v31, v88, v89, v31
    v_max3_u32 v31, v90, v91, v31
    v_max3_u32 v31, v92, v93, v31
    v_cmp_eq_u32 vcc, -1, v31
    s_cbranch_vccnz Lgc_121
    s_bitset0_b32 s70, 0
Lgc_121:
    s_bitcmp0_b32 s70, 1
    s_cbranch_scc1 Lgc_122
    v_max_u32 v31, v94, v95
    v_max3_u32 v31, v96, v97, v31
    v_max3_u32 v31, v98, v99, v31
    v_max3_u32 v31, v100, v101, v31
    v_max3_u32 v31, v102, v103, v31
    v_cmp_eq_u32 vcc, -1, v31
    s_cbranch_vccnz Lgc_122
    s_bitset0_b32 s70, 1
Lgc_122:
    s_bitcmp0_b32 s70, 2
    s_cbranch_scc1 Lgc_123
    v_max_u32 v31, v104, v105
    v_max3_u32 v31, v106, v107, v31
    v_max3_u32 v31, v108, v109, v31
    v_max3_u32 v31, v110, v111, v31
    v_max3_u32 v31, v112, v113, v31
    v_cmp_eq_u32 vcc, -1, v31
    s_cbranch_vccnz Lgc_123
    s_bitset0_b32 s70, 2
Lgc_123:
    s_bitcmp0_b32 s70, 3
    s_cbranch_scc1 Lgc_124
    v_max_u32 v31, v114, v115
    v_max3_u32 v31, v116, v117, v31
    v_max3_u32 v31, v118, v119, v31
    v_max3_u32 v31, v120, v121, v31
    v_max3_u32 v31, v122, v123, v31
    v_cmp_eq_u32 vcc, -1, v31
    s_cbranch_vccnz Lgc_124
    s_bitset0_b32 s70, 3
Lgc_124:
    s_cmp_eq_u32 s70, 0
    s_cbranch_scc1 Lgok_116
    s_add_u32 s46, s46, 1
    s_cmp_lt_u32 s46, 524288
    s_cbranch_scc1 Lg_115
Lgok_116:
    v_add_f32 v84, v84, v94
    v_add_f32 v104, v104, v114
    v_add_f32 v85, v85, v95
    v_add_f32 v105, v105, v115
    v_add_f32 v86, v86, v96
    v_add_f32 v106, v106, v116
    v_add_f32 v87, v87, v97
    v_add_f32 v107, v107, v117
    v_add_f32 v88, v88, v98
    v_add_f32 v108, v108, v118
    v_add_f32 v89, v89, v99
    v_add_f32 v109, v109, v119
    v_add_f32 v90, v90, v100
    v_add_f32 v110, v110, v120
    v_add_f32 v91, v91, v101
    v_add_f32 v111, v111, v121
    v_add_f32 v92, v92, v102
    v_add_f32 v112, v112, v122
    v_add_f32 v93, v93, v103
    v_add_f32 v113, v113, v123
    v_add_f32 v84, v84, v104
    v_add_f32 v85, v85, v105
    v_add_f32 v86, v86, v106
    v_add_f32 v87, v87, v107
    v_add_f32 v88, v88, v108
    v_add_f32 v89, v89, v109
    v_add_f32 v90, v90, v110
    v_add_f32 v91, v91, v111
    v_add_f32 v92, v92, v112
    v_add_f32 v93, v93, v113
    ds_write_b128 v25, v[84:87]
    ds_write_b128 v25, v[88:91] offset:1024
    ds_write_b64 v26, v[92:93] offset:2048
    s_waitcnt lgkmcnt(0)
    s_barrier
    ds_read_b128 v[84:87], v27 offset:0
    ds_read_b128 v[88:91], v27 offset:1024
    ds_read_b64 v[92:93], v28 offset:2048
    ds_read_b128 v[94:97], v27 offset:2560
    ds_read_b128 v[98:101], v27 offset:3584
    ds_read_b64 v[102:103], v28 offset:4608
    ds_read_b128 v[104:107], v27 offset:5120
    ds_read_b128 v[108:111], v27 offset:6144
    ds_read_b64 v[112:113], v28 offset:7168
    ds_read_b128 v[114:117], v27 offset:7680
    ds_read_b128 v[118:121], v27 offset:8704
    ds_read_b64 v[122:123], v28 offset:9728
    s_waitcnt lgkmcnt(0)
    v_add_f32 v84, v84, v94
    v_add_f32 v104, v104, v114
    v_add_f32 v85, v85, v95
    v_add_f32 v105, v105, v115
    v_add_f32 v86, v86, v96
    v_add_f32 v106, v106, v116
    v_add_f32 v87, v87, v97
    v_add_f32 v107, v107, v117
    v_add_f32 v88, v88, v98
    v_add_f32 v108, v108, v118
    v_add_f32 v89, v89, v99
    v_add_f32 v109, v109, v119
    v_add_f32 v90, v90, v100
    v_add_f32 v110, v110, v120
    v_add_f32 v91, v91, v101
    v_add_f32 v111, v111, v121
    v_add_f32 v92, v92, v102
    v_add_f32 v112, v112, v122
    v_add_f32 v93, v93, v103
    v_add_f32 v113, v113, v123
    v_add_f32 v84, v84, v104
    v_cvt_pk_bf16_f32 v84, v84, v84
    v_lshlrev_b32 v84, 16, v84
    v_add_f32 v44, v84, v54
    v_cvt_pk_bf16_f32 v44, v44, v44
    v_lshlrev_b32 v44, 16, v44
    v_add_f32 v85, v85, v105
    v_cvt_pk_bf16_f32 v85, v85, v85
    v_lshlrev_b32 v85, 16, v85
    v_add_f32 v45, v85, v55
    v_cvt_pk_bf16_f32 v45, v45, v45
    v_lshlrev_b32 v45, 16, v45
    v_add_f32 v86, v86, v106
    v_cvt_pk_bf16_f32 v86, v86, v86
    v_lshlrev_b32 v86, 16, v86
    v_add_f32 v46, v86, v56
    v_cvt_pk_bf16_f32 v46, v46, v46
    v_lshlrev_b32 v46, 16, v46
    v_add_f32 v87, v87, v107
    v_cvt_pk_bf16_f32 v87, v87, v87
    v_lshlrev_b32 v87, 16, v87
    v_add_f32 v47, v87, v57
    v_cvt_pk_bf16_f32 v47, v47, v47
    v_lshlrev_b32 v47, 16, v47
    v_add_f32 v88, v88, v108
    v_cvt_pk_bf16_f32 v88, v88, v88
    v_lshlrev_b32 v88, 16, v88
    v_add_f32 v48, v88, v58
    v_cvt_pk_bf16_f32 v48, v48, v48
    v_lshlrev_b32 v48, 16, v48
    v_add_f32 v89, v89, v109
    v_cvt_pk_bf16_f32 v89, v89, v89
    v_lshlrev_b32 v89, 16, v89
    v_add_f32 v49, v89, v59
    v_cvt_pk_bf16_f32 v49, v49, v49
    v_lshlrev_b32 v49, 16, v49
    v_add_f32 v90, v90, v110
    v_cvt_pk_bf16_f32 v90, v90, v90
    v_lshlrev_b32 v90, 16, v90
    v_add_f32 v50, v90, v60
    v_cvt_pk_bf16_f32 v50, v50, v50
    v_lshlrev_b32 v50, 16, v50
    v_add_f32 v91, v91, v111
    v_cvt_pk_bf16_f32 v91, v91, v91
    v_lshlrev_b32 v91, 16, v91
    v_add_f32 v51, v91, v61
    v_cvt_pk_bf16_f32 v51, v51, v51
    v_lshlrev_b32 v51, 16, v51
    v_add_f32 v92, v92, v112
    v_cvt_pk_bf16_f32 v92, v92, v92
    v_lshlrev_b32 v92, 16, v92
    v_add_f32 v52, v92, v62
    v_cvt_pk_bf16_f32 v52, v52, v52
    v_lshlrev_b32 v52, 16, v52
    v_add_f32 v93, v93, v113
    v_cvt_pk_bf16_f32 v93, v93, v93
    v_lshlrev_b32 v93, 16, v93
    v_add_f32 v53, v93, v63
    v_cvt_pk_bf16_f32 v53, v53, v53
    v_lshlrev_b32 v53, 16, v53
    s_setpc_b64 s[84:85]
L_ln:
    v_add_f32 v31, v44, v45
    v_add_f32 v31, v31, v46
    v_add_f32 v31, v31, v47
    v_add_f32 v31, v31, v48
    v_add_f32 v31, v31, v49
    v_add_f32 v31, v31, v50
    v_add_f32 v31, v31, v51
    v_add_f32 v31, v31, v52
    v_add_f32 v31, v31, v53
    s_nop 1
    v_add_f32_dpp v31, v31, v31 row_ror:1 row_mask:0xf bank_mask:0xf
    s_nop 1
    v_add_f32_dpp v31, v31, v31 row_ror:2 row_mask:0xf bank_mask:0xf
    s_nop 1
    v_add_f32_dpp v31, v31, v31 row_ror:4 row_mask:0xf bank_mask:0xf
    s_nop 1
    v_add_f32_dpp v31, v31, v31 row_ror:8 row_mask:0xf bank_mask:0xf
    v_mov_b32 v32, v31
    s_nop 1
    v_permlane16_swap_b32 v31, v32
    s_nop 1
    v_add_f32 v31, v31, v32
    v_mov_b32 v32, v31
    s_nop 1
    v_permlane32_swap_b32 v31, v32
    s_nop 1
    v_add_f32 v31, v31, v32
    v_mul_f32 v31, 0x3acccccd, v31
    v_sub_f32 v33, v44, v31
    v_mul_f32 v32, v33, v33
    v_sub_f32 v33, v45, v31
    v_fmac_f32 v32, v33, v33
    v_sub_f32 v33, v46, v31
    v_fmac_f32 v32, v33, v33
    v_sub_f32 v33, v47, v31
    v_fmac_f32 v32, v33, v33
    v_sub_f32 v33, v48, v31
    v_fmac_f32 v32, v33, v33
    v_sub_f32 v33, v49, v31
    v_fmac_f32 v32, v33, v33
    v_sub_f32 v33, v50, v31
    v_fmac_f32 v32, v33, v33
    v_sub_f32 v33, v51, v31
    v_fmac_f32 v32, v33, v33
    v_sub_f32 v33, v52, v31
    v_fmac_f32 v32, v33, v33
    v_sub_f32 v33, v53, v31
    v_fmac_f32 v32, v33, v33
    s_nop 1
    v_add_f32_dpp v32, v32, v32 row_ror:1 row_mask:0xf bank_mask:0xf
    s_nop 1
    v_add_f32_dpp v32, v32, v32 row_ror:2 row_mask:0xf bank_mask:0xf
    s_nop 1
    v_add_f32_dpp v32, v32, v32 row_ror:4 row_mask:0xf bank_mask:0xf
    s_nop 1
    v_add_f32_dpp v32, v32, v32 row_ror:8 row_mask:0xf bank_mask:0xf
    v_mov_b32 v33, v32
    s_nop 1
    v_permlane16_swap_b32 v32, v33
    s_nop 1
    v_add_f32 v32, v32, v33
    v_mov_b32 v33, v32
    s_nop 1
    v_permlane32_swap_b32 v32, v33
    s_nop 1
    v_add_f32 v32, v32, v33
    v_mul_f32 v32, 0x3acccccd, v32
    v_cvt_pk_bf16_f32 v31, v31, v31
    v_lshlrev_b32 v31, 16, v31
    v_cvt_pk_bf16_f32 v32, v32, v32
    v_lshlrev_b32 v32, 16, v32
    v_add_f32 v32, 0x3727c5ac, v32
    v_cvt_pk_bf16_f32 v32, v32, v32
    v_lshlrev_b32 v32, 16, v32
    v_sqrt_f32 v32, v32
    s_nop 0
    v_cvt_pk_bf16_f32 v32, v32, v32
    v_lshlrev_b32 v32, 16, v32
    v_rcp_f32 v32, v32
    s_nop 0
    v_sub_f32 v84, v44, v31
    v_cvt_pk_bf16_f32 v84, v84, v84
    v_lshlrev_b32 v84, 16, v84
    v_mul_f32 v84, v84, v32
    v_cvt_pk_bf16_f32 v84, v84, v84
    v_sub_f32 v85, v45, v31
    v_cvt_pk_bf16_f32 v85, v85, v85
    v_lshlrev_b32 v85, 16, v85
    v_mul_f32 v85, v85, v32
    v_cvt_pk_bf16_f32 v85, v85, v85
    v_sub_f32 v86, v46, v31
    v_cvt_pk_bf16_f32 v86, v86, v86
    v_lshlrev_b32 v86, 16, v86
    v_mul_f32 v86, v86, v32
    v_cvt_pk_bf16_f32 v86, v86, v86
    v_sub_f32 v87, v47, v31
    v_cvt_pk_bf16_f32 v87, v87, v87
    v_lshlrev_b32 v87, 16, v87
    v_mul_f32 v87, v87, v32
    v_cvt_pk_bf16_f32 v87, v87, v87
    v_sub_f32 v88, v48, v31
    v_cvt_pk_bf16_f32 v88, v88, v88
    v_lshlrev_b32 v88, 16, v88
    v_mul_f32 v88, v88, v32
    v_cvt_pk_bf16_f32 v88, v88, v88
    v_sub_f32 v89, v49, v31
    v_cvt_pk_bf16_f32 v89, v89, v89
    v_lshlrev_b32 v89, 16, v89
    v_mul_f32 v89, v89, v32
    v_cvt_pk_bf16_f32 v89, v89, v89
    v_sub_f32 v90, v50, v31
    v_cvt_pk_bf16_f32 v90, v90, v90
    v_lshlrev_b32 v90, 16, v90
    v_mul_f32 v90, v90, v32
    v_cvt_pk_bf16_f32 v90, v90, v90
    v_sub_f32 v91, v51, v31
    v_cvt_pk_bf16_f32 v91, v91, v91
    v_lshlrev_b32 v91, 16, v91
    v_mul_f32 v91, v91, v32
    v_cvt_pk_bf16_f32 v91, v91, v91
    v_sub_f32 v92, v52, v31
    v_cvt_pk_bf16_f32 v92, v92, v92
    v_lshlrev_b32 v92, 16, v92
    v_mul_f32 v92, v92, v32
    v_cvt_pk_bf16_f32 v92, v92, v92
    v_sub_f32 v93, v53, v31
    v_cvt_pk_bf16_f32 v93, v93, v93
    v_lshlrev_b32 v93, 16, v93
    v_mul_f32 v93, v93, v32
    v_cvt_pk_bf16_f32 v93, v93, v93
    ds_write_b128 v21, v[84:87]
    ds_write_b128 v21, v[88:91] offset:1024
    ds_write_b64 v22, v[92:93] offset:2048
    s_waitcnt lgkmcnt(0)
    s_setpc_b64 s[84:85]
L_frole:
    s_sub_u32 s69, s64, 32
    s_cmp_lg_u32 s42, 0
    s_cbranch_scc1 Lfw_125
    s_lshl_b32 s44, s69, 3
    s_add_u32 s44, s44, 64
    s_mov_b32 s46, 0
    v_mov_b32 v85, 0
Lpoll_126:
    buffer_load_dword v84, v85, s[32:35], s44 offen sc1
    s_waitcnt vmcnt(0)
    v_readfirstlane_b32 s43, v84
    s_cmp_ge_u32 s43, 1
    s_cbranch_scc1 Lok_127
    s_sleep 32
    s_add_u32 s46, s46, 1
    s_cmp_lt_u32 s46, 524288
    s_cbranch_scc1 Lpoll_126
Lok_127:
Lfw_125:
    s_barrier
    v_mov_b32 v84, -1
    v_mov_b32 v85, -1
    v_mov_b32 v86, -1
    v_mov_b32 v87, -1
    v_lshlrev_b32 v34, 4, v2
    s_lshl_b32 s43, s64, 12
    s_add_u32 s43, s43, 49152
Lfill_128:
    buffer_store_dwordx4 v[84:87], v34, s[36:39], s43 offen sc1
    s_add_u32 s43, s43, 196608
    s_cmp_lt_u32 s43, 9314304
    s_cbranch_scc1 Lfill_128
    s_waitcnt vmcnt(0)
    s_barrier
    s_cmp_lg_u32 s42, 0
    s_cbranch_scc1 Larr_129
    v_mov_b32 v84, 1
    s_mov_b64 exec, 1
    buffer_atomic_add v84, v18, s[32:35], 0 offen
    s_mov_b64 exec, -1
Larr_129:
    s_mov_b32 s52, s16
    s_mov_b32 s53, s17
    s_mov_b32 s54, 1966080
    s_mov_b32 s55, 0x00020000
    s_mov_b32 s56, s18
    s_mov_b32 s57, s19
    s_mov_b32 s58, 1966080
    s_mov_b32 s59, 0x00020000
    v_mul_u32_u24 v33, 3072, v19
    v_add_u32 v33, v33, v20
    s_mul_i32 s65, s42, 491520
    s_mul_i32 s43, s69, 192
    s_add_u32 s65, s65, s43
    v_subrev_u32 v34, 64, v33
    buffer_load_dwordx4 a[0:3], v33, s[52:55], s65 offen nt
    buffer_load_dwordx4 a[8:11], v33, s[56:59], s65 offen offset:64 nt
    s_mov_b32 exec_lo, 0x0f0f0f0f
    s_mov_b32 exec_hi, 0x0f0f0f0f
    buffer_load_dwordx4 a[4:7], v33, s[52:55], s65 offen offset:128 nt
    s_mov_b32 exec_lo, 0xf0f0f0f0
    s_mov_b32 exec_hi, 0xf0f0f0f0
    buffer_load_dwordx4 a[4:7], v34, s[56:59], s65 offen nt
    s_mov_b64 exec, -1
    s_add_u32 s65, s65, 24576
    buffer_load_dwordx4 a[12:15], v33, s[52:55], s65 offen nt
    buffer_load_dwordx4 a[20:23], v33, s[56:59], s65 offen offset:64 nt
    s_mov_b32 exec_lo, 0x0f0f0f0f
    s_mov_b32 exec_hi, 0x0f0f0f0f
    buffer_load_dwordx4 a[16:19], v33, s[52:55], s65 offen offset:128 nt
    s_mov_b32 exec_lo, 0xf0f0f0f0
    s_mov_b32 exec_hi, 0xf0f0f0f0
    buffer_load_dwordx4 a[16:19], v34, s[56:59], s65 offen nt
    s_mov_b64 exec, -1
    s_add_u32 s65, s65, 24576
    buffer_load_dwordx4 a[24:27], v33, s[52:55], s65 offen nt
    buffer_load_dwordx4 a[32:35], v33, s[56:59], s65 offen offset:64 nt
    s_mov_b32 exec_lo, 0x0f0f0f0f
    s_mov_b32 exec_hi, 0x0f0f0f0f
    buffer_load_dwordx4 a[28:31], v33, s[52:55], s65 offen offset:128 nt
    s_mov_b32 exec_lo, 0xf0f0f0f0
    s_mov_b32 exec_hi, 0xf0f0f0f0
    buffer_load_dwordx4 a[28:31], v34, s[56:59], s65 offen nt
    s_mov_b64 exec, -1
    s_add_u32 s65, s65, 24576
    buffer_load_dwordx4 a[36:39], v33, s[52:55], s65 offen nt
    buffer_load_dwordx4 a[44:47], v33, s[56:59], s65 offen offset:64 nt
    s_mov_b32 exec_lo, 0x0f0f0f0f
    s_mov_b32 exec_hi, 0x0f0f0f0f
    buffer_load_dwordx4 a[40:43], v33, s[52:55], s65 offen offset:128 nt
    s_mov_b32 exec_lo, 0xf0f0f0f0
    s_mov_b32 exec_hi, 0xf0f0f0f0
    buffer_load_dwordx4 a[40:43], v34, s[56:59], s65 offen nt
    s_mov_b64 exec, -1
    s_add_u32 s65, s65, 24576
    buffer_load_dwordx4 a[48:51], v33, s[52:55], s65 offen nt
    buffer_load_dwordx4 a[56:59], v33, s[56:59], s65 offen offset:64 nt
    s_mov_b32 exec_lo, 0x0f0f0f0f
    s_mov_b32 exec_hi, 0x0f0f0f0f
    buffer_load_dwordx4 a[52:55], v33, s[52:55], s65 offen offset:128 nt
    s_mov_b32 exec_lo, 0xf0f0f0f0
    s_mov_b32 exec_hi, 0xf0f0f0f0
    buffer_load_dwordx4 a[52:55], v34, s[56:59], s65 offen nt
    s_mov_b64 exec, -1
    s_add_u32 s65, s65, 24576
    buffer_load_dwordx4 a[60:63], v33, s[52:55], s65 offen nt
    buffer_load_dwordx4 a[68:71], v33, s[56:59], s65 offen offset:64 nt
    s_mov_b32 exec_lo, 0x0f0f0f0f
    s_mov_b32 exec_hi, 0x0f0f0f0f
    buffer_load_dwordx4 a[64:67], v33, s[52:55], s65 offen offset:128 nt
    s_mov_b32 exec_lo, 0xf0f0f0f0
    s_mov_b32 exec_hi, 0xf0f0f0f0
    buffer_load_dwordx4 a[64:67], v34, s[56:59], s65 offen nt
    s_mov_b64 exec, -1
    s_add_u32 s65, s65, 24576
    buffer_load_dwordx4 a[72:75], v33, s[52:55], s65 offen nt
    buffer_load_dwordx4 a[80:83], v33, s[56:59], s65 offen offset:64 nt
    s_mov_b32 exec_lo, 0x0f0f0f0f
    s_mov_b32 exec_hi, 0x0f0f0f0f
    buffer_load_dwordx4 a[76:79], v33, s[52:55], s65 offen offset:128 nt
    s_mov_b32 exec_lo, 0xf0f0f0f0
    s_mov_b32 exec_hi, 0xf0f0f0f0
    buffer_load_dwordx4 a[76:79], v34, s[56:59], s65 offen nt
    s_mov_b64 exec, -1
    s_add_u32 s65, s65, 24576
    buffer_load_dwordx4 a[84:87], v33, s[52:55], s65 offen nt
    buffer_load_dwordx4 a[92:95], v33, s[56:59], s65 offen offset:64 nt
    s_mov_b32 exec_lo, 0x0f0f0f0f
    s_mov_b32 exec_hi, 0x0f0f0f0f
    buffer_load_dwordx4 a[88:91], v33, s[52:55], s65 offen offset:128 nt
    s_mov_b32 exec_lo, 0xf0f0f0f0
    s_mov_b32 exec_hi, 0xf0f0f0f0
    buffer_load_dwordx4 a[88:91], v34, s[56:59], s65 offen nt
    s_mov_b64 exec, -1
    s_add_u32 s65, s65, 24576
    buffer_load_dwordx4 a[96:99], v33, s[52:55], s65 offen nt
    buffer_load_dwordx4 a[104:107], v33, s[56:59], s65 offen offset:64 nt
    s_mov_b32 exec_lo, 0x0f0f0f0f
    s_mov_b32 exec_hi, 0x0f0f0f0f
    buffer_load_dwordx4 a[100:103], v33, s[52:55], s65 offen offset:128 nt
    s_mov_b32 exec_lo, 0xf0f0f0f0
    s_mov_b32 exec_hi, 0xf0f0f0f0
    buffer_load_dwordx4 a[100:103], v34, s[56:59], s65 offen nt
    s_mov_b64 exec, -1
    s_add_u32 s65, s65, 24576
    buffer_load_dwordx4 a[108:111], v33, s[52:55], s65 offen nt
    buffer_load_dwordx4 a[116:119], v33, s[56:59], s65 offen offset:64 nt
    s_mov_b32 exec_lo, 0x0f0f0f0f
    s_mov_b32 exec_hi, 0x0f0f0f0f
    buffer_load_dwordx4 a[112:115], v33, s[52:55], s65 offen offset:128 nt
    s_mov_b32 exec_lo, 0xf0f0f0f0
    s_mov_b32 exec_hi, 0xf0f0f0f0
    buffer_load_dwordx4 a[112:115], v34, s[56:59], s65 offen nt
    s_mov_b64 exec, -1
    s_add_u32 s65, s65, 24576
    buffer_load_dwordx4 a[120:123], v33, s[52:55], s65 offen nt
    buffer_load_dwordx4 a[128:131], v33, s[56:59], s65 offen offset:64 nt
    s_mov_b32 exec_lo, 0x0f0f0f0f
    s_mov_b32 exec_hi, 0x0f0f0f0f
    buffer_load_dwordx4 a[124:127], v33, s[52:55], s65 offen offset:128 nt
    s_mov_b32 exec_lo, 0xf0f0f0f0
    s_mov_b32 exec_hi, 0xf0f0f0f0
    buffer_load_dwordx4 a[124:127], v34, s[56:59], s65 offen nt
    s_mov_b64 exec, -1
    s_add_u32 s65, s65, 24576
    buffer_load_dwordx4 a[132:135], v33, s[52:55], s65 offen nt
    buffer_load_dwordx4 a[140:143], v33, s[56:59], s65 offen offset:64 nt
    s_mov_b32 exec_lo, 0x0f0f0f0f
    s_mov_b32 exec_hi, 0x0f0f0f0f
    buffer_load_dwordx4 a[136:139], v33, s[52:55], s65 offen offset:128 nt
    s_mov_b32 exec_lo, 0xf0f0f0f0
    s_mov_b32 exec_hi, 0xf0f0f0f0
    buffer_load_dwordx4 a[136:139], v34, s[56:59], s65 offen nt
    s_mov_b64 exec, -1
    s_add_u32 s65, s65, 24576
    buffer_load_dwordx4 a[144:147], v33, s[52:55], s65 offen nt
    buffer_load_dwordx4 a[152:155], v33, s[56:59], s65 offen offset:64 nt
    s_mov_b32 exec_lo, 0x0f0f0f0f
    s_mov_b32 exec_hi, 0x0f0f0f0f
    buffer_load_dwordx4 a[148:151], v33, s[52:55], s65 offen offset:128 nt
    s_mov_b32 exec_lo, 0xf0f0f0f0
    s_mov_b32 exec_hi, 0xf0f0f0f0
    buffer_load_dwordx4 a[148:151], v34, s[56:59], s65 offen nt
    s_mov_b64 exec, -1
    s_add_u32 s65, s65, 24576
    buffer_load_dwordx4 a[156:159], v33, s[52:55], s65 offen nt
    buffer_load_dwordx4 a[164:167], v33, s[56:59], s65 offen offset:64 nt
    s_mov_b32 exec_lo, 0x0f0f0f0f
    s_mov_b32 exec_hi, 0x0f0f0f0f
    buffer_load_dwordx4 a[160:163], v33, s[52:55], s65 offen offset:128 nt
    s_mov_b32 exec_lo, 0xf0f0f0f0
    s_mov_b32 exec_hi, 0xf0f0f0f0
    buffer_load_dwordx4 a[160:163], v34, s[56:59], s65 offen nt
    s_mov_b64 exec, -1
    s_add_u32 s65, s65, 24576
    buffer_load_dwordx4 a[168:171], v33, s[52:55], s65 offen nt
    buffer_load_dwordx4 a[176:179], v33, s[56:59], s65 offen offset:64 nt
    s_mov_b32 exec_lo, 0x0f0f0f0f
    s_mov_b32 exec_hi, 0x0f0f0f0f
    buffer_load_dwordx4 a[172:175], v33, s[52:55], s65 offen offset:128 nt
    s_mov_b32 exec_lo, 0xf0f0f0f0
    s_mov_b32 exec_hi, 0xf0f0f0f0
    buffer_load_dwordx4 a[172:175], v34, s[56:59], s65 offen nt
    s_mov_b64 exec, -1
    s_add_u32 s65, s65, 24576
    buffer_load_dwordx4 a[180:183], v33, s[52:55], s65 offen nt
    buffer_load_dwordx4 a[188:191], v33, s[56:59], s65 offen offset:64 nt
    s_mov_b32 exec_lo, 0x0f0f0f0f
    s_mov_b32 exec_hi, 0x0f0f0f0f
    buffer_load_dwordx4 a[184:187], v33, s[52:55], s65 offen offset:128 nt
    s_mov_b32 exec_lo, 0xf0f0f0f0
    s_mov_b32 exec_hi, 0xf0f0f0f0
    buffer_load_dwordx4 a[184:187], v34, s[56:59], s65 offen nt
    s_mov_b64 exec, -1
    s_add_u32 s65, s65, 24576
    buffer_load_dwordx4 a[192:195], v33, s[52:55], s65 offen nt
    buffer_load_dwordx4 a[200:203], v33, s[56:59], s65 offen offset:64 nt
    s_mov_b32 exec_lo, 0x0f0f0f0f
    s_mov_b32 exec_hi, 0x0f0f0f0f
    buffer_load_dwordx4 a[196:199], v33, s[52:55], s65 offen offset:128 nt
    s_mov_b32 exec_lo, 0xf0f0f0f0
    s_mov_b32 exec_hi, 0xf0f0f0f0
    buffer_load_dwordx4 a[196:199], v34, s[56:59], s65 offen nt
    s_mov_b64 exec, -1
    s_add_u32 s65, s65, 24576
    buffer_load_dwordx4 a[204:207], v33, s[52:55], s65 offen nt
    buffer_load_dwordx4 a[212:215], v33, s[56:59], s65 offen offset:64 nt
    s_mov_b32 exec_lo, 0x0f0f0f0f
    s_mov_b32 exec_hi, 0x0f0f0f0f
    buffer_load_dwordx4 a[208:211], v33, s[52:55], s65 offen offset:128 nt
    s_mov_b32 exec_lo, 0xf0f0f0f0
    s_mov_b32 exec_hi, 0xf0f0f0f0
    buffer_load_dwordx4 a[208:211], v34, s[56:59], s65 offen nt
    s_mov_b64 exec, -1
    s_add_u32 s65, s65, 24576
    buffer_load_dwordx4 a[216:219], v33, s[52:55], s65 offen nt
    buffer_load_dwordx4 a[224:227], v33, s[56:59], s65 offen offset:64 nt
    s_mov_b32 exec_lo, 0x0f0f0f0f
    s_mov_b32 exec_hi, 0x0f0f0f0f
    buffer_load_dwordx4 a[220:223], v33, s[52:55], s65 offen offset:128 nt
    s_mov_b32 exec_lo, 0xf0f0f0f0
    s_mov_b32 exec_hi, 0xf0f0f0f0
    buffer_load_dwordx4 a[220:223], v34, s[56:59], s65 offen nt
    s_mov_b64 exec, -1
    s_add_u32 s65, s65, 24576
    buffer_load_dwordx4 a[228:231], v33, s[52:55], s65 offen nt
    buffer_load_dwordx4 a[236:239], v33, s[56:59], s65 offen offset:64 nt
    s_mov_b32 exec_lo, 0x0f0f0f0f
    s_mov_b32 exec_hi, 0x0f0f0f0f
    buffer_load_dwordx4 a[232:235], v33, s[52:55], s65 offen offset:128 nt
    s_mov_b32 exec_lo, 0xf0f0f0f0
    s_mov_b32 exec_hi, 0xf0f0f0f0
    buffer_load_dwordx4 a[232:235], v34, s[56:59], s65 offen nt
    s_mov_b64 exec, -1
    s_add_u32 s65, s65, 24576
    s_waitcnt vmcnt(0)
    s_mov_b32 s52, s20
    s_mov_b32 s53, s21
    s_mov_b32 s54, 1966080
    s_mov_b32 s55, 0x00020000
    v_mul_u32_u24 v33, 1280, v19
    v_add_u32 v33, v33, v20
    s_mul_i32 s43, s69, 96
    s_mul_i32 s44, s42, 24
    s_add_u32 s43, s43, s44
    s_mul_i32 s65, s43, 1280
    buffer_load_dwordx4 a[240:243], v33, s[52:55], s65 offen offset:0 nt
    buffer_load_dwordx4 a[244:247], v33, s[52:55], s65 offen offset:128 nt
    buffer_load_dwordx4 a[248:251], v33, s[52:55], s65 offen offset:256 nt
    buffer_load_dwordx4 a[252:255], v33, s[52:55], s65 offen offset:384 nt
    buffer_load_dwordx4 v[152:155], v33, s[52:55], s65 offen offset:512 nt
    buffer_load_dwordx4 v[156:159], v33, s[52:55], s65 offen offset:640 nt
    buffer_load_dwordx4 v[160:163], v33, s[52:55], s65 offen offset:768 nt
    buffer_load_dwordx4 v[164:167], v33, s[52:55], s65 offen offset:896 nt
    buffer_load_dwordx4 v[168:171], v33, s[52:55], s65 offen offset:1024 nt
    buffer_load_dwordx4 v[172:175], v33, s[52:55], s65 offen offset:1152 nt
    s_add_u32 s65, s65, 10240
    buffer_load_dwordx4 v[176:179], v33, s[52:55], s65 offen offset:0 nt
    buffer_load_dwordx4 v[180:183], v33, s[52:55], s65 offen offset:128 nt
    buffer_load_dwordx4 v[184:187], v33, s[52:55], s65 offen offset:256 nt
    buffer_load_dwordx4 v[188:191], v33, s[52:55], s65 offen offset:384 nt
    buffer_load_dwordx4 v[192:195], v33, s[52:55], s65 offen offset:512 nt
    buffer_load_dwordx4 v[196:199], v33, s[52:55], s65 offen offset:640 nt
    buffer_load_dwordx4 v[200:203], v33, s[52:55], s65 offen offset:768 nt
    buffer_load_dwordx4 v[204:207], v33, s[52:55], s65 offen offset:896 nt
    buffer_load_dwordx4 v[208:211], v33, s[52:55], s65 offen offset:1024 nt
    buffer_load_dwordx4 v[212:215], v33, s[52:55], s65 offen offset:1152 nt
    s_add_u32 s65, s65, 10240
    buffer_load_dwordx4 v[216:219], v33, s[52:55], s65 offen offset:0 nt
    buffer_load_dwordx4 v[220:223], v33, s[52:55], s65 offen offset:128 nt
    buffer_load_dwordx4 v[224:227], v33, s[52:55], s65 offen offset:256 nt
    buffer_load_dwordx4 v[228:231], v33, s[52:55], s65 offen offset:384 nt
    buffer_load_dwordx4 v[232:235], v33, s[52:55], s65 offen offset:512 nt
    buffer_load_dwordx4 v[236:239], v33, s[52:55], s65 offen offset:640 nt
    buffer_load_dwordx4 v[240:243], v33, s[52:55], s65 offen offset:768 nt
    buffer_load_dwordx4 v[244:247], v33, s[52:55], s65 offen offset:896 nt
    buffer_load_dwordx4 v[248:251], v33, s[52:55], s65 offen offset:1024 nt
    buffer_load_dwordx4 v[252:255], v33, s[52:55], s65 offen offset:1152 nt
    s_add_u32 s65, s65, 10240
    s_mov_b32 s56, s22
    s_mov_b32 s57, s23
    s_mov_b32 s58, 5120
    s_mov_b32 s59, 0x00020000
    v_mul_u32_u24 v37, 768, v30
    v_add_u32 v37, v37, v29
    v_mul_u32_u24 v38, 2560, v30
    v_add_u32 v38, v38, v29
    v_add_u32 v38, 8192, v38
    s_mul_i32 s43, s42, 96
    v_lshlrev_b32 v39, 2, v19
    v_add_u32 v39, s43, v39
    v_lshlrev_b32 v40, 4, v2
    v_lshrrev_b32 v33, 2, v0
    v_mul_u32_u24 v33, 2560, v33
    v_and_b32 v34, 3, v0
    v_lshlrev_b32 v34, 4, v34
    v_add_u32 v41, v33, v34
    s_mul_i32 s43, s69, 160
    v_add_u32 v41, s43, v41
    s_waitcnt vmcnt(0)
    s_cmp_lg_u32 s42, 0
    s_cbranch_scc1 Liniw_130
    s_mov_b32 s46, 0
    v_mov_b32 v85, 0
Lpoll_131:
    buffer_load_dword v84, v85, s[32:35], 0 offen sc1
    s_waitcnt vmcnt(0)
    v_readfirstlane_b32 s43, v84
    s_cmp_ge_u32 s43, 48
    s_cbranch_scc1 Lok_132
    s_sleep 8
    s_add_u32 s46, s46, 1
    s_cmp_lt_u32 s46, 524288
    s_cbranch_scc1 Lpoll_131
Lok_132:
Liniw_130:
    s_barrier
    s_mov_b32 s67, 0
L_ftask:
    s_lshl_b32 s43, s67, 2
    s_lshr_b32 s66, 0x75634210, s43
    s_and_b32 s66, s66, 15
    s_and_b32 s68, s66, 3
    s_cmp_ge_u32 s66, 4
    s_cbranch_scc1 Lfl2_133
    s_mul_i32 s65, s68, 1280
    buffer_load_dwordx2 v[84:85], v17, s[60:63], s65 offen
    buffer_load_dwordx2 v[86:87], v17, s[60:63], s65 offen offset:512
    v_lshlrev_b32 v31, 2, v0
    buffer_load_dword v88, v31, s[60:63], s65 offen offset:1024
    s_waitcnt vmcnt(0)
    v_lshlrev_b32 v54, 16, v84
    v_and_b32 v55, 0xffff0000, v84
    v_lshlrev_b32 v56, 16, v85
    v_and_b32 v57, 0xffff0000, v85
    v_lshlrev_b32 v58, 16, v86
    v_and_b32 v59, 0xffff0000, v86
    v_lshlrev_b32 v60, 16, v87
    v_and_b32 v61, 0xffff0000, v87
    v_lshlrev_b32 v62, 16, v88
    v_and_b32 v63, 0xffff0000, v88
    s_branch Lfx_134
Lfl2_133:
    s_mul_i32 s65, s68, 5120
    s_add_u32 s65, s65, 100864
    s_swappc_b64 s[84:85], s[82:83]
Lfx_134:
    s_mul_i32 s71, s66, 40960
    s_add_u32 s71, s71, 139264
    s_swappc_b64 s[84:85], s[78:79]
    s_add_u32 s43, s69, s42
    s_cmp_lg_u32 s43, 0
    s_cbranch_scc1 Lnox1_135
    s_mul_i32 s65, s66, 5120
    s_add_u32 s65, s65, 98304
    buffer_store_dwordx4 v[44:47], v16, s[28:31], s65 offen sc1
    buffer_store_dwordx4 v[48:51], v16, s[28:31], s65 offen offset:1024 sc1
    buffer_store_dwordx2 v[52:53], v17, s[28:31], s65 offen offset:2048 sc1
Lnox1_135:
    s_cmp_lg_u32 s42, 3
    s_cbranch_scc1 Lnoxs_136
    ds_write_b128 v16, v[44:47] offset:32768
    ds_write_b128 v16, v[48:51] offset:33792
    ds_write_b64 v17, v[52:53] offset:34816
Lnoxs_136:
    s_swappc_b64 s[84:85], s[76:77]
    ds_read_b32 v64, v23 offset:0
    ds_read_b32 v65, v23 offset:32
    ds_read_b32 v66, v23 offset:64
    ds_read_b32 v67, v23 offset:96
    ds_read_b32 v68, v23 offset:128
    ds_read_b32 v69, v23 offset:160
    ds_read_b32 v70, v23 offset:192
    ds_read_b32 v71, v23 offset:224
    ds_read_b32 v72, v23 offset:256
    ds_read_b32 v73, v23 offset:288
    ds_read_b32 v74, v23 offset:320
    ds_read_b32 v75, v23 offset:352
    s_waitcnt lgkmcnt(0)
    ds_read_b32 v76, v23 offset:384
    ds_read_b32 v77, v23 offset:416
    ds_read_b32 v78, v23 offset:448
    ds_read_b32 v79, v23 offset:480
    ds_read_b32 v80, v23 offset:512
    ds_read_b32 v81, v23 offset:544
    ds_read_b32 v82, v23 offset:576
    ds_read_b32 v83, v23 offset:608
    s_waitcnt lgkmcnt(0)
    v_and_b32 v8, v64, v4
    v_and_b32 v9, v64, v5
    v_and_b32 v10, v64, v6
    v_and_b32 v11, v64, v7
    s_nop 1
    v_mfma_f32_16x16x32_bf16 v[84:87], v[8:11], a[0:3], 0
    v_mfma_f32_16x16x32_bf16 v[88:91], v[8:11], a[4:7], 0
    v_mfma_f32_16x16x32_bf16 v[92:95], v[8:11], a[8:11], 0
    v_and_b32 v12, v65, v4
    v_and_b32 v13, v65, v5
    v_and_b32 v14, v65, v6
    v_and_b32 v15, v65, v7
    s_nop 1
    v_mfma_f32_16x16x32_bf16 v[84:87], v[12:15], a[12:15], v[84:87]
    v_mfma_f32_16x16x32_bf16 v[88:91], v[12:15], a[16:19], v[88:91]
    v_mfma_f32_16x16x32_bf16 v[92:95], v[12:15], a[20:23], v[92:95]
    v_and_b32 v8, v66, v4
    v_and_b32 v9, v66, v5
    v_and_b32 v10, v66, v6
    v_and_b32 v11, v66, v7
    s_nop 1
    v_mfma_f32_16x16x32_bf16 v[84:87], v[8:11], a[24:27], v[84:87]
    v_mfma_f32_16x16x32_bf16 v[88:91], v[8:11], a[28:31], v[88:91]
    v_mfma_f32_16x16x32_bf16 v[92:95], v[8:11], a[32:35], v[92:95]
    v_and_b32 v12, v67, v4
    v_and_b32 v13, v67, v5
    v_and_b32 v14, v67, v6
    v_and_b32 v15, v67, v7
    s_nop 1
    v_mfma_f32_16x16x32_bf16 v[84:87], v[12:15], a[36:39], v[84:87]
    v_mfma_f32_16x16x32_bf16 v[88:91], v[12:15], a[40:43], v[88:91]
    v_mfma_f32_16x16x32_bf16 v[92:95], v[12:15], a[44:47], v[92:95]
    v_and_b32 v8, v68, v4
    v_and_b32 v9, v68, v5
    v_and_b32 v10, v68, v6
    v_and_b32 v11, v68, v7
    s_nop 1
    v_mfma_f32_16x16x32_bf16 v[84:87], v[8:11], a[48:51], v[84:87]
    v_mfma_f32_16x16x32_bf16 v[88:91], v[8:11], a[52:55], v[88:91]
    v_mfma_f32_16x16x32_bf16 v[92:95], v[8:11], a[56:59], v[92:95]
    v_and_b32 v12, v69, v4
    v_and_b32 v13, v69, v5
    v_and_b32 v14, v69, v6
    v_and_b32 v15, v69, v7
    s_nop 1
    v_mfma_f32_16x16x32_bf16 v[84:87], v[12:15], a[60:63], v[84:87]
    v_mfma_f32_16x16x32_bf16 v[88:91], v[12:15], a[64:67], v[88:91]
    v_mfma_f32_16x16x32_bf16 v[92:95], v[12:15], a[68:71], v[92:95]
    v_and_b32 v8, v70, v4
    v_and_b32 v9, v70, v5
    v_and_b32 v10, v70, v6
    v_and_b32 v11, v70, v7
    s_nop 1
    v_mfma_f32_16x16x32_bf16 v[84:87], v[8:11], a[72:75], v[84:87]
    v_mfma_f32_16x16x32_bf16 v[88:91], v[8:11], a[76:79], v[88:91]
    v_mfma_f32_16x16x32_bf16 v[92:95], v[8:11], a[80:83], v[92:95]
    v_and_b32 v12, v71, v4
    v_and_b32 v13, v71, v5
    v_and_b32 v14, v71, v6
    v_and_b32 v15, v71, v7
    s_nop 1
    v_mfma_f32_16x16x32_bf16 v[84:87], v[12:15], a[84:87], v[84:87]
    v_mfma_f32_16x16x32_bf16 v[88:91], v[12:15], a[88:91], v[88:91]
    v_mfma_f32_16x16x32_bf16 v[92:95], v[12:15], a[92:95], v[92:95]
    v_and_b32 v8, v72, v4
    v_and_b32 v9, v72, v5
    v_and_b32 v10, v72, v6
    v_and_b32 v11, v72, v7
    s_nop 1
    v_mfma_f32_16x16x32_bf16 v[84:87], v[8:11], a[96:99], v[84:87]
    v_mfma_f32_16x16x32_bf16 v[88:91], v[8:11], a[100:103], v[88:91]
    v_mfma_f32_16x16x32_bf16 v[92:95], v[8:11], a[104:107], v[92:95]
    v_and_b32 v12, v73, v4
    v_and_b32 v13, v73, v5
    v_and_b32 v14, v73, v6
    v_and_b32 v15, v73, v7
    s_nop 1
    v_mfma_f32_16x16x32_bf16 v[84:87], v[12:15], a[108:111], v[84:87]
    v_mfma_f32_16x16x32_bf16 v[88:91], v[12:15], a[112:115], v[88:91]
    v_mfma_f32_16x16x32_bf16 v[92:95], v[12:15], a[116:119], v[92:95]
    v_and_b32 v8, v74, v4
    v_and_b32 v9, v74, v5
    v_and_b32 v10, v74, v6
    v_and_b32 v11, v74, v7
    s_nop 1
    v_mfma_f32_16x16x32_bf16 v[84:87], v[8:11], a[120:123], v[84:87]
    v_mfma_f32_16x16x32_bf16 v[88:91], v[8:11], a[124:127], v[88:91]
    v_mfma_f32_16x16x32_bf16 v[92:95], v[8:11], a[128:131], v[92:95]
    v_and_b32 v12, v75, v4
    v_and_b32 v13, v75, v5
    v_and_b32 v14, v75, v6
    v_and_b32 v15, v75, v7
    s_nop 1
    v_mfma_f32_16x16x32_bf16 v[84:87], v[12:15], a[132:135], v[84:87]
    v_mfma_f32_16x16x32_bf16 v[88:91], v[12:15], a[136:139], v[88:91]
    v_mfma_f32_16x16x32_bf16 v[92:95], v[12:15], a[140:143], v[92:95]
    v_and_b32 v8, v76, v4
    v_and_b32 v9, v76, v5
    v_and_b32 v10, v76, v6
    v_and_b32 v11, v76, v7
    s_nop 1
    v_mfma_f32_16x16x32_bf16 v[84:87], v[8:11], a[144:147], v[84:87]
    v_mfma_f32_16x16x32_bf16 v[88:91], v[8:11], a[148:151], v[88:91]
    v_mfma_f32_16x16x32_bf16 v[92:95], v[8:11], a[152:155], v[92:95]
    v_and_b32 v12, v77, v4
    v_and_b32 v13, v77, v5
    v_and_b32 v14, v77, v6
    v_and_b32 v15, v77, v7
    s_nop 1
    v_mfma_f32_16x16x32_bf16 v[84:87], v[12:15], a[156:159], v[84:87]
    v_mfma_f32_16x16x32_bf16 v[88:91], v[12:15], a[160:163], v[88:91]
    v_mfma_f32_16x16x32_bf16 v[92:95], v[12:15], a[164:167], v[92:95]
    v_and_b32 v8, v78, v4
    v_and_b32 v9, v78, v5
    v_and_b32 v10, v78, v6
    v_and_b32 v11, v78, v7
    s_nop 1
    v_mfma_f32_16x16x32_bf16 v[84:87], v[8:11], a[168:171], v[84:87]
    v_mfma_f32_16x16x32_bf16 v[88:91], v[8:11], a[172:175], v[88:91]
    v_mfma_f32_16x16x32_bf16 v[92:95], v[8:11], a[176:179], v[92:95]
    v_and_b32 v12, v79, v4
    v_and_b32 v13, v79, v5
    v_and_b32 v14, v79, v6
    v_and_b32 v15, v79, v7
    s_nop 1
    v_mfma_f32_16x16x32_bf16 v[84:87], v[12:15], a[180:183], v[84:87]
    v_mfma_f32_16x16x32_bf16 v[88:91], v[12:15], a[184:187], v[88:91]
    v_mfma_f32_16x16x32_bf16 v[92:95], v[12:15], a[188:191], v[92:95]
    v_and_b32 v8, v80, v4
    v_and_b32 v9, v80, v5
    v_and_b32 v10, v80, v6
    v_and_b32 v11, v80, v7
    s_nop 1
    v_mfma_f32_16x16x32_bf16 v[84:87], v[8:11], a[192:195], v[84:87]
    v_mfma_f32_16x16x32_bf16 v[88:91], v[8:11], a[196:199], v[88:91]
    v_mfma_f32_16x16x32_bf16 v[92:95], v[8:11], a[200:203], v[92:95]
    v_and_b32 v12, v81, v4
    v_and_b32 v13, v81, v5
    v_and_b32 v14, v81, v6
    v_and_b32 v15, v81, v7
    s_nop 1
    v_mfma_f32_16x16x32_bf16 v[84:87], v[12:15], a[204:207], v[84:87]
    v_mfma_f32_16x16x32_bf16 v[88:91], v[12:15], a[208:211], v[88:91]
    v_mfma_f32_16x16x32_bf16 v[92:95], v[12:15], a[212:215], v[92:95]
    v_and_b32 v8, v82, v4
    v_and_b32 v9, v82, v5
    v_and_b32 v10, v82, v6
    v_and_b32 v11, v82, v7
    s_nop 1
    v_mfma_f32_16x16x32_bf16 v[84:87], v[8:11], a[216:219], v[84:87]
    v_mfma_f32_16x16x32_bf16 v[88:91], v[8:11], a[220:223], v[88:91]
    v_mfma_f32_16x16x32_bf16 v[92:95], v[8:11], a[224:227], v[92:95]
    v_and_b32 v12, v83, v4
    v_and_b32 v13, v83, v5
    v_and_b32 v14, v83, v6
    v_and_b32 v15, v83, v7
    s_nop 1
    v_mfma_f32_16x16x32_bf16 v[84:87], v[12:15], a[228:231], v[84:87]
    v_mfma_f32_16x16x32_bf16 v[88:91], v[12:15], a[232:235], v[88:91]
    v_mfma_f32_16x16x32_bf16 v[92:95], v[12:15], a[236:239], v[92:95]
    s_nop 7
    s_mov_b64 exec, s[74:75]
    ds_write_b128 v37, v[84:87] offset:0
    ds_write_b128 v37, v[88:91] offset:256
    ds_write_b128 v37, v[92:95] offset:512
    s_mov_b64 exec, -1
    s_waitcnt lgkmcnt(0)
    s_barrier
    v_add_u32 v34, 0, v39
    ds_read2_b32 v[84:85], v34 offset0:0 offset1:96
    ds_read2_b32 v[86:87], v34 offset0:8 offset1:104
    ds_read2_b32 v[88:89], v34 offset0:16 offset1:112
    v_add_u32 v34, 768, v39
    ds_read2_b32 v[90:91], v34 offset0:0 offset1:96
    ds_read2_b32 v[92:93], v34 offset0:8 offset1:104
    ds_read2_b32 v[94:95], v34 offset0:16 offset1:112
    v_add_u32 v34, 1536, v39
    ds_read2_b32 v[96:97], v34 offset0:0 offset1:96
    ds_read2_b32 v[98:99], v34 offset0:8 offset1:104
    ds_read2_b32 v[100:101], v34 offset0:16 offset1:112
    v_add_u32 v34, 2304, v39
    ds_read2_b32 v[102:103], v34 offset0:0 offset1:96
    ds_read2_b32 v[104:105], v34 offset0:8 offset1:104
    ds_read2_b32 v[106:107], v34 offset0:16 offset1:112
    s_waitcnt lgkmcnt(0)
    v_add_u32 v34, 3072, v39
    ds_read2_b32 v[108:109], v34 offset0:0 offset1:96
    ds_read2_b32 v[110:111], v34 offset0:8 offset1:104
    ds_read2_b32 v[112:113], v34 offset0:16 offset1:112
    v_add_u32 v34, 3840, v39
    ds_read2_b32 v[114:115], v34 offset0:0 offset1:96
    ds_read2_b32 v[116:117], v34 offset0:8 offset1:104
    ds_read2_b32 v[118:119], v34 offset0:16 offset1:112
    v_add_u32 v34, 4608, v39
    ds_read2_b32 v[120:121], v34 offset0:0 offset1:96
    ds_read2_b32 v[122:123], v34 offset0:8 offset1:104
    ds_read2_b32 v[124:125], v34 offset0:16 offset1:112
    v_add_u32 v34, 5376, v39
    ds_read2_b32 v[126:127], v34 offset0:0 offset1:96
    ds_read2_b32 v[128:129], v34 offset0:8 offset1:104
    ds_read2_b32 v[130:131], v34 offset0:16 offset1:112
    s_waitcnt lgkmcnt(0)
    v_add_f32 v84, v84, v90
    v_add_f32 v84, v84, v96
    v_add_f32 v84, v84, v102
    v_add_f32 v84, v84, v108
    v_add_f32 v84, v84, v114
    v_add_f32 v84, v84, v120
    v_add_f32 v84, v84, v126
    v_cvt_pk_bf16_f32 v84, v84, v84
    v_lshlrev_b32 v84, 16, v84
    v_add_f32 v85, v85, v91
    v_add_f32 v85, v85, v97
    v_add_f32 v85, v85, v103
    v_add_f32 v85, v85, v109
    v_add_f32 v85, v85, v115
    v_add_f32 v85, v85, v121
    v_add_f32 v85, v85, v127
    v_cvt_pk_bf16_f32 v85, v85, v85
    v_lshlrev_b32 v85, 16, v85
    v_add_f32 v86, v86, v92
    v_add_f32 v86, v86, v98
    v_add_f32 v86, v86, v104
    v_add_f32 v86, v86, v110
    v_add_f32 v86, v86, v116
    v_add_f32 v86, v86, v122
    v_add_f32 v86, v86, v128
    v_cvt_pk_bf16_f32 v86, v86, v86
    v_lshlrev_b32 v86, 16, v86
    v_add_f32 v87, v87, v93
    v_add_f32 v87, v87, v99
    v_add_f32 v87, v87, v105
    v_add_f32 v87, v87, v111
    v_add_f32 v87, v87, v117
    v_add_f32 v87, v87, v123
    v_add_f32 v87, v87, v129
    v_cvt_pk_bf16_f32 v87, v87, v87
    v_lshlrev_b32 v87, 16, v87
    v_add_f32 v88, v88, v94
    v_add_f32 v88, v88, v100
    v_add_f32 v88, v88, v106
    v_add_f32 v88, v88, v112
    v_add_f32 v88, v88, v118
    v_add_f32 v88, v88, v124
    v_add_f32 v88, v88, v130
    v_cvt_pk_bf16_f32 v88, v88, v88
    v_lshlrev_b32 v88, 16, v88
    v_add_f32 v89, v89, v95
    v_add_f32 v89, v89, v101
    v_add_f32 v89, v89, v107
    v_add_f32 v89, v89, v113
    v_add_f32 v89, v89, v119
    v_add_f32 v89, v89, v125
    v_add_f32 v89, v89, v131
    v_cvt_pk_bf16_f32 v89, v89, v89
    v_lshlrev_b32 v89, 16, v89
    v_mov_b32 v34, 0x3d372713
    v_mul_f32 v64, v84, v84
    v_fma_f32 v64, v64, v34, 1.0
    v_mul_f32 v64, v64, v84
    v_mul_f32 v64, 0x40135761, v64
    v_exp_f32 v64, v64
    s_nop 0
    v_add_f32 v64, 1.0, v64
    v_rcp_f32 v64, v64
    s_nop 0
    v_sub_f32 v64, 1.0, v64
    v_mul_f32 v64, v64, v84
    v_cvt_pk_bf16_f32 v64, v64, v64
    v_lshlrev_b32 v64, 16, v64
    v_mul_f32 v64, v64, v85
    v_cvt_pk_bf16_f32 v64, v64, v64
    v_mul_f32 v65, v86, v86
    v_fma_f32 v65, v65, v34, 1.0
    v_mul_f32 v65, v65, v86
    v_mul_f32 v65, 0x40135761, v65
    v_exp_f32 v65, v65
    s_nop 0
    v_add_f32 v65, 1.0, v65
    v_rcp_f32 v65, v65
    s_nop 0
    v_sub_f32 v65, 1.0, v65
    v_mul_f32 v65, v65, v86
    v_cvt_pk_bf16_f32 v65, v65, v65
    v_lshlrev_b32 v65, 16, v65
    v_mul_f32 v65, v65, v87
    v_cvt_pk_bf16_f32 v65, v65, v65
    v_mul_f32 v66, v88, v88
    v_fma_f32 v66, v66, v34, 1.0
    v_mul_f32 v66, v66, v88
    v_mul_f32 v66, 0x40135761, v66
    v_exp_f32 v66, v66
    s_nop 0
    v_add_f32 v66, 1.0, v66
    v_rcp_f32 v66, v66
    s_nop 0
    v_sub_f32 v66, 1.0, v66
    v_mul_f32 v66, v66, v88
    v_cvt_pk_bf16_f32 v66, v66, v66
    v_lshlrev_b32 v66, 16, v66
    v_mul_f32 v66, v66, v89
    v_cvt_pk_bf16_f32 v66, v66, v66
    v_and_b32 v8, v64, v4
    v_and_b32 v9, v64, v5
    v_and_b32 v10, v64, v6
    v_and_b32 v11, v64, v7
    s_nop 1
    v_mfma_f32_16x16x32_bf16 v[84:87], v[8:11], a[240:243], 0
    v_mfma_f32_16x16x32_bf16 v[88:91], v[8:11], a[244:247], 0
    v_mfma_f32_16x16x32_bf16 v[92:95], v[8:11], a[248:251], 0
    v_mfma_f32_16x16x32_bf16 v[96:99], v[8:11], a[252:255], 0
    v_mfma_f32_16x16x32_bf16 v[100:103], v[8:11], v[152:155], 0
    v_mfma_f32_16x16x32_bf16 v[104:107], v[8:11], v[156:159], 0
    v_mfma_f32_16x16x32_bf16 v[108:111], v[8:11], v[160:163], 0
    v_mfma_f32_16x16x32_bf16 v[112:115], v[8:11], v[164:167], 0
    v_mfma_f32_16x16x32_bf16 v[116:119], v[8:11], v[168:171], 0
    v_mfma_f32_16x16x32_bf16 v[120:123], v[8:11], v[172:175], 0
    v_and_b32 v12, v65, v4
    v_and_b32 v13, v65, v5
    v_and_b32 v14, v65, v6
    v_and_b32 v15, v65, v7
    s_nop 1
    v_mfma_f32_16x16x32_bf16 v[84:87], v[12:15], v[176:179], v[84:87]
    v_mfma_f32_16x16x32_bf16 v[88:91], v[12:15], v[180:183], v[88:91]
    v_mfma_f32_16x16x32_bf16 v[92:95], v[12:15], v[184:187], v[92:95]
    v_mfma_f32_16x16x32_bf16 v[96:99], v[12:15], v[188:191], v[96:99]
    v_mfma_f32_16x16x32_bf16 v[100:103], v[12:15], v[192:195], v[100:103]
    v_mfma_f32_16x16x32_bf16 v[104:107], v[12:15], v[196:199], v[104:107]
    v_mfma_f32_16x16x32_bf16 v[108:111], v[12:15], v[200:203], v[108:111]
    v_mfma_f32_16x16x32_bf16 v[112:115], v[12:15], v[204:207], v[112:115]
    v_mfma_f32_16x16x32_bf16 v[116:119], v[12:15], v[208:211], v[116:119]
    v_mfma_f32_16x16x32_bf16 v[120:123], v[12:15], v[212:215], v[120:123]
    v_and_b32 v8, v66, v4
    v_and_b32 v9, v66, v5
    v_and_b32 v10, v66, v6
    v_and_b32 v11, v66, v7
    s_nop 1
    v_mfma_f32_16x16x32_bf16 v[84:87], v[8:11], v[216:219], v[84:87]
    v_mfma_f32_16x16x32_bf16 v[88:91], v[8:11], v[220:223], v[88:91]
    v_mfma_f32_16x16x32_bf16 v[92:95], v[8:11], v[224:227], v[92:95]
    v_mfma_f32_16x16x32_bf16 v[96:99], v[8:11], v[228:231], v[96:99]
    v_mfma_f32_16x16x32_bf16 v[100:103], v[8:11], v[232:235], v[100:103]
    v_mfma_f32_16x16x32_bf16 v[104:107], v[8:11], v[236:239], v[104:107]
    v_mfma_f32_16x16x32_bf16 v[108:111], v[8:11], v[240:243], v[108:111]
    v_mfma_f32_16x16x32_bf16 v[112:115], v[8:11], v[244:247], v[112:115]
    v_mfma_f32_16x16x32_bf16 v[116:119], v[8:11], v[248:251], v[116:119]
    v_mfma_f32_16x16x32_bf16 v[120:123], v[8:11], v[252:255], v[120:123]
    s_nop 7
    s_mov_b64 exec, s[74:75]
    ds_write_b128 v38, v[84:87] offset:0
    ds_write_b128 v38, v[88:91] offset:256
    ds_write_b128 v38, v[92:95] offset:512
    ds_write_b128 v38, v[96:99] offset:768
    ds_write_b128 v38, v[100:103] offset:1024
    ds_write_b128 v38, v[104:107] offset:1280
    ds_write_b128 v38, v[108:111] offset:1536
    ds_write_b128 v38, v[112:115] offset:1792
    ds_write_b128 v38, v[116:119] offset:2048
    ds_write_b128 v38, v[120:123] offset:2304
    s_mov_b64 exec, -1
    s_mul_i32 s71, s66, 40960
    s_add_u32 s71, s71, 466944
    s_waitcnt lgkmcnt(0)
    s_barrier
    s_cmp_eq_u32 s42, 3
    s_cbranch_scc1 Lfw3_137
    s_cmp_eq_u32 s42, 2
    s_cselect_b32 exec_hi, 0, -1
    ds_read_b128 v[84:87], v40 offset:8192
    ds_read_b128 v[88:91], v40 offset:10752
    ds_read_b128 v[92:95], v40 offset:13312
    ds_read_b128 v[96:99], v40 offset:15872
    ds_read_b128 v[100:103], v40 offset:18432
    ds_read_b128 v[104:107], v40 offset:20992
    ds_read_b128 v[108:111], v40 offset:23552
    ds_read_b128 v[112:115], v40 offset:26112
    s_waitcnt lgkmcnt(0)
    v_add_f32 v84, v84, v88
    v_add_f32 v84, v84, v92
    v_add_f32 v84, v84, v96
    v_add_f32 v84, v84, v100
    v_add_f32 v84, v84, v104
    v_add_f32 v84, v84, v108
    v_add_f32 v84, v84, v112
    v_min_u32 v84, -2, v84
    v_add_f32 v85, v85, v89
    v_add_f32 v85, v85, v93
    v_add_f32 v85, v85, v97
    v_add_f32 v85, v85, v101
    v_add_f32 v85, v85, v105
    v_add_f32 v85, v85, v109
    v_add_f32 v85, v85, v113
    v_min_u32 v85, -2, v85
    v_add_f32 v86, v86, v90
    v_add_f32 v86, v86, v94
    v_add_f32 v86, v86, v98
    v_add_f32 v86, v86, v102
    v_add_f32 v86, v86, v106
    v_add_f32 v86, v86, v110
    v_add_f32 v86, v86, v114
    v_min_u32 v86, -2, v86
    v_add_f32 v87, v87, v91
    v_add_f32 v87, v87, v95
    v_add_f32 v87, v87, v99
    v_add_f32 v87, v87, v103
    v_add_f32 v87, v87, v107
    v_add_f32 v87, v87, v111
    v_add_f32 v87, v87, v115
    v_min_u32 v87, -2, v87
    s_mul_i32 s43, s69, 2560
    s_add_u32 s43, s43, s71
    buffer_store_dwordx4 v[84:87], v40, s[28:31], s43 offen sc1
    s_mov_b64 exec, -1
    s_branch Lfnext_138
Lfw3_137:
    s_cmp_lt_u32 s66, 4
    s_cbranch_scc1 Lfnext_138
    v_and_b32 v34, 3, v0
    v_lshlrev_b32 v34, 4, v34
    s_mul_i32 s43, s69, 160
    v_add_u32 v33, s43, v34
    ds_read_b128 v[96:99], v33 offset:32768
    ds_read_b128 v[100:103], v33 offset:32832
    ds_read_b128 v[104:107], v33 offset:32896
    s_mov_b32 s46, 0
    v_mov_b32 v92, 0
    v_mov_b32 v93, 0
    v_mov_b32 v94, 0
    v_mov_b32 v95, 0
Lfin_139:
    buffer_load_dwordx4 v[84:87], v41, s[28:31], s71 offen sc1
    buffer_load_dwordx4 v[88:91], v41, s[28:31], s71 offen offset:64 sc1
    s_mov_b32 exec_lo, 0x33333333
    s_mov_b32 exec_hi, 0x33333333
    buffer_load_dwordx4 v[92:95], v41, s[28:31], s71 offen offset:128 sc1
    s_mov_b64 exec, -1
    s_waitcnt vmcnt(0)
    v_max_u32 v31, v84, v85
    v_max3_u32 v31, v86, v87, v31
    v_max3_u32 v31, v88, v89, v31
    v_max3_u32 v31, v90, v91, v31
    v_max3_u32 v31, v92, v93, v31
    v_max3_u32 v31, v94, v95, v31
    v_cmp_eq_u32 vcc, -1, v31
    s_cbranch_vccz Lfinok_140
    s_add_u32 s46, s46, 1
    s_cmp_lt_u32 s46, 524288
    s_cbranch_scc1 Lfin_139
Lfinok_140:
    s_nop 1
    v_add_f32_dpp v84, v84, v84 row_ror:4 row_mask:0xf bank_mask:0xf
    s_nop 1
    v_add_f32_dpp v84, v84, v84 row_ror:8 row_mask:0xf bank_mask:0xf
    v_mov_b32 v31, v84
    s_nop 1
    v_permlane16_swap_b32 v84, v31
    s_nop 1
    v_add_f32 v84, v84, v31
    v_mov_b32 v31, v84
    s_nop 1
    v_permlane32_swap_b32 v84, v31
    s_nop 1
    v_add_f32 v84, v84, v31
    s_nop 1
    v_add_f32_dpp v85, v85, v85 row_ror:4 row_mask:0xf bank_mask:0xf
    s_nop 1
    v_add_f32_dpp v85, v85, v85 row_ror:8 row_mask:0xf bank_mask:0xf
    v_mov_b32 v31, v85
    s_nop 1
    v_permlane16_swap_b32 v85, v31
    s_nop 1
    v_add_f32 v85, v85, v31
    v_mov_b32 v31, v85
    s_nop 1
    v_permlane32_swap_b32 v85, v31
    s_nop 1
    v_add_f32 v85, v85, v31
    s_nop 1
    v_add_f32_dpp v86, v86, v86 row_ror:4 row_mask:0xf bank_mask:0xf
    s_nop 1
    v_add_f32_dpp v86, v86, v86 row_ror:8 row_mask:0xf bank_mask:0xf
    v_mov_b32 v31, v86
    s_nop 1
    v_permlane16_swap_b32 v86, v31
    s_nop 1
    v_add_f32 v86, v86, v31
    v_mov_b32 v31, v86
    s_nop 1
    v_permlane32_swap_b32 v86, v31
    s_nop 1
    v_add_f32 v86, v86, v31
    s_nop 1
    v_add_f32_dpp v87, v87, v87 row_ror:4 row_mask:0xf bank_mask:0xf
    s_nop 1
    v_add_f32_dpp v87, v87, v87 row_ror:8 row_mask:0xf bank_mask:0xf
    v_mov_b32 v31, v87
    s_nop 1
    v_permlane16_swap_b32 v87, v31
    s_nop 1
    v_add_f32 v87, v87, v31
    v_mov_b32 v31, v87
    s_nop 1
    v_permlane32_swap_b32 v87, v31
    s_nop 1
    v_add_f32 v87, v87, v31
    s_nop 1
    v_add_f32_dpp v88, v88, v88 row_ror:4 row_mask:0xf bank_mask:0xf
    s_nop 1
    v_add_f32_dpp v88, v88, v88 row_ror:8 row_mask:0xf bank_mask:0xf
    v_mov_b32 v31, v88
    s_nop 1
    v_permlane16_swap_b32 v88, v31
    s_nop 1
    v_add_f32 v88, v88, v31
    v_mov_b32 v31, v88
    s_nop 1
    v_permlane32_swap_b32 v88, v31
    s_nop 1
    v_add_f32 v88, v88, v31
    s_nop 1
    v_add_f32_dpp v89, v89, v89 row_ror:4 row_mask:0xf bank_mask:0xf
    s_nop 1
    v_add_f32_dpp v89, v89, v89 row_ror:8 row_mask:0xf bank_mask:0xf
    v_mov_b32 v31, v89
    s_nop 1
    v_permlane16_swap_b32 v89, v31
    s_nop 1
    v_add_f32 v89, v89, v31
    v_mov_b32 v31, v89
    s_nop 1
    v_permlane32_swap_b32 v89, v31
    s_nop 1
    v_add_f32 v89, v89, v31
    s_nop 1
    v_add_f32_dpp v90, v90, v90 row_ror:4 row_mask:0xf bank_mask:0xf
    s_nop 1
    v_add_f32_dpp v90, v90, v90 row_ror:8 row_mask:0xf bank_mask:0xf
    v_mov_b32 v31, v90
    s_nop 1
    v_permlane16_swap_b32 v90, v31
    s_nop 1
    v_add_f32 v90, v90, v31
    v_mov_b32 v31, v90
    s_nop 1
    v_permlane32_swap_b32 v90, v31
    s_nop 1
    v_add_f32 v90, v90, v31
    s_nop 1
    v_add_f32_dpp v91, v91, v91 row_ror:4 row_mask:0xf bank_mask:0xf
    s_nop 1
    v_add_f32_dpp v91, v91, v91 row_ror:8 row_mask:0xf bank_mask:0xf
    v_mov_b32 v31, v91
    s_nop 1
    v_permlane16_swap_b32 v91, v31
    s_nop 1
    v_add_f32 v91, v91, v31
    v_mov_b32 v31, v91
    s_nop 1
    v_permlane32_swap_b32 v91, v31
    s_nop 1
    v_add_f32 v91, v91, v31
    s_nop 1
    v_add_f32_dpp v92, v92, v92 row_ror:4 row_mask:0xf bank_mask:0xf
    s_nop 1
    v_add_f32_dpp v92, v92, v92 row_ror:8 row_mask:0xf bank_mask:0xf
    v_mov_b32 v31, v92
    s_nop 1
    v_permlane16_swap_b32 v92, v31
    s_nop 1
    v_add_f32 v92, v92, v31
    v_mov_b32 v31, v92
    s_nop 1
    v_permlane32_swap_b32 v92, v31
    s_nop 1
    v_add_f32 v92, v92, v31
    s_nop 1
    v_add_f32_dpp v93, v93, v93 row_ror:4 row_mask:0xf bank_mask:0xf
    s_nop 1
    v_add_f32_dpp v93, v93, v93 row_ror:8 row_mask:0xf bank_mask:0xf
    v_mov_b32 v31, v93
    s_nop 1
    v_permlane16_swap_b32 v93, v31
    s_nop 1
    v_add_f32 v93, v93, v31
    v_mov_b32 v31, v93
    s_nop 1
    v_permlane32_swap_b32 v93, v31
    s_nop 1
    v_add_f32 v93, v93, v31
    s_nop 1
    v_add_f32_dpp v94, v94, v94 row_ror:4 row_mask:0xf bank_mask:0xf
    s_nop 1
    v_add_f32_dpp v94, v94, v94 row_ror:8 row_mask:0xf bank_mask:0xf
    v_mov_b32 v31, v94
    s_nop 1
    v_permlane16_swap_b32 v94, v31
    s_nop 1
    v_add_f32 v94, v94, v31
    v_mov_b32 v31, v94
    s_nop 1
    v_permlane32_swap_b32 v94, v31
    s_nop 1
    v_add_f32 v94, v94, v31
    s_nop 1
    v_add_f32_dpp v95, v95, v95 row_ror:4 row_mask:0xf bank_mask:0xf
    s_nop 1
    v_add_f32_dpp v95, v95, v95 row_ror:8 row_mask:0xf bank_mask:0xf
    v_mov_b32 v31, v95
    s_nop 1
    v_permlane16_swap_b32 v95, v31
    s_nop 1
    v_add_f32 v95, v95, v31
    v_mov_b32 v31, v95
    s_nop 1
    v_permlane32_swap_b32 v95, v31
    s_nop 1
    v_add_f32 v95, v95, v31
    s_waitcnt lgkmcnt(0)
    v_cvt_pk_bf16_f32 v84, v84, v84
    v_lshlrev_b32 v84, 16, v84
    v_add_f32 v84, v84, v96
    v_cvt_pk_bf16_f32 v85, v85, v85
    v_lshlrev_b32 v85, 16, v85
    v_add_f32 v85, v85, v97
    v_cvt_pk_bf16_f32 v86, v86, v86
    v_lshlrev_b32 v86, 16, v86
    v_add_f32 v86, v86, v98
    v_cvt_pk_bf16_f32 v87, v87, v87
    v_lshlrev_b32 v87, 16, v87
    v_add_f32 v87, v87, v99
    v_cvt_pk_bf16_f32 v88, v88, v88
    v_lshlrev_b32 v88, 16, v88
    v_add_f32 v88, v88, v100
    v_cvt_pk_bf16_f32 v89, v89, v89
    v_lshlrev_b32 v89, 16, v89
    v_add_f32 v89, v89, v101
    v_cvt_pk_bf16_f32 v90, v90, v90
    v_lshlrev_b32 v90, 16, v90
    v_add_f32 v90, v90, v102
    v_cvt_pk_bf16_f32 v91, v91, v91
    v_lshlrev_b32 v91, 16, v91
    v_add_f32 v91, v91, v103
    v_cvt_pk_bf16_f32 v92, v92, v92
    v_lshlrev_b32 v92, 16, v92
    v_add_f32 v92, v92, v104
    v_cvt_pk_bf16_f32 v93, v93, v93
    v_lshlrev_b32 v93, 16, v93
    v_add_f32 v93, v93, v105
    v_cvt_pk_bf16_f32 v94, v94, v94
    v_lshlrev_b32 v94, 16, v94
    v_add_f32 v94, v94, v106
    v_cvt_pk_bf16_f32 v95, v95, v95
    v_lshlrev_b32 v95, 16, v95
    v_add_f32 v95, v95, v107
    v_cvt_pk_bf16_f32 v108, v84, v85
    v_cvt_pk_bf16_f32 v109, v86, v87
    v_cvt_pk_bf16_f32 v110, v88, v89
    v_cvt_pk_bf16_f32 v111, v90, v91
    v_cvt_pk_bf16_f32 v112, v92, v93
    v_cvt_pk_bf16_f32 v113, v94, v95
    v_lshrrev_b32 v34, 1, v34
    s_mul_i32 s43, s68, 1280
    s_mul_i32 s44, s69, 80
    s_add_u32 s43, s43, s44
    s_mov_b64 exec, 15
    buffer_store_dwordx2 v[108:109], v34, s[56:59], s43 offen
    buffer_store_dwordx2 v[110:111], v34, s[56:59], s43 offen offset:32
    s_mov_b64 exec, 3
    buffer_store_dwordx2 v[112:113], v34, s[56:59], s43 offen offset:64
    s_mov_b64 exec, -1
Lfnext_138:
    s_add_u32 s67, s67, 1
    s_cmp_lt_u32 s67, 8
    s_cbranch_scc1 L_ftask
    s_waitcnt vmcnt(0)
    s_branch L_end
L_end:
    s_endpgm

.section .rodata,"a"
.p2align 6
.amdhsa_kernel interleave_layers__mha_block_cached__glu_gated_geglu__decode_kernel
  .amdhsa_next_free_vgpr 512
  .amdhsa_next_free_sgpr 102
  .amdhsa_accum_offset 256
  .amdhsa_group_segment_fixed_size 0
  .amdhsa_kernarg_size 96
  .amdhsa_user_sgpr_count 2
  .amdhsa_user_sgpr_kernarg_segment_ptr 1
  .amdhsa_system_sgpr_workgroup_id_x 1
.end_amdhsa_kernel
```
